```python
import torch

def _softmax(x, axis=-1):
    return torch.softmax(x, dim=axis)
def _gelu(x):
    return torch.nn.functional.gelu(x, approximate="tanh")
def _silu(x):
    return torch.nn.functional.silu(x)
def _sigmoid(x):
    return torch.sigmoid(x)
def _layernorm(x, axis=-1, eps=1e-5):
    m = x.mean(dim=axis, keepdim=True)
    v = x.var(dim=axis, keepdim=True, unbiased=False)
    return (x - m) / torch.sqrt(v + eps)
def _scatter_add(tgt, idx, src, axis=0):
    return tgt.clone().index_add_(axis, idx, src)
def _segment_sum(src, seg, n):
    out = torch.zeros((n,) + src.shape[1:], dtype=src.dtype)
    return out.index_add_(0, seg, src)
def _pad(x, pw):
    flat = tuple(v for pair in reversed(pw) for v in pair)
    return torch.nn.functional.pad(x, flat)

kernel_name = 'standalone__mha_block_cached__near_ridge'

def setup_inputs():

    _w = (lambda a: (lambda t: t.to(torch.bfloat16) if t.is_floating_point() else t)(torch.as_tensor(a)))
    B, Sq, D = 8, 256, 640
    H, Sk, Dh = 32, 1024, 128
    return {
        "x": _w((lambda *s: torch.randn(*s, dtype=torch.bfloat16) * 0.8)(B, Sq, D)),
        "k_cache": _w((lambda *s: torch.randn(*s, dtype=torch.bfloat16) * 0.8)(B, H, Sk, Dh)),
        "v_cache": _w((lambda *s: torch.randn(*s, dtype=torch.bfloat16) * 0.05)(B, H, Sk, Dh)),
        "wq": _w((lambda *s: torch.randn(*s, dtype=torch.bfloat16) * 0.8)(D, H * Dh) * (D ** -0.5)),
        "wo": _w((lambda *s: torch.randn(*s, dtype=torch.bfloat16) * 0.05)(H * Dh, D) * ((H * Dh) ** -0.5)),
    }

def reference(x, k_cache, v_cache, wq, wo):
    B, Sq, D = x.shape
    H, Dh = 32, 128
    q = (lambda x, *d: x.permute(*d))((x @ wq).reshape(B, Sq, H, Dh), 0, 2, 1, 3)
    scores = torch.einsum("bhqd,bhkd->bhqk", q, k_cache) * (Dh ** -0.5)
    p = _softmax(scores, axis=-1)
    o = torch.einsum("bhqk,bhkd->bhqd", p, v_cache)
    return (lambda x, *d: x.permute(*d))(o, 0, 2, 1, 3).reshape(B, Sq, H * Dh) @ wo
```

```asm
; @launch grid=(256,1,1) block=(256,1,1) lds=163840
.amdgcn_target "amdgcn-amd-amdhsa--gfx950"
.text
.globl standalone__mha_block_cached__near_ridge_kernel
.p2align 8
.type standalone__mha_block_cached__near_ridge_kernel,@function
standalone__mha_block_cached__near_ridge_kernel:
s_cmp_ge_u32 s2, 256
s_cbranch_scc1 L_end
s_mov_b32 s73, 0
L_top:
s_load_dwordx16 s[16:31], s[0:1], 0
v_lshrrev_b32 v21, 6, v0
v_and_b32 v1, 63, v0
v_readfirstlane_b32 s60, v21
s_brev_b32 s4, s2
s_lshr_b32 s4, s4, 29
s_lshr_b32 s5, s2, 3
s_and_b32 s6, s5, 3
s_lshr_b32 s7, s5, 2
s_and_b32 s61, s4, 1
s_lshl_b32 s61, s61, 2
s_add_u32 s61, s61, s6
s_lshr_b32 s62, s4, 1
s_lshl_b32 s62, s62, 3
s_add_u32 s62, s62, s7
s_lshr_b32 s8, s4, 1
s_and_b32 s9, s4, 1
s_lshl_b32 s9, s9, 1
s_add_u32 s8, s8, s9
s_and_b32 s8, s8, 3
s_mul_i32 s8, s8, 5
s_lshr_b32 s63, s8, 1
s_lshl_b32 s68, s60, 13
s_lshl_b32 s69, s60, 12
s_mul_i32 s64, s61, 327680
s_mul_i32 s8, s60, 81920
s_add_u32 s64, s64, s8
s_bitcmp1_b32 s2, 1
s_cselect_b32 s8, 40960, 0
s_cselect_b32 s79, -40960, 0
s_cselect_b32 s79, s79, 40960
s_add_u32 s64, s64, s8
s_lshl_b32 s65, s62, 8
s_lshl_b32 s8, s60, 17
s_add_u32 s65, s65, s8
v_lshrrev_b32 v21, 4, v1
v_and_b32 v22, 15, v1
v_lshlrev_b32 v23, 1, v21
v_xor_b32 v23, v23, v22
v_lshlrev_b32 v23, 4, v23
v_lshl_add_u32 v178, v21, 13, v23
v_add_u32 v179, 31744, v178
v_xor_b32 v23, 128, v178
v_add_u32 v180, 63488, v23
v_add_u32 v181, 95232, v23
v_lshrrev_b32 v22, 3, v1
v_and_b32 v23, 7, v1
v_xor_b32 v23, v23, v21
v_mul_u32_u24 v22, 1280, v22
v_lshl_add_u32 v174, v23, 4, v22
v_add_u32 v176, 18432, v174
v_xor_b32 v23, 64, v174
v_add_u32 v175, 9216, v23
v_add_u32 v177, 27648, v23
s_waitcnt lgkmcnt(0)
s_mov_b32 s44, s22
s_mov_b32 s45, s23
s_mov_b32 s46, 5242880
s_mov_b32 s47, 0x20000
s_mov_b32 s32, s16
s_mov_b32 s33, s17
s_mov_b32 s34, 2621440
s_mov_b32 s35, 0x20000
s_lshl_b32 s66, s63, 19
s_add_u32 s66, s66, s65
s_add_u32 m0, s69, 81920
s_nop 0
buffer_load_dwordx4 v178, s[44:47], s66 offen lds
buffer_load_dwordx4 v179, s[44:47], s66 offen offset:1024 lds
buffer_load_dwordx4 v180, s[44:47], s66 offen offset:2048 lds
buffer_load_dwordx4 v181, s[44:47], s66 offen offset:3072 lds
s_lshl_b32 s70, s63, 7
s_add_u32 s70, s70, s64
s_add_u32 m0, s68, 98304
s_nop 0
buffer_load_dwordx4 v174, s[32:35], s70 offen lds
buffer_load_dwordx4 v175, s[32:35], s70 offen offset:1024 lds
buffer_load_dwordx4 v176, s[32:35], s70 offen offset:2048 lds
buffer_load_dwordx4 v177, s[32:35], s70 offen offset:3072 lds
s_add_u32 s71, s70, s79
s_add_u32 m0, s68, 102400
s_add_u32 s63, s63, 1
s_nop 0
buffer_load_dwordx4 v174, s[32:35], s71 offen lds
s_cmp_eq_u32 s63, 10
s_cselect_b32 s63, 0, s63
s_nop 0
buffer_load_dwordx4 v175, s[32:35], s71 offen offset:1024 lds
buffer_load_dwordx4 v176, s[32:35], s71 offen offset:2048 lds
buffer_load_dwordx4 v177, s[32:35], s71 offen offset:3072 lds
s_mov_b32 s36, s18
s_mov_b32 s37, s19
s_mov_b32 s38, 67108864
s_mov_b32 s39, 0x20000
s_mov_b32 s40, s20
s_mov_b32 s41, s21
s_mov_b32 s42, 67108864
s_mov_b32 s43, 0x20000
s_mov_b32 s48, s24
s_mov_b32 s49, s25
s_mov_b32 s50, 5242880
s_mov_b32 s51, 0x20000
s_mov_b32 s52, s30
s_mov_b32 s53, s31
s_mov_b32 s54, 268435456
s_mov_b32 s55, 0x20000
s_mov_b32 s56, s26
s_mov_b32 s57, s27
s_mov_b32 s58, 2621440
s_mov_b32 s59, 0x20000
s_mov_b32 s12, s28
s_mov_b32 s13, s29
s_mov_b32 s14, 256
s_mov_b32 s15, 0x20000
s_lshl_b32 s67, s61, 5
s_add_u32 s67, s67, s62
s_lshl_b32 s67, s67, 18
s_and_b32 s8, s60, 1
s_lshl_b32 s8, s8, 12
s_add_u32 s67, s67, s8
s_lshr_b32 s8, s60, 1
s_lshl_b32 s8, s8, 13
s_add_u32 s67, s67, s8
s_getpc_b64 s[8:9]
L_pc:
s_mov_b32 s10, L_codeend-L_pc
s_mov_b32 s11, 0x20000
s_mul_i32 s3, s5, 2304
v_mul_u32_u24 v21, 9, v0
v_and_b32 v21, -4, v21
buffer_load_dword v250, v21, s[8:11], s3 offen
s_mov_b32 s72, 0x3e0293ee
s_mov_b32 s77, 0x53800000
v_lshrrev_b32 v240, 4, v1
v_bfe_u32 v241, v1, 2, 2
v_and_b32 v242, 3, v1
v_lshl_add_u32 v21, v240, 3, v241
v_lshlrev_b32 v21, 8, v21
v_lshl_add_u32 v21, v242, 3, v21
v_add_u32 v21, 32768, v21
v_and_b32 v22, 1, v240
v_lshl_add_u32 v22, v22, 2, v241
v_xor_b32 v23, 0, v22
v_lshl_add_u32 v160, v23, 5, v21
v_xor_b32 v23, 1, v22
v_lshl_add_u32 v161, v23, 5, v21
v_xor_b32 v23, 2, v22
v_lshl_add_u32 v162, v23, 5, v21
v_xor_b32 v23, 3, v22
v_lshl_add_u32 v163, v23, 5, v21
v_xor_b32 v23, 4, v22
v_lshl_add_u32 v164, v23, 5, v21
v_xor_b32 v23, 5, v22
v_lshl_add_u32 v165, v23, 5, v21
v_xor_b32 v23, 6, v22
v_lshl_add_u32 v166, v23, 5, v21
v_xor_b32 v23, 7, v22
v_lshl_add_u32 v167, v23, 5, v21
v_and_b32 v21, 15, v1
v_lshrrev_b32 v22, 1, v21
v_xor_b32 v22, v22, v240
v_lshlrev_b32 v21, 7, v21
v_add_u32 v21, s68, v21
v_xor_b32 v23, 0, v22
v_lshl_add_u32 v23, v23, 4, v21
v_add_u32 v168, 98304, v23
v_add_u32 v170, 131072, v23
v_xor_b32 v23, 4, v22
v_lshl_add_u32 v23, v23, 4, v21
v_add_u32 v169, 98304, v23
v_add_u32 v171, 131072, v23
v_lshl_add_u32 v243, v240, 2, v241
v_lshlrev_b32 v21, 8, v243
v_lshl_add_u32 v21, v242, 3, v21
v_add_u32 v21, 65536, v21
v_and_b32 v22, 7, v243
v_xor_b32 v23, 0, v22
v_lshl_add_u32 v6, v23, 5, v21
v_xor_b32 v23, 1, v22
v_lshl_add_u32 v7, v23, 5, v21
v_xor_b32 v23, 2, v22
v_lshl_add_u32 v8, v23, 5, v21
v_xor_b32 v23, 3, v22
v_lshl_add_u32 v9, v23, 5, v21
v_xor_b32 v23, 4, v22
v_lshl_add_u32 v10, v23, 5, v21
v_xor_b32 v23, 5, v22
v_lshl_add_u32 v11, v23, 5, v21
v_xor_b32 v23, 6, v22
v_lshl_add_u32 v12, v23, 5, v21
v_xor_b32 v23, 7, v22
v_lshl_add_u32 v13, v23, 5, v21
v_mul_u32_u24 v21, 640, v243
v_lshl_add_u32 v21, v242, 3, v21
s_mul_i32 s75, s60, 5120
s_add_u32 s75, s75, 16384
s_cmp_eq_u32 s60, 3
s_cselect_b32 s75, 65536, s75
s_lshr_b32 s8, s2, 1
s_mul_i32 s10, s8, 40960
s_and_b32 s8, s2, 1
s_mul_i32 s8, s8, 640
s_add_u32 s10, s10, s8
s_mul_i32 s8, s60, 160
s_add_u32 s8, s8, 16384
v_add_u32 v237, s8, v21
v_lshrrev_b32 v21, 5, v1
v_mul_u32_u24 v21, 33792, v21
v_add_u32 v31, v21, v237
v_lshlrev_b32 v238, 4, v1
v_add_u32 v29, s69, v238
v_add_u32 v30, 65536, v29
v_and_b32 v22, 15, v1
v_and_b32 v244, 1, v240
v_lshlrev_b32 v244, 8, v244
v_lshrrev_b32 v23, 1, v240
v_lshl_add_u32 v244, v23, 15, v244
v_or_b32 v23, 0, v240
v_xor_b32 v23, v23, v22
v_lshlrev_b32 v23, 4, v23
v_add_u32 v14, v244, v23
v_or_b32 v23, 4, v240
v_xor_b32 v23, v23, v22
v_lshlrev_b32 v23, 4, v23
v_add_u32 v15, v244, v23
v_or_b32 v23, 8, v240
v_xor_b32 v23, v23, v22
v_lshlrev_b32 v23, 4, v23
v_add_u32 v16, v244, v23
v_or_b32 v23, 12, v240
v_xor_b32 v23, v23, v22
v_lshlrev_b32 v23, 4, v23
v_add_u32 v17, v244, v23
v_lshlrev_b32 v23, 1, v240
v_xor_b32 v23, v23, v22
v_lshlrev_b32 v23, 4, v23
v_add_u32 v18, v244, v23
v_xor_b32 v19, 128, v18
v_lshlrev_b32 v21, 8, v22
v_bfrev_b32 v23, v240
v_lshrrev_b32 v23, 30, v23
v_xor_b32 v22, v22, v23
v_lshlrev_b32 v28, 4, v23
v_xor_b32 v23, 0, v22
v_lshl_add_u32 v2, v23, 4, v21
v_xor_b32 v23, 4, v22
v_lshl_add_u32 v3, v23, 4, v21
v_xor_b32 v23, 8, v22
v_lshl_add_u32 v4, v23, 4, v21
v_xor_b32 v23, 12, v22
v_lshl_add_u32 v5, v23, 4, v21
v_mov_b32 v21, 0x3f803f80
v_accvgpr_write_b32 a144, v21
v_accvgpr_write_b32 a145, v21
v_accvgpr_write_b32 a146, v21
v_accvgpr_write_b32 a147, v21
s_lshl_b32 s8, s61, 2
s_add_u32 s8, s8, s60
s_and_b32 s8, s8, -2
s_bfe_u32 s9, s2, 0x10001
s_add_u32 s8, s8, s9
s_and_b32 s3, s60, 1
s_lshl_b32 s74, s8, 19
s_lshl_b32 s9, s62, 14
s_add_u32 s74, s74, s9
s_lshl_b32 s9, s3, 11
s_add_u32 s74, s74, s9
s_lshl1_add_u32 s9, s8, s3
s_lshl_b32 s9, s9, 5
s_add_u32 s9, s9, s62
s_lshl_b32 s78, s9, 8
s_add_u32 s78, s78, 25165824
s_xor_b32 s27, s78, 16384
s_mul_i32 s8, s60, 320
v_add_u32 v243, s8, v1
v_add_u32 v21, 0, v243
v_mul_u32_u24 v22, 6554, v21
v_lshrrev_b32 v22, 18, v22
v_mul_u32_u24 v23, 640, v22
v_lshl_add_u32 v23, v21, 4, v23
v_subrev_u32 v232, 0, v23
v_add_u32 v21, 64, v243
v_mul_u32_u24 v22, 6554, v21
v_lshrrev_b32 v22, 18, v22
v_mul_u32_u24 v23, 640, v22
v_lshl_add_u32 v23, v21, 4, v23
v_subrev_u32 v233, 1024, v23
v_add_u32 v21, 128, v243
v_mul_u32_u24 v22, 6554, v21
v_lshrrev_b32 v22, 18, v22
v_mul_u32_u24 v23, 640, v22
v_lshl_add_u32 v23, v21, 4, v23
v_subrev_u32 v234, 2048, v23
v_add_u32 v21, 192, v243
v_mul_u32_u24 v22, 6554, v21
v_lshrrev_b32 v22, 18, v22
v_mul_u32_u24 v23, 640, v22
v_lshl_add_u32 v23, v21, 4, v23
v_subrev_u32 v235, 3072, v23
v_add_u32 v21, 256, v243
v_mul_u32_u24 v22, 6554, v21
v_lshrrev_b32 v22, 18, v22
v_mul_u32_u24 v23, 640, v22
v_lshl_add_u32 v23, v21, 4, v23
v_subrev_u32 v236, 0, v23
s_and_b32 s9, s2, 1
s_lshl2_add_u32 s9, s9, s60
s_mul_i32 s9, s9, 655360
s_lshr_b32 s8, s2, 1
s_mul_i32 s8, s8, 5120
s_add_u32 s9, s9, s8
s_add_u32 s11, s9, 16777216
s_add_u32 s62, s11, 4096
v_or_b32 v21, s73, v0
v_min_u32 v21, 1, v21
v_lshlrev_b32 v20, 12, v21
s_and_b32 s8, s2, 128
v_add_u32 v20, s8, v20
s_bfe_u32 s9, s2, 0x10001
s_xor_b32 s9, s9, 1
s_lshl_b32 s24, s9, 15
s_xor_b32 s3, s9, 2
s_lshl_b32 s25, s3, 15
s_lshl_b32 s66, s63, 19
s_add_u32 s66, s66, s65
s_add_u32 m0, s69, 32768
s_nop 0
buffer_load_dwordx4 v178, s[44:47], s66 offen lds
buffer_load_dwordx4 v179, s[44:47], s66 offen offset:1024 lds
buffer_load_dwordx4 v180, s[44:47], s66 offen offset:2048 lds
buffer_load_dwordx4 v181, s[44:47], s66 offen offset:3072 lds
s_lshl_b32 s70, s63, 7
s_add_u32 s70, s70, s64
s_add_u32 m0, s68, 131072
s_nop 0
buffer_load_dwordx4 v174, s[32:35], s70 offen lds
buffer_load_dwordx4 v175, s[32:35], s70 offen offset:1024 lds
buffer_load_dwordx4 v176, s[32:35], s70 offen offset:2048 lds
buffer_load_dwordx4 v177, s[32:35], s70 offen offset:3072 lds
s_add_u32 s71, s70, s79
s_add_u32 m0, s68, 135168
s_add_u32 s63, s63, 1
s_nop 0
buffer_load_dwordx4 v174, s[32:35], s71 offen lds
s_cmp_eq_u32 s63, 10
s_cselect_b32 s63, 0, s63
s_nop 0
buffer_load_dwordx4 v175, s[32:35], s71 offen offset:1024 lds
buffer_load_dwordx4 v176, s[32:35], s71 offen offset:2048 lds
buffer_load_dwordx4 v177, s[32:35], s71 offen offset:3072 lds
s_branch L_main
.p2align 12
L_main:
s_waitcnt vmcnt(13)
s_barrier
ds_read_b64_tr_b16 a[64:65], v160 offset:49152
ds_read_b64_tr_b16 a[66:67], v160 offset:50176
ds_read_b64_tr_b16 a[68:69], v160 offset:57344
ds_read_b64_tr_b16 a[70:71], v160 offset:58368
ds_read_b128 a[0:3], v168 offset:0
ds_read_b128 a[4:7], v169 offset:0
ds_read_b64_tr_b16 a[72:73], v161 offset:49152
ds_read_b64_tr_b16 a[74:75], v161 offset:50176
ds_read_b64_tr_b16 a[76:77], v161 offset:57344
ds_read_b64_tr_b16 a[78:79], v161 offset:58368
ds_read_b128 a[8:11], v168 offset:2048
ds_read_b128 a[12:15], v169 offset:2048
ds_read_b128 a[16:19], v168 offset:4096
ds_read_b128 a[20:23], v169 offset:4096
ds_read_b128 a[24:27], v168 offset:6144
ds_read_b128 a[28:31], v169 offset:6144
s_waitcnt lgkmcnt(10)
v_mfma_f32_16x16x32_bf16 v[32:35], a[64:67], a[0:3], 0
s_lshl_b32 s66, s63, 19
ds_read_b64_tr_b16 a[80:81], v162 offset:49152
v_mfma_f32_16x16x32_bf16 v[32:35], a[68:71], a[4:7], v[32:35]
s_waitcnt lgkmcnt(7)
s_add_u32 s66, s66, s65
ds_read_b64_tr_b16 a[82:83], v162 offset:50176
v_mfma_f32_16x16x32_bf16 v[96:99], a[76:79], a[4:7], 0
s_add_u32 m0, s69, 49152
ds_read_b64_tr_b16 a[84:85], v162 offset:57344
v_mfma_f32_16x16x32_bf16 v[96:99], a[72:75], a[0:3], v[96:99]
s_waitcnt lgkmcnt(7)
buffer_load_dwordx4 v178, s[44:47], s66 offen lds
v_mfma_f32_16x16x32_bf16 v[112:115], a[72:75], a[8:11], 0
ds_read_b64_tr_b16 a[86:87], v162 offset:58368
v_mfma_f32_16x16x32_bf16 v[112:115], a[76:79], a[12:15], v[112:115]
ds_read_b64_tr_b16 a[88:89], v163 offset:49152
v_mfma_f32_16x16x32_bf16 v[48:51], a[68:71], a[12:15], 0
ds_read_b64_tr_b16 a[90:91], v163 offset:50176
v_mfma_f32_16x16x32_bf16 v[48:51], a[64:67], a[8:11], v[48:51]
s_waitcnt lgkmcnt(8)
buffer_load_dwordx4 v179, s[44:47], s66 offen offset:1024 lds
v_mfma_f32_16x16x32_bf16 v[64:67], a[64:67], a[16:19], 0
ds_read_b64_tr_b16 a[92:93], v163 offset:57344
v_mfma_f32_16x16x32_bf16 v[64:67], a[68:71], a[20:23], v[64:67]
ds_read_b64_tr_b16 a[94:95], v163 offset:58368
v_mfma_f32_16x16x32_bf16 v[128:131], a[76:79], a[20:23], 0
ds_read_b64_tr_b16 a[96:97], v164 offset:49152
v_mfma_f32_16x16x32_bf16 v[128:131], a[72:75], a[16:19], v[128:131]
s_waitcnt lgkmcnt(9)
buffer_load_dwordx4 v180, s[44:47], s66 offen offset:2048 lds
v_mfma_f32_16x16x32_bf16 v[144:147], a[72:75], a[24:27], 0
ds_read_b64_tr_b16 a[98:99], v164 offset:50176
v_mfma_f32_16x16x32_bf16 v[144:147], a[76:79], a[28:31], v[144:147]
ds_read_b64_tr_b16 a[100:101], v164 offset:57344
v_mfma_f32_16x16x32_bf16 v[80:83], a[68:71], a[28:31], 0
ds_read_b64_tr_b16 a[102:103], v164 offset:58368
v_mfma_f32_16x16x32_bf16 v[80:83], a[64:67], a[24:27], v[80:83]
s_waitcnt lgkmcnt(4)
buffer_load_dwordx4 v181, s[44:47], s66 offen offset:3072 lds
v_mfma_f32_16x16x32_bf16 v[36:39], a[80:83], a[0:3], 0
s_lshl_b32 s70, s63, 7
ds_read_b64_tr_b16 a[104:105], v165 offset:49152
v_mfma_f32_16x16x32_bf16 v[36:39], a[84:87], a[4:7], v[36:39]
s_add_u32 s70, s70, s64
ds_read_b64_tr_b16 a[106:107], v165 offset:50176
v_mfma_f32_16x16x32_bf16 v[100:103], a[92:95], a[4:7], 0
s_add_u32 m0, s68, 98304
ds_read_b64_tr_b16 a[108:109], v165 offset:57344
v_mfma_f32_16x16x32_bf16 v[100:103], a[88:91], a[0:3], v[100:103]
buffer_load_dwordx4 v174, s[32:35], s70 offen lds
v_mfma_f32_16x16x32_bf16 v[116:119], a[88:91], a[8:11], 0
ds_read_b64_tr_b16 a[110:111], v165 offset:58368
v_mfma_f32_16x16x32_bf16 v[116:119], a[92:95], a[12:15], v[116:119]
ds_read_b64_tr_b16 a[112:113], v166 offset:49152
v_mfma_f32_16x16x32_bf16 v[52:55], a[84:87], a[12:15], 0
ds_read_b64_tr_b16 a[114:115], v166 offset:50176
v_mfma_f32_16x16x32_bf16 v[52:55], a[80:83], a[8:11], v[52:55]
buffer_load_dwordx4 v175, s[32:35], s70 offen offset:1024 lds
v_mfma_f32_16x16x32_bf16 v[68:71], a[80:83], a[16:19], 0
ds_read_b64_tr_b16 a[116:117], v166 offset:57344
v_mfma_f32_16x16x32_bf16 v[68:71], a[84:87], a[20:23], v[68:71]
ds_read_b64_tr_b16 a[118:119], v166 offset:58368
v_mfma_f32_16x16x32_bf16 v[132:135], a[92:95], a[20:23], 0
ds_read_b64_tr_b16 a[120:121], v167 offset:49152
v_mfma_f32_16x16x32_bf16 v[132:135], a[88:91], a[16:19], v[132:135]
buffer_load_dwordx4 v176, s[32:35], s70 offen offset:2048 lds
v_mfma_f32_16x16x32_bf16 v[148:151], a[88:91], a[24:27], 0
ds_read_b64_tr_b16 a[122:123], v167 offset:50176
v_mfma_f32_16x16x32_bf16 v[148:151], a[92:95], a[28:31], v[148:151]
ds_read_b64_tr_b16 a[124:125], v167 offset:57344
v_mfma_f32_16x16x32_bf16 v[84:87], a[84:87], a[28:31], 0
ds_read_b64_tr_b16 a[126:127], v167 offset:58368
v_mfma_f32_16x16x32_bf16 v[84:87], a[80:83], a[24:27], v[84:87]
s_waitcnt lgkmcnt(8)
buffer_load_dwordx4 v177, s[32:35], s70 offen offset:3072 lds
v_mfma_f32_16x16x32_bf16 v[40:43], a[96:99], a[0:3], 0
s_add_u32 s71, s70, s79
v_mfma_f32_16x16x32_bf16 v[40:43], a[100:103], a[4:7], v[40:43]
s_add_u32 m0, s68, 102400
s_add_u32 s63, s63, 1
v_mfma_f32_16x16x32_bf16 v[104:107], a[108:111], a[4:7], 0
buffer_load_dwordx4 v174, s[32:35], s71 offen lds
v_mfma_f32_16x16x32_bf16 v[104:107], a[104:107], a[0:3], v[104:107]
s_cmp_eq_u32 s63, 10
s_cselect_b32 s63, 0, s63
v_mfma_f32_16x16x32_bf16 v[120:123], a[104:107], a[8:11], 0
buffer_load_dwordx4 v175, s[32:35], s71 offen offset:1024 lds
v_mfma_f32_16x16x32_bf16 v[120:123], a[108:111], a[12:15], v[120:123]
buffer_load_dwordx4 v176, s[32:35], s71 offen offset:2048 lds
v_mfma_f32_16x16x32_bf16 v[56:59], a[100:103], a[12:15], 0
buffer_load_dwordx4 v177, s[32:35], s71 offen offset:3072 lds
v_mfma_f32_16x16x32_bf16 v[56:59], a[96:99], a[8:11], v[56:59]
v_mfma_f32_16x16x32_bf16 v[72:75], a[96:99], a[16:19], 0
s_add_u32 m0, s75, 0
v_mfma_f32_16x16x32_bf16 v[72:75], a[100:103], a[20:23], v[72:75]
buffer_load_dwordx4 v232, s[48:51], s10 offen nt lds
v_mfma_f32_16x16x32_bf16 v[136:139], a[108:111], a[20:23], 0
v_mfma_f32_16x16x32_bf16 v[136:139], a[104:107], a[16:19], v[136:139]
s_add_u32 m0, s75, 0
v_mfma_f32_16x16x32_bf16 v[152:155], a[104:107], a[24:27], 0
buffer_load_dwordx4 v233, s[48:51], s10 offen offset:1024 nt lds
v_mfma_f32_16x16x32_bf16 v[152:155], a[108:111], a[28:31], v[152:155]
s_xor_b32 s76, s67, 0
s_add_u32 m0, s69, 0
v_mfma_f32_16x16x32_bf16 v[88:91], a[100:103], a[28:31], 0
buffer_load_dwordx4 v14, s[36:39], s76 offen nt lds
v_mfma_f32_16x16x32_bf16 v[88:91], a[96:99], a[24:27], v[88:91]
s_mov_b64 exec, 0
s_cmp_eq_u32 s60, 0
s_cbranch_scc1 L_hop0_0
s_cmp_eq_u32 s60, 1
s_cbranch_scc1 L_hop0_1
s_cmp_eq_u32 s60, 2
s_cbranch_scc1 L_hop0_2
s_branch L_hop0_3
L_hop_ret0:
s_mov_b64 exec, -1
s_waitcnt vmcnt(15) lgkmcnt(0)
s_barrier
v_mfma_f32_16x16x32_bf16 v[44:47], a[112:115], a[0:3], 0
ds_read_b64_tr_b16 a[64:65], v160 offset:0
v_mfma_f32_16x16x32_bf16 v[44:47], a[116:119], a[4:7], v[44:47]
ds_read_b64_tr_b16 a[66:67], v160 offset:1024
v_mfma_f32_16x16x32_bf16 v[108:111], a[124:127], a[4:7], 0
ds_read_b64_tr_b16 a[68:69], v160 offset:8192
v_mfma_f32_16x16x32_bf16 v[108:111], a[120:123], a[0:3], v[108:111]
ds_read_b64_tr_b16 a[70:71], v160 offset:9216
v_mfma_f32_16x16x32_bf16 v[124:127], a[120:123], a[8:11], 0
ds_read_b128 a[32:35], v170 offset:0
v_mfma_f32_16x16x32_bf16 v[124:127], a[124:127], a[12:15], v[124:127]
ds_read_b128 a[36:39], v171 offset:0
v_mfma_f32_16x16x32_bf16 v[60:63], a[116:119], a[12:15], 0
ds_read_b64_tr_b16 a[72:73], v161 offset:0
v_mfma_f32_16x16x32_bf16 v[60:63], a[112:115], a[8:11], v[60:63]
ds_read_b64_tr_b16 a[74:75], v161 offset:1024
v_mfma_f32_16x16x32_bf16 v[76:79], a[112:115], a[16:19], 0
ds_read_b64_tr_b16 a[76:77], v161 offset:8192
v_mfma_f32_16x16x32_bf16 v[76:79], a[116:119], a[20:23], v[76:79]
ds_read_b64_tr_b16 a[78:79], v161 offset:9216
v_mfma_f32_16x16x32_bf16 v[140:143], a[124:127], a[20:23], 0
ds_read_b128 a[40:43], v170 offset:2048
v_mfma_f32_16x16x32_bf16 v[140:143], a[120:123], a[16:19], v[140:143]
ds_read_b128 a[44:47], v171 offset:2048
v_mfma_f32_16x16x32_bf16 v[156:159], a[120:123], a[24:27], 0
ds_read_b128 a[48:51], v170 offset:4096
v_mfma_f32_16x16x32_bf16 v[156:159], a[124:127], a[28:31], v[156:159]
ds_read_b128 a[52:55], v171 offset:4096
v_mfma_f32_16x16x32_bf16 v[92:95], a[116:119], a[28:31], 0
ds_read_b128 a[56:59], v170 offset:6144
v_mfma_f32_16x16x32_bf16 v[92:95], a[112:115], a[24:27], v[92:95]
s_waitcnt lgkmcnt(9)
ds_read_b128 a[60:63], v171 offset:6144
v_mfma_f32_16x16x32_bf16 v[32:35], a[64:67], a[32:35], v[32:35]
s_lshl_b32 s66, s63, 19
ds_read_b64_tr_b16 a[80:81], v162 offset:0
v_mfma_f32_16x16x32_bf16 v[32:35], a[68:71], a[36:39], v[32:35]
s_waitcnt lgkmcnt(7)
s_add_u32 s66, s66, s65
ds_read_b64_tr_b16 a[82:83], v162 offset:1024
v_mfma_f32_16x16x32_bf16 v[96:99], a[76:79], a[36:39], v[96:99]
s_add_u32 m0, s69, 81920
ds_read_b64_tr_b16 a[84:85], v162 offset:8192
v_mfma_f32_16x16x32_bf16 v[96:99], a[72:75], a[32:35], v[96:99]
s_waitcnt lgkmcnt(7)
buffer_load_dwordx4 v178, s[44:47], s66 offen lds
v_mfma_f32_16x16x32_bf16 v[112:115], a[72:75], a[40:43], v[112:115]
ds_read_b64_tr_b16 a[86:87], v162 offset:9216
v_mfma_f32_16x16x32_bf16 v[112:115], a[76:79], a[44:47], v[112:115]
ds_read_b64_tr_b16 a[88:89], v163 offset:0
v_mfma_f32_16x16x32_bf16 v[48:51], a[68:71], a[44:47], v[48:51]
ds_read_b64_tr_b16 a[90:91], v163 offset:1024
v_mfma_f32_16x16x32_bf16 v[48:51], a[64:67], a[40:43], v[48:51]
s_waitcnt lgkmcnt(8)
buffer_load_dwordx4 v179, s[44:47], s66 offen offset:1024 lds
v_mfma_f32_16x16x32_bf16 v[64:67], a[64:67], a[48:51], v[64:67]
ds_read_b64_tr_b16 a[92:93], v163 offset:8192
v_mfma_f32_16x16x32_bf16 v[64:67], a[68:71], a[52:55], v[64:67]
ds_read_b64_tr_b16 a[94:95], v163 offset:9216
v_mfma_f32_16x16x32_bf16 v[128:131], a[76:79], a[52:55], v[128:131]
ds_read_b64_tr_b16 a[96:97], v164 offset:0
v_mfma_f32_16x16x32_bf16 v[128:131], a[72:75], a[48:51], v[128:131]
s_waitcnt lgkmcnt(9)
buffer_load_dwordx4 v180, s[44:47], s66 offen offset:2048 lds
v_mfma_f32_16x16x32_bf16 v[144:147], a[72:75], a[56:59], v[144:147]
ds_read_b64_tr_b16 a[98:99], v164 offset:1024
v_mfma_f32_16x16x32_bf16 v[144:147], a[76:79], a[60:63], v[144:147]
ds_read_b64_tr_b16 a[100:101], v164 offset:8192
v_mfma_f32_16x16x32_bf16 v[80:83], a[68:71], a[60:63], v[80:83]
ds_read_b64_tr_b16 a[102:103], v164 offset:9216
v_mfma_f32_16x16x32_bf16 v[80:83], a[64:67], a[56:59], v[80:83]
s_waitcnt lgkmcnt(4)
buffer_load_dwordx4 v181, s[44:47], s66 offen offset:3072 lds
v_mfma_f32_16x16x32_bf16 v[36:39], a[80:83], a[32:35], v[36:39]
s_lshl_b32 s70, s63, 7
ds_read_b64_tr_b16 a[104:105], v165 offset:0
v_mfma_f32_16x16x32_bf16 v[36:39], a[84:87], a[36:39], v[36:39]
s_add_u32 s70, s70, s64
ds_read_b64_tr_b16 a[106:107], v165 offset:1024
v_mfma_f32_16x16x32_bf16 v[100:103], a[92:95], a[36:39], v[100:103]
s_add_u32 m0, s68, 131072
ds_read_b64_tr_b16 a[108:109], v165 offset:8192
v_mfma_f32_16x16x32_bf16 v[100:103], a[88:91], a[32:35], v[100:103]
buffer_load_dwordx4 v174, s[32:35], s70 offen lds
v_mfma_f32_16x16x32_bf16 v[116:119], a[88:91], a[40:43], v[116:119]
ds_read_b64_tr_b16 a[110:111], v165 offset:9216
v_mfma_f32_16x16x32_bf16 v[116:119], a[92:95], a[44:47], v[116:119]
ds_read_b64_tr_b16 a[112:113], v166 offset:0
v_mfma_f32_16x16x32_bf16 v[52:55], a[84:87], a[44:47], v[52:55]
ds_read_b64_tr_b16 a[114:115], v166 offset:1024
v_mfma_f32_16x16x32_bf16 v[52:55], a[80:83], a[40:43], v[52:55]
buffer_load_dwordx4 v175, s[32:35], s70 offen offset:1024 lds
v_mfma_f32_16x16x32_bf16 v[68:71], a[80:83], a[48:51], v[68:71]
ds_read_b64_tr_b16 a[116:117], v166 offset:8192
v_mfma_f32_16x16x32_bf16 v[68:71], a[84:87], a[52:55], v[68:71]
ds_read_b64_tr_b16 a[118:119], v166 offset:9216
v_mfma_f32_16x16x32_bf16 v[132:135], a[92:95], a[52:55], v[132:135]
ds_read_b64_tr_b16 a[120:121], v167 offset:0
v_mfma_f32_16x16x32_bf16 v[132:135], a[88:91], a[48:51], v[132:135]
buffer_load_dwordx4 v176, s[32:35], s70 offen offset:2048 lds
v_mfma_f32_16x16x32_bf16 v[148:151], a[88:91], a[56:59], v[148:151]
ds_read_b64_tr_b16 a[122:123], v167 offset:1024
v_mfma_f32_16x16x32_bf16 v[148:151], a[92:95], a[60:63], v[148:151]
ds_read_b64_tr_b16 a[124:125], v167 offset:8192
v_mfma_f32_16x16x32_bf16 v[84:87], a[84:87], a[60:63], v[84:87]
ds_read_b64_tr_b16 a[126:127], v167 offset:9216
v_mfma_f32_16x16x32_bf16 v[84:87], a[80:83], a[56:59], v[84:87]
s_waitcnt lgkmcnt(8)
buffer_load_dwordx4 v177, s[32:35], s70 offen offset:3072 lds
v_mfma_f32_16x16x32_bf16 v[40:43], a[96:99], a[32:35], v[40:43]
s_add_u32 s71, s70, s79
v_mfma_f32_16x16x32_bf16 v[40:43], a[100:103], a[36:39], v[40:43]
s_add_u32 m0, s68, 135168
s_add_u32 s63, s63, 1
v_mfma_f32_16x16x32_bf16 v[104:107], a[108:111], a[36:39], v[104:107]
buffer_load_dwordx4 v174, s[32:35], s71 offen lds
v_mfma_f32_16x16x32_bf16 v[104:107], a[104:107], a[32:35], v[104:107]
s_cmp_eq_u32 s63, 10
s_cselect_b32 s63, 0, s63
v_mfma_f32_16x16x32_bf16 v[120:123], a[104:107], a[40:43], v[120:123]
buffer_load_dwordx4 v175, s[32:35], s71 offen offset:1024 lds
v_mfma_f32_16x16x32_bf16 v[120:123], a[108:111], a[44:47], v[120:123]
buffer_load_dwordx4 v176, s[32:35], s71 offen offset:2048 lds
v_mfma_f32_16x16x32_bf16 v[56:59], a[100:103], a[44:47], v[56:59]
buffer_load_dwordx4 v177, s[32:35], s71 offen offset:3072 lds
v_mfma_f32_16x16x32_bf16 v[56:59], a[96:99], a[40:43], v[56:59]
v_mfma_f32_16x16x32_bf16 v[72:75], a[96:99], a[48:51], v[72:75]
s_add_u32 m0, s75, 0
v_mfma_f32_16x16x32_bf16 v[72:75], a[100:103], a[52:55], v[72:75]
buffer_load_dwordx4 v234, s[48:51], s10 offen offset:2048 nt lds
v_mfma_f32_16x16x32_bf16 v[136:139], a[108:111], a[52:55], v[136:139]
v_mfma_f32_16x16x32_bf16 v[136:139], a[104:107], a[48:51], v[136:139]
s_add_u32 m0, s75, 0
v_mfma_f32_16x16x32_bf16 v[152:155], a[104:107], a[56:59], v[152:155]
buffer_load_dwordx4 v235, s[48:51], s10 offen offset:3072 nt lds
v_mfma_f32_16x16x32_bf16 v[152:155], a[108:111], a[60:63], v[152:155]
s_xor_b32 s76, s67, 0
s_add_u32 m0, s69, 0
v_mfma_f32_16x16x32_bf16 v[88:91], a[100:103], a[60:63], v[88:91]
buffer_load_dwordx4 v15, s[36:39], s76 offen offset:1024 nt lds
v_mfma_f32_16x16x32_bf16 v[88:91], a[96:99], a[56:59], v[88:91]
s_mov_b64 exec, 0
s_cmp_eq_u32 s60, 0
s_cbranch_scc1 L_hop1_0
s_cmp_eq_u32 s60, 1
s_cbranch_scc1 L_hop1_1
s_cmp_eq_u32 s60, 2
s_cbranch_scc1 L_hop1_2
s_branch L_hop1_3
L_hop_ret1:
s_mov_b64 exec, -1
s_waitcnt vmcnt(18) lgkmcnt(0)
s_barrier
v_mfma_f32_16x16x32_bf16 v[44:47], a[112:115], a[32:35], v[44:47]
ds_read_b64_tr_b16 a[64:65], v160 offset:16384
v_mfma_f32_16x16x32_bf16 v[44:47], a[116:119], a[36:39], v[44:47]
ds_read_b64_tr_b16 a[66:67], v160 offset:17408
v_mfma_f32_16x16x32_bf16 v[108:111], a[124:127], a[36:39], v[108:111]
ds_read_b64_tr_b16 a[68:69], v160 offset:24576
v_mfma_f32_16x16x32_bf16 v[108:111], a[120:123], a[32:35], v[108:111]
ds_read_b64_tr_b16 a[70:71], v160 offset:25600
v_mfma_f32_16x16x32_bf16 v[124:127], a[120:123], a[40:43], v[124:127]
ds_read_b128 a[0:3], v168 offset:0
v_mfma_f32_16x16x32_bf16 v[124:127], a[124:127], a[44:47], v[124:127]
ds_read_b128 a[4:7], v169 offset:0
v_mfma_f32_16x16x32_bf16 v[60:63], a[116:119], a[44:47], v[60:63]
ds_read_b64_tr_b16 a[72:73], v161 offset:16384
v_mfma_f32_16x16x32_bf16 v[60:63], a[112:115], a[40:43], v[60:63]
ds_read_b64_tr_b16 a[74:75], v161 offset:17408
v_mfma_f32_16x16x32_bf16 v[76:79], a[112:115], a[48:51], v[76:79]
ds_read_b64_tr_b16 a[76:77], v161 offset:24576
v_mfma_f32_16x16x32_bf16 v[76:79], a[116:119], a[52:55], v[76:79]
ds_read_b64_tr_b16 a[78:79], v161 offset:25600
v_mfma_f32_16x16x32_bf16 v[140:143], a[124:127], a[52:55], v[140:143]
ds_read_b128 a[8:11], v168 offset:2048
v_mfma_f32_16x16x32_bf16 v[140:143], a[120:123], a[48:51], v[140:143]
ds_read_b128 a[12:15], v169 offset:2048
v_mfma_f32_16x16x32_bf16 v[156:159], a[120:123], a[56:59], v[156:159]
ds_read_b128 a[16:19], v168 offset:4096
v_mfma_f32_16x16x32_bf16 v[156:159], a[124:127], a[60:63], v[156:159]
ds_read_b128 a[20:23], v169 offset:4096
v_mfma_f32_16x16x32_bf16 v[92:95], a[116:119], a[60:63], v[92:95]
ds_read_b128 a[24:27], v168 offset:6144
v_mfma_f32_16x16x32_bf16 v[92:95], a[112:115], a[56:59], v[92:95]
s_waitcnt lgkmcnt(9)
ds_read_b128 a[28:31], v169 offset:6144
v_mfma_f32_16x16x32_bf16 v[32:35], a[64:67], a[0:3], v[32:35]
s_lshl_b32 s66, s63, 19
ds_read_b64_tr_b16 a[80:81], v162 offset:16384
v_mfma_f32_16x16x32_bf16 v[32:35], a[68:71], a[4:7], v[32:35]
s_waitcnt lgkmcnt(7)
s_add_u32 s66, s66, s65
ds_read_b64_tr_b16 a[82:83], v162 offset:17408
v_mfma_f32_16x16x32_bf16 v[96:99], a[76:79], a[4:7], v[96:99]
s_add_u32 m0, s69, 32768
ds_read_b64_tr_b16 a[84:85], v162 offset:24576
v_mfma_f32_16x16x32_bf16 v[96:99], a[72:75], a[0:3], v[96:99]
s_waitcnt lgkmcnt(7)
buffer_load_dwordx4 v178, s[44:47], s66 offen lds
v_mfma_f32_16x16x32_bf16 v[112:115], a[72:75], a[8:11], v[112:115]
ds_read_b64_tr_b16 a[86:87], v162 offset:25600
v_mfma_f32_16x16x32_bf16 v[112:115], a[76:79], a[12:15], v[112:115]
ds_read_b64_tr_b16 a[88:89], v163 offset:16384
v_mfma_f32_16x16x32_bf16 v[48:51], a[68:71], a[12:15], v[48:51]
ds_read_b64_tr_b16 a[90:91], v163 offset:17408
v_mfma_f32_16x16x32_bf16 v[48:51], a[64:67], a[8:11], v[48:51]
s_waitcnt lgkmcnt(8)
buffer_load_dwordx4 v179, s[44:47], s66 offen offset:1024 lds
v_mfma_f32_16x16x32_bf16 v[64:67], a[64:67], a[16:19], v[64:67]
ds_read_b64_tr_b16 a[92:93], v163 offset:24576
v_mfma_f32_16x16x32_bf16 v[64:67], a[68:71], a[20:23], v[64:67]
ds_read_b64_tr_b16 a[94:95], v163 offset:25600
v_mfma_f32_16x16x32_bf16 v[128:131], a[76:79], a[20:23], v[128:131]
ds_read_b64_tr_b16 a[96:97], v164 offset:16384
v_mfma_f32_16x16x32_bf16 v[128:131], a[72:75], a[16:19], v[128:131]
s_waitcnt lgkmcnt(9)
buffer_load_dwordx4 v180, s[44:47], s66 offen offset:2048 lds
v_mfma_f32_16x16x32_bf16 v[144:147], a[72:75], a[24:27], v[144:147]
ds_read_b64_tr_b16 a[98:99], v164 offset:17408
v_mfma_f32_16x16x32_bf16 v[144:147], a[76:79], a[28:31], v[144:147]
ds_read_b64_tr_b16 a[100:101], v164 offset:24576
v_mfma_f32_16x16x32_bf16 v[80:83], a[68:71], a[28:31], v[80:83]
ds_read_b64_tr_b16 a[102:103], v164 offset:25600
v_mfma_f32_16x16x32_bf16 v[80:83], a[64:67], a[24:27], v[80:83]
s_waitcnt lgkmcnt(4)
buffer_load_dwordx4 v181, s[44:47], s66 offen offset:3072 lds
v_mfma_f32_16x16x32_bf16 v[36:39], a[80:83], a[0:3], v[36:39]
s_lshl_b32 s70, s63, 7
ds_read_b64_tr_b16 a[104:105], v165 offset:16384
v_mfma_f32_16x16x32_bf16 v[36:39], a[84:87], a[4:7], v[36:39]
s_add_u32 s70, s70, s64
ds_read_b64_tr_b16 a[106:107], v165 offset:17408
v_mfma_f32_16x16x32_bf16 v[100:103], a[92:95], a[4:7], v[100:103]
s_add_u32 m0, s68, 98304
ds_read_b64_tr_b16 a[108:109], v165 offset:24576
v_mfma_f32_16x16x32_bf16 v[100:103], a[88:91], a[0:3], v[100:103]
buffer_load_dwordx4 v174, s[32:35], s70 offen lds
v_mfma_f32_16x16x32_bf16 v[116:119], a[88:91], a[8:11], v[116:119]
ds_read_b64_tr_b16 a[110:111], v165 offset:25600
v_mfma_f32_16x16x32_bf16 v[116:119], a[92:95], a[12:15], v[116:119]
ds_read_b64_tr_b16 a[112:113], v166 offset:16384
v_mfma_f32_16x16x32_bf16 v[52:55], a[84:87], a[12:15], v[52:55]
ds_read_b64_tr_b16 a[114:115], v166 offset:17408
v_mfma_f32_16x16x32_bf16 v[52:55], a[80:83], a[8:11], v[52:55]
buffer_load_dwordx4 v175, s[32:35], s70 offen offset:1024 lds
v_mfma_f32_16x16x32_bf16 v[68:71], a[80:83], a[16:19], v[68:71]
ds_read_b64_tr_b16 a[116:117], v166 offset:24576
v_mfma_f32_16x16x32_bf16 v[68:71], a[84:87], a[20:23], v[68:71]
ds_read_b64_tr_b16 a[118:119], v166 offset:25600
v_mfma_f32_16x16x32_bf16 v[132:135], a[92:95], a[20:23], v[132:135]
ds_read_b64_tr_b16 a[120:121], v167 offset:16384
v_mfma_f32_16x16x32_bf16 v[132:135], a[88:91], a[16:19], v[132:135]
buffer_load_dwordx4 v176, s[32:35], s70 offen offset:2048 lds
v_mfma_f32_16x16x32_bf16 v[148:151], a[88:91], a[24:27], v[148:151]
ds_read_b64_tr_b16 a[122:123], v167 offset:17408
v_mfma_f32_16x16x32_bf16 v[148:151], a[92:95], a[28:31], v[148:151]
ds_read_b64_tr_b16 a[124:125], v167 offset:24576
v_mfma_f32_16x16x32_bf16 v[84:87], a[84:87], a[28:31], v[84:87]
ds_read_b64_tr_b16 a[126:127], v167 offset:25600
v_mfma_f32_16x16x32_bf16 v[84:87], a[80:83], a[24:27], v[84:87]
s_waitcnt lgkmcnt(8)
buffer_load_dwordx4 v177, s[32:35], s70 offen offset:3072 lds
v_mfma_f32_16x16x32_bf16 v[40:43], a[96:99], a[0:3], v[40:43]
s_add_u32 s71, s70, s79
v_mfma_f32_16x16x32_bf16 v[40:43], a[100:103], a[4:7], v[40:43]
s_add_u32 m0, s68, 102400
s_add_u32 s63, s63, 1
v_mfma_f32_16x16x32_bf16 v[104:107], a[108:111], a[4:7], v[104:107]
buffer_load_dwordx4 v174, s[32:35], s71 offen lds
v_mfma_f32_16x16x32_bf16 v[104:107], a[104:107], a[0:3], v[104:107]
s_cmp_eq_u32 s63, 10
s_cselect_b32 s63, 0, s63
v_mfma_f32_16x16x32_bf16 v[120:123], a[104:107], a[8:11], v[120:123]
buffer_load_dwordx4 v175, s[32:35], s71 offen offset:1024 lds
v_mfma_f32_16x16x32_bf16 v[120:123], a[108:111], a[12:15], v[120:123]
buffer_load_dwordx4 v176, s[32:35], s71 offen offset:2048 lds
v_mfma_f32_16x16x32_bf16 v[56:59], a[100:103], a[12:15], v[56:59]
buffer_load_dwordx4 v177, s[32:35], s71 offen offset:3072 lds
v_mfma_f32_16x16x32_bf16 v[56:59], a[96:99], a[8:11], v[56:59]
v_mfma_f32_16x16x32_bf16 v[72:75], a[96:99], a[16:19], v[72:75]
s_add_u32 m0, s75, 4096
v_mfma_f32_16x16x32_bf16 v[72:75], a[100:103], a[20:23], v[72:75]
buffer_load_dwordx4 v236, s[48:51], s10 offen nt lds
v_mfma_f32_16x16x32_bf16 v[136:139], a[108:111], a[20:23], v[136:139]
s_xor_b32 s76, s67, 0
v_mfma_f32_16x16x32_bf16 v[136:139], a[104:107], a[16:19], v[136:139]
s_add_u32 m0, s69, 0
v_mfma_f32_16x16x32_bf16 v[152:155], a[104:107], a[24:27], v[152:155]
buffer_load_dwordx4 v16, s[36:39], s76 offen offset:2048 nt lds
v_mfma_f32_16x16x32_bf16 v[152:155], a[108:111], a[28:31], v[152:155]
v_mfma_f32_16x16x32_bf16 v[88:91], a[100:103], a[28:31], v[88:91]
buffer_load_dwordx4 v17, s[36:39], s76 offen offset:3072 nt lds
v_mfma_f32_16x16x32_bf16 v[88:91], a[96:99], a[24:27], v[88:91]
s_mov_b64 exec, 0
s_cmp_eq_u32 s60, 0
s_cbranch_scc1 L_hop2_0
s_cmp_eq_u32 s60, 1
s_cbranch_scc1 L_hop2_1
s_cmp_eq_u32 s60, 2
s_cbranch_scc1 L_hop2_2
s_branch L_hop2_3
L_hop_ret2:
s_mov_b64 exec, -1
s_waitcnt vmcnt(18) lgkmcnt(0)
s_barrier
v_mfma_f32_16x16x32_bf16 v[44:47], a[112:115], a[0:3], v[44:47]
ds_read_b64_tr_b16 a[64:65], v160 offset:49152
v_mfma_f32_16x16x32_bf16 v[44:47], a[116:119], a[4:7], v[44:47]
ds_read_b64_tr_b16 a[66:67], v160 offset:50176
v_mfma_f32_16x16x32_bf16 v[108:111], a[124:127], a[4:7], v[108:111]
ds_read_b64_tr_b16 a[68:69], v160 offset:57344
v_mfma_f32_16x16x32_bf16 v[108:111], a[120:123], a[0:3], v[108:111]
ds_read_b64_tr_b16 a[70:71], v160 offset:58368
v_mfma_f32_16x16x32_bf16 v[124:127], a[120:123], a[8:11], v[124:127]
ds_read_b128 a[32:35], v170 offset:0
v_mfma_f32_16x16x32_bf16 v[124:127], a[124:127], a[12:15], v[124:127]
ds_read_b128 a[36:39], v171 offset:0
v_mfma_f32_16x16x32_bf16 v[60:63], a[116:119], a[12:15], v[60:63]
ds_read_b64_tr_b16 a[72:73], v161 offset:49152
v_mfma_f32_16x16x32_bf16 v[60:63], a[112:115], a[8:11], v[60:63]
ds_read_b64_tr_b16 a[74:75], v161 offset:50176
v_mfma_f32_16x16x32_bf16 v[76:79], a[112:115], a[16:19], v[76:79]
ds_read_b64_tr_b16 a[76:77], v161 offset:57344
v_mfma_f32_16x16x32_bf16 v[76:79], a[116:119], a[20:23], v[76:79]
ds_read_b64_tr_b16 a[78:79], v161 offset:58368
v_mfma_f32_16x16x32_bf16 v[140:143], a[124:127], a[20:23], v[140:143]
ds_read_b128 a[40:43], v170 offset:2048
v_mfma_f32_16x16x32_bf16 v[140:143], a[120:123], a[16:19], v[140:143]
ds_read_b128 a[44:47], v171 offset:2048
v_mfma_f32_16x16x32_bf16 v[156:159], a[120:123], a[24:27], v[156:159]
ds_read_b128 a[48:51], v170 offset:4096
v_mfma_f32_16x16x32_bf16 v[156:159], a[124:127], a[28:31], v[156:159]
ds_read_b128 a[52:55], v171 offset:4096
v_mfma_f32_16x16x32_bf16 v[92:95], a[116:119], a[28:31], v[92:95]
ds_read_b128 a[56:59], v170 offset:6144
v_mfma_f32_16x16x32_bf16 v[92:95], a[112:115], a[24:27], v[92:95]
s_waitcnt lgkmcnt(9)
ds_read_b128 a[60:63], v171 offset:6144
v_mfma_f32_16x16x32_bf16 v[32:35], a[64:67], a[32:35], v[32:35]
s_lshl_b32 s66, s63, 19
ds_read_b64_tr_b16 a[80:81], v162 offset:49152
v_mfma_f32_16x16x32_bf16 v[32:35], a[68:71], a[36:39], v[32:35]
s_waitcnt lgkmcnt(7)
s_add_u32 s66, s66, s65
ds_read_b64_tr_b16 a[82:83], v162 offset:50176
v_mfma_f32_16x16x32_bf16 v[96:99], a[76:79], a[36:39], v[96:99]
s_add_u32 m0, s69, 49152
ds_read_b64_tr_b16 a[84:85], v162 offset:57344
v_mfma_f32_16x16x32_bf16 v[96:99], a[72:75], a[32:35], v[96:99]
s_waitcnt lgkmcnt(7)
buffer_load_dwordx4 v178, s[44:47], s66 offen lds
v_mfma_f32_16x16x32_bf16 v[112:115], a[72:75], a[40:43], v[112:115]
ds_read_b64_tr_b16 a[86:87], v162 offset:58368
v_mfma_f32_16x16x32_bf16 v[112:115], a[76:79], a[44:47], v[112:115]
ds_read_b64_tr_b16 a[88:89], v163 offset:49152
v_mfma_f32_16x16x32_bf16 v[48:51], a[68:71], a[44:47], v[48:51]
ds_read_b64_tr_b16 a[90:91], v163 offset:50176
v_mfma_f32_16x16x32_bf16 v[48:51], a[64:67], a[40:43], v[48:51]
s_waitcnt lgkmcnt(8)
buffer_load_dwordx4 v179, s[44:47], s66 offen offset:1024 lds
v_mfma_f32_16x16x32_bf16 v[64:67], a[64:67], a[48:51], v[64:67]
ds_read_b64_tr_b16 a[92:93], v163 offset:57344
v_mfma_f32_16x16x32_bf16 v[64:67], a[68:71], a[52:55], v[64:67]
ds_read_b64_tr_b16 a[94:95], v163 offset:58368
v_mfma_f32_16x16x32_bf16 v[128:131], a[76:79], a[52:55], v[128:131]
ds_read_b64_tr_b16 a[96:97], v164 offset:49152
v_mfma_f32_16x16x32_bf16 v[128:131], a[72:75], a[48:51], v[128:131]
s_waitcnt lgkmcnt(9)
buffer_load_dwordx4 v180, s[44:47], s66 offen offset:2048 lds
v_mfma_f32_16x16x32_bf16 v[144:147], a[72:75], a[56:59], v[144:147]
ds_read_b64_tr_b16 a[98:99], v164 offset:50176
v_mfma_f32_16x16x32_bf16 v[144:147], a[76:79], a[60:63], v[144:147]
ds_read_b64_tr_b16 a[100:101], v164 offset:57344
v_mfma_f32_16x16x32_bf16 v[80:83], a[68:71], a[60:63], v[80:83]
ds_read_b64_tr_b16 a[102:103], v164 offset:58368
v_mfma_f32_16x16x32_bf16 v[80:83], a[64:67], a[56:59], v[80:83]
s_waitcnt lgkmcnt(4)
buffer_load_dwordx4 v181, s[44:47], s66 offen offset:3072 lds
v_mfma_f32_16x16x32_bf16 v[36:39], a[80:83], a[32:35], v[36:39]
s_lshl_b32 s70, s63, 7
ds_read_b64_tr_b16 a[104:105], v165 offset:49152
v_mfma_f32_16x16x32_bf16 v[36:39], a[84:87], a[36:39], v[36:39]
s_add_u32 s70, s70, s64
ds_read_b64_tr_b16 a[106:107], v165 offset:50176
v_mfma_f32_16x16x32_bf16 v[100:103], a[92:95], a[36:39], v[100:103]
s_add_u32 m0, s68, 131072
ds_read_b64_tr_b16 a[108:109], v165 offset:57344
v_mfma_f32_16x16x32_bf16 v[100:103], a[88:91], a[32:35], v[100:103]
buffer_load_dwordx4 v174, s[32:35], s70 offen lds
v_mfma_f32_16x16x32_bf16 v[116:119], a[88:91], a[40:43], v[116:119]
ds_read_b64_tr_b16 a[110:111], v165 offset:58368
v_mfma_f32_16x16x32_bf16 v[116:119], a[92:95], a[44:47], v[116:119]
ds_read_b64_tr_b16 a[112:113], v166 offset:49152
v_mfma_f32_16x16x32_bf16 v[52:55], a[84:87], a[44:47], v[52:55]
ds_read_b64_tr_b16 a[114:115], v166 offset:50176
v_mfma_f32_16x16x32_bf16 v[52:55], a[80:83], a[40:43], v[52:55]
buffer_load_dwordx4 v175, s[32:35], s70 offen offset:1024 lds
v_mfma_f32_16x16x32_bf16 v[68:71], a[80:83], a[48:51], v[68:71]
ds_read_b64_tr_b16 a[116:117], v166 offset:57344
v_mfma_f32_16x16x32_bf16 v[68:71], a[84:87], a[52:55], v[68:71]
ds_read_b64_tr_b16 a[118:119], v166 offset:58368
v_mfma_f32_16x16x32_bf16 v[132:135], a[92:95], a[52:55], v[132:135]
ds_read_b64_tr_b16 a[120:121], v167 offset:49152
v_mfma_f32_16x16x32_bf16 v[132:135], a[88:91], a[48:51], v[132:135]
buffer_load_dwordx4 v176, s[32:35], s70 offen offset:2048 lds
v_mfma_f32_16x16x32_bf16 v[148:151], a[88:91], a[56:59], v[148:151]
ds_read_b64_tr_b16 a[122:123], v167 offset:50176
v_mfma_f32_16x16x32_bf16 v[148:151], a[92:95], a[60:63], v[148:151]
ds_read_b64_tr_b16 a[124:125], v167 offset:57344
v_mfma_f32_16x16x32_bf16 v[84:87], a[84:87], a[60:63], v[84:87]
ds_read_b64_tr_b16 a[126:127], v167 offset:58368
v_mfma_f32_16x16x32_bf16 v[84:87], a[80:83], a[56:59], v[84:87]
s_waitcnt lgkmcnt(8)
buffer_load_dwordx4 v177, s[32:35], s70 offen offset:3072 lds
v_mfma_f32_16x16x32_bf16 v[40:43], a[96:99], a[32:35], v[40:43]
s_add_u32 s71, s70, s79
v_mfma_f32_16x16x32_bf16 v[40:43], a[100:103], a[36:39], v[40:43]
s_add_u32 m0, s68, 135168
v_mfma_f32_16x16x32_bf16 v[104:107], a[108:111], a[36:39], v[104:107]
s_add_u32 s63, s63, 1
v_mfma_f32_16x16x32_bf16 v[104:107], a[104:107], a[32:35], v[104:107]
buffer_load_dwordx4 v174, s[32:35], s71 offen lds
v_mfma_f32_16x16x32_bf16 v[120:123], a[104:107], a[40:43], v[120:123]
v_mfma_f32_16x16x32_bf16 v[120:123], a[108:111], a[44:47], v[120:123]
v_mfma_f32_16x16x32_bf16 v[56:59], a[100:103], a[44:47], v[56:59]
s_cmp_eq_u32 s63, 10
s_cselect_b32 s63, 0, s63
v_mfma_f32_16x16x32_bf16 v[56:59], a[96:99], a[40:43], v[56:59]
buffer_load_dwordx4 v175, s[32:35], s71 offen offset:1024 lds
L_hop0_0:
s_cbranch_execz L_hop_ret0
v_mfma_f32_16x16x32_bf16 v[72:75], a[96:99], a[48:51], v[72:75]
v_mfma_f32_16x16x32_bf16 v[72:75], a[100:103], a[52:55], v[72:75]
v_mfma_f32_16x16x32_bf16 v[136:139], a[108:111], a[52:55], v[136:139]
v_mfma_f32_16x16x32_bf16 v[136:139], a[104:107], a[48:51], v[136:139]
buffer_load_dwordx4 v176, s[32:35], s71 offen offset:2048 lds
v_mfma_f32_16x16x32_bf16 v[152:155], a[104:107], a[56:59], v[152:155]
v_mfma_f32_16x16x32_bf16 v[152:155], a[108:111], a[60:63], v[152:155]
v_mfma_f32_16x16x32_bf16 v[88:91], a[100:103], a[60:63], v[88:91]
buffer_load_dwordx4 v177, s[32:35], s71 offen offset:3072 lds
v_mfma_f32_16x16x32_bf16 v[88:91], a[96:99], a[56:59], v[88:91]
s_waitcnt vmcnt(15) lgkmcnt(0)
s_barrier
v_mfma_f32_16x16x32_bf16 v[44:47], a[112:115], a[32:35], v[44:47]
ds_read_b64_tr_b16 a[64:65], v160 offset:0
v_mfma_f32_16x16x32_bf16 v[44:47], a[116:119], a[36:39], v[44:47]
ds_read_b64_tr_b16 a[66:67], v160 offset:1024
v_mfma_f32_16x16x32_bf16 v[108:111], a[124:127], a[36:39], v[108:111]
ds_read_b64_tr_b16 a[68:69], v160 offset:8192
v_mfma_f32_16x16x32_bf16 v[108:111], a[120:123], a[32:35], v[108:111]
ds_read_b64_tr_b16 a[70:71], v160 offset:9216
v_mfma_f32_16x16x32_bf16 v[124:127], a[120:123], a[40:43], v[124:127]
ds_read_b128 a[0:3], v168 offset:0
v_mfma_f32_16x16x32_bf16 v[124:127], a[124:127], a[44:47], v[124:127]
ds_read_b128 a[4:7], v169 offset:0
v_mfma_f32_16x16x32_bf16 v[60:63], a[116:119], a[44:47], v[60:63]
ds_read_b64_tr_b16 a[72:73], v161 offset:0
v_mfma_f32_16x16x32_bf16 v[60:63], a[112:115], a[40:43], v[60:63]
ds_read_b64_tr_b16 a[74:75], v161 offset:1024
v_mfma_f32_16x16x32_bf16 v[76:79], a[112:115], a[48:51], v[76:79]
ds_read_b64_tr_b16 a[76:77], v161 offset:8192
v_mfma_f32_16x16x32_bf16 v[76:79], a[116:119], a[52:55], v[76:79]
ds_read_b64_tr_b16 a[78:79], v161 offset:9216
v_mfma_f32_16x16x32_bf16 v[140:143], a[124:127], a[52:55], v[140:143]
ds_read_b128 a[8:11], v168 offset:2048
v_mfma_f32_16x16x32_bf16 v[140:143], a[120:123], a[48:51], v[140:143]
ds_read_b128 a[12:15], v169 offset:2048
v_mfma_f32_16x16x32_bf16 v[156:159], a[120:123], a[56:59], v[156:159]
ds_read_b128 a[16:19], v168 offset:4096
v_mfma_f32_16x16x32_bf16 v[156:159], a[124:127], a[60:63], v[156:159]
ds_read_b128 a[20:23], v169 offset:4096
v_mfma_f32_16x16x32_bf16 v[92:95], a[116:119], a[60:63], v[92:95]
ds_read_b128 a[24:27], v168 offset:6144
v_mfma_f32_16x16x32_bf16 v[92:95], a[112:115], a[56:59], v[92:95]
s_waitcnt lgkmcnt(9)
ds_read_b128 a[28:31], v169 offset:6144
v_mfma_f32_16x16x32_bf16 v[32:35], a[64:67], a[0:3], v[32:35]
s_lshl_b32 s66, s63, 19
ds_read_b64_tr_b16 a[80:81], v162 offset:0
v_mfma_f32_16x16x32_bf16 v[32:35], a[68:71], a[4:7], v[32:35]
s_waitcnt lgkmcnt(7)
s_add_u32 s66, s66, s65
ds_read_b64_tr_b16 a[82:83], v162 offset:1024
v_mfma_f32_16x16x32_bf16 v[96:99], a[76:79], a[4:7], v[96:99]
s_add_u32 m0, s69, 81920
ds_read_b64_tr_b16 a[84:85], v162 offset:8192
v_mfma_f32_16x16x32_bf16 v[96:99], a[72:75], a[0:3], v[96:99]
s_waitcnt lgkmcnt(7)
buffer_load_dwordx4 v178, s[44:47], s66 offen lds
v_mfma_f32_16x16x32_bf16 v[112:115], a[72:75], a[8:11], v[112:115]
ds_read_b64_tr_b16 a[86:87], v162 offset:9216
v_mfma_f32_16x16x32_bf16 v[112:115], a[76:79], a[12:15], v[112:115]
ds_read_b64_tr_b16 a[88:89], v163 offset:0
v_mfma_f32_16x16x32_bf16 v[48:51], a[68:71], a[12:15], v[48:51]
ds_read_b64_tr_b16 a[90:91], v163 offset:1024
v_mfma_f32_16x16x32_bf16 v[48:51], a[64:67], a[8:11], v[48:51]
s_waitcnt lgkmcnt(8)
buffer_load_dwordx4 v179, s[44:47], s66 offen offset:1024 lds
v_mfma_f32_16x16x32_bf16 v[64:67], a[64:67], a[16:19], v[64:67]
ds_read_b64_tr_b16 a[92:93], v163 offset:8192
v_mfma_f32_16x16x32_bf16 v[64:67], a[68:71], a[20:23], v[64:67]
ds_read_b64_tr_b16 a[94:95], v163 offset:9216
v_mfma_f32_16x16x32_bf16 v[128:131], a[76:79], a[20:23], v[128:131]
ds_read_b64_tr_b16 a[96:97], v164 offset:0
v_mfma_f32_16x16x32_bf16 v[128:131], a[72:75], a[16:19], v[128:131]
s_waitcnt lgkmcnt(9)
buffer_load_dwordx4 v180, s[44:47], s66 offen offset:2048 lds
v_mfma_f32_16x16x32_bf16 v[144:147], a[72:75], a[24:27], v[144:147]
ds_read_b64_tr_b16 a[98:99], v164 offset:1024
v_mfma_f32_16x16x32_bf16 v[144:147], a[76:79], a[28:31], v[144:147]
ds_read_b64_tr_b16 a[100:101], v164 offset:8192
v_mfma_f32_16x16x32_bf16 v[80:83], a[68:71], a[28:31], v[80:83]
ds_read_b64_tr_b16 a[102:103], v164 offset:9216
v_mfma_f32_16x16x32_bf16 v[80:83], a[64:67], a[24:27], v[80:83]
s_waitcnt lgkmcnt(4)
buffer_load_dwordx4 v181, s[44:47], s66 offen offset:3072 lds
v_mfma_f32_16x16x32_bf16 v[36:39], a[80:83], a[0:3], v[36:39]
s_lshl_b32 s70, s63, 7
ds_read_b64_tr_b16 a[104:105], v165 offset:0
v_mfma_f32_16x16x32_bf16 v[36:39], a[84:87], a[4:7], v[36:39]
s_add_u32 s70, s70, s64
ds_read_b64_tr_b16 a[106:107], v165 offset:1024
v_mfma_f32_16x16x32_bf16 v[100:103], a[92:95], a[4:7], v[100:103]
s_add_u32 m0, s68, 98304
ds_read_b64_tr_b16 a[108:109], v165 offset:8192
v_mfma_f32_16x16x32_bf16 v[100:103], a[88:91], a[0:3], v[100:103]
buffer_load_dwordx4 v174, s[32:35], s70 offen lds
v_mfma_f32_16x16x32_bf16 v[116:119], a[88:91], a[8:11], v[116:119]
ds_read_b64_tr_b16 a[110:111], v165 offset:9216
v_mfma_f32_16x16x32_bf16 v[116:119], a[92:95], a[12:15], v[116:119]
ds_read_b64_tr_b16 a[112:113], v166 offset:0
v_mfma_f32_16x16x32_bf16 v[52:55], a[84:87], a[12:15], v[52:55]
ds_read_b64_tr_b16 a[114:115], v166 offset:1024
v_mfma_f32_16x16x32_bf16 v[52:55], a[80:83], a[8:11], v[52:55]
buffer_load_dwordx4 v175, s[32:35], s70 offen offset:1024 lds
v_mfma_f32_16x16x32_bf16 v[68:71], a[80:83], a[16:19], v[68:71]
ds_read_b64_tr_b16 a[116:117], v166 offset:8192
v_mfma_f32_16x16x32_bf16 v[68:71], a[84:87], a[20:23], v[68:71]
ds_read_b64_tr_b16 a[118:119], v166 offset:9216
v_mfma_f32_16x16x32_bf16 v[132:135], a[92:95], a[20:23], v[132:135]
ds_read_b64_tr_b16 a[120:121], v167 offset:0
v_mfma_f32_16x16x32_bf16 v[132:135], a[88:91], a[16:19], v[132:135]
buffer_load_dwordx4 v176, s[32:35], s70 offen offset:2048 lds
v_mfma_f32_16x16x32_bf16 v[148:151], a[88:91], a[24:27], v[148:151]
ds_read_b64_tr_b16 a[122:123], v167 offset:1024
v_mfma_f32_16x16x32_bf16 v[148:151], a[92:95], a[28:31], v[148:151]
ds_read_b64_tr_b16 a[124:125], v167 offset:8192
v_mfma_f32_16x16x32_bf16 v[84:87], a[84:87], a[28:31], v[84:87]
ds_read_b64_tr_b16 a[126:127], v167 offset:9216
v_mfma_f32_16x16x32_bf16 v[84:87], a[80:83], a[24:27], v[84:87]
s_waitcnt lgkmcnt(8)
buffer_load_dwordx4 v177, s[32:35], s70 offen offset:3072 lds
v_mfma_f32_16x16x32_bf16 v[40:43], a[96:99], a[0:3], v[40:43]
s_add_u32 s71, s70, s79
v_mfma_f32_16x16x32_bf16 v[40:43], a[100:103], a[4:7], v[40:43]
s_add_u32 m0, s68, 102400
v_mfma_f32_16x16x32_bf16 v[104:107], a[108:111], a[4:7], v[104:107]
s_add_u32 s63, s63, 1
v_mfma_f32_16x16x32_bf16 v[104:107], a[104:107], a[0:3], v[104:107]
buffer_load_dwordx4 v174, s[32:35], s71 offen lds
v_mfma_f32_16x16x32_bf16 v[120:123], a[104:107], a[8:11], v[120:123]
v_mfma_f32_16x16x32_bf16 v[120:123], a[108:111], a[12:15], v[120:123]
v_mfma_f32_16x16x32_bf16 v[56:59], a[100:103], a[12:15], v[56:59]
s_cmp_eq_u32 s63, 10
s_cselect_b32 s63, 0, s63
v_mfma_f32_16x16x32_bf16 v[56:59], a[96:99], a[8:11], v[56:59]
buffer_load_dwordx4 v175, s[32:35], s71 offen offset:1024 lds
v_mfma_f32_16x16x32_bf16 v[72:75], a[96:99], a[16:19], v[72:75]
v_mfma_f32_16x16x32_bf16 v[72:75], a[100:103], a[20:23], v[72:75]
v_mfma_f32_16x16x32_bf16 v[136:139], a[108:111], a[20:23], v[136:139]
v_mfma_f32_16x16x32_bf16 v[136:139], a[104:107], a[16:19], v[136:139]
buffer_load_dwordx4 v176, s[32:35], s71 offen offset:2048 lds
v_mfma_f32_16x16x32_bf16 v[152:155], a[104:107], a[24:27], v[152:155]
v_mfma_f32_16x16x32_bf16 v[152:155], a[108:111], a[28:31], v[152:155]
v_mfma_f32_16x16x32_bf16 v[88:91], a[100:103], a[28:31], v[88:91]
buffer_load_dwordx4 v177, s[32:35], s71 offen offset:3072 lds
v_mfma_f32_16x16x32_bf16 v[88:91], a[96:99], a[24:27], v[88:91]
s_waitcnt vmcnt(12) lgkmcnt(0)
s_barrier
v_mfma_f32_16x16x32_bf16 v[44:47], a[112:115], a[0:3], v[44:47]
ds_read_b64_tr_b16 a[64:65], v160 offset:16384
v_mfma_f32_16x16x32_bf16 v[44:47], a[116:119], a[4:7], v[44:47]
ds_read_b64_tr_b16 a[66:67], v160 offset:17408
v_mfma_f32_16x16x32_bf16 v[108:111], a[124:127], a[4:7], v[108:111]
ds_read_b64_tr_b16 a[68:69], v160 offset:24576
v_mfma_f32_16x16x32_bf16 v[108:111], a[120:123], a[0:3], v[108:111]
ds_read_b64_tr_b16 a[70:71], v160 offset:25600
v_mfma_f32_16x16x32_bf16 v[124:127], a[120:123], a[8:11], v[124:127]
ds_read_b128 a[32:35], v170 offset:0
v_mfma_f32_16x16x32_bf16 v[124:127], a[124:127], a[12:15], v[124:127]
ds_read_b128 a[36:39], v171 offset:0
v_mfma_f32_16x16x32_bf16 v[60:63], a[116:119], a[12:15], v[60:63]
ds_read_b64_tr_b16 a[72:73], v161 offset:16384
v_mfma_f32_16x16x32_bf16 v[60:63], a[112:115], a[8:11], v[60:63]
ds_read_b64_tr_b16 a[74:75], v161 offset:17408
v_mfma_f32_16x16x32_bf16 v[76:79], a[112:115], a[16:19], v[76:79]
ds_read_b64_tr_b16 a[76:77], v161 offset:24576
v_mfma_f32_16x16x32_bf16 v[76:79], a[116:119], a[20:23], v[76:79]
ds_read_b64_tr_b16 a[78:79], v161 offset:25600
v_mfma_f32_16x16x32_bf16 v[140:143], a[124:127], a[20:23], v[140:143]
ds_read_b128 a[40:43], v170 offset:2048
v_mfma_f32_16x16x32_bf16 v[140:143], a[120:123], a[16:19], v[140:143]
ds_read_b128 a[44:47], v171 offset:2048
v_mfma_f32_16x16x32_bf16 v[156:159], a[120:123], a[24:27], v[156:159]
ds_read_b128 a[48:51], v170 offset:4096
v_mfma_f32_16x16x32_bf16 v[156:159], a[124:127], a[28:31], v[156:159]
ds_read_b128 a[52:55], v171 offset:4096
v_mfma_f32_16x16x32_bf16 v[92:95], a[116:119], a[28:31], v[92:95]
ds_read_b128 a[56:59], v170 offset:6144
v_mfma_f32_16x16x32_bf16 v[92:95], a[112:115], a[24:27], v[92:95]
s_waitcnt lgkmcnt(9)
ds_read_b128 a[60:63], v171 offset:6144
v_mfma_f32_16x16x32_bf16 v[32:35], a[64:67], a[32:35], v[32:35]
s_lshl_b32 s66, s63, 19
ds_read_b64_tr_b16 a[80:81], v162 offset:16384
v_mov_b32 v232, 0
v_mfma_f32_16x16x32_bf16 v[32:35], a[68:71], a[36:39], v[32:35]
s_waitcnt lgkmcnt(7)
s_add_u32 s66, s66, s65
ds_read_b64_tr_b16 a[82:83], v162 offset:17408
v_mov_b32 v233, 1
v_mfma_f32_16x16x32_bf16 v[96:99], a[76:79], a[36:39], v[96:99]
s_add_u32 m0, s69, 32768
ds_read_b64_tr_b16 a[84:85], v162 offset:24576
v_min_u32 v236, 1, v1
v_mfma_f32_16x16x32_bf16 v[96:99], a[72:75], a[32:35], v[96:99]
s_waitcnt lgkmcnt(7)
buffer_load_dwordx4 v178, s[44:47], s66 offen lds
v_mfma_f32_16x16x32_bf16 v[112:115], a[72:75], a[40:43], v[112:115]
ds_read_b64_tr_b16 a[86:87], v162 offset:25600
v_lshlrev_b32 v236, 28, v236
v_mfma_f32_16x16x32_bf16 v[112:115], a[76:79], a[44:47], v[112:115]
ds_read_b64_tr_b16 a[88:89], v163 offset:16384
v_lshrrev_b32 v235, 5, v1
v_mfma_f32_16x16x32_bf16 v[48:51], a[68:71], a[44:47], v[48:51]
ds_read_b64_tr_b16 a[90:91], v163 offset:17408
v_lshlrev_b32 v235, 28, v235
v_mfma_f32_16x16x32_bf16 v[48:51], a[64:67], a[40:43], v[48:51]
s_waitcnt lgkmcnt(8)
buffer_load_dwordx4 v179, s[44:47], s66 offen offset:1024 lds
v_mfma_f32_16x16x32_bf16 v[64:67], a[64:67], a[48:51], v[64:67]
ds_read_b64_tr_b16 a[92:93], v163 offset:24576
v_lshl_add_u32 v235, v1, 2, v235
v_mfma_f32_16x16x32_bf16 v[64:67], a[68:71], a[52:55], v[64:67]
ds_read_b64_tr_b16 a[94:95], v163 offset:25600
v_lshlrev_b32 v234, 7, v1
v_mfma_f32_16x16x32_bf16 v[128:131], a[76:79], a[52:55], v[128:131]
ds_read_b64_tr_b16 a[96:97], v164 offset:16384
v_mfma_f32_16x16x32_bf16 v[128:131], a[72:75], a[48:51], v[128:131]
s_waitcnt lgkmcnt(9)
buffer_load_dwordx4 v180, s[44:47], s66 offen offset:2048 lds
v_mfma_f32_16x16x32_bf16 v[144:147], a[72:75], a[56:59], v[144:147]
ds_read_b64_tr_b16 a[98:99], v164 offset:17408
v_mfma_f32_16x16x32_bf16 v[144:147], a[76:79], a[60:63], v[144:147]
ds_read_b64_tr_b16 a[100:101], v164 offset:24576
v_mfma_f32_16x16x32_bf16 v[80:83], a[68:71], a[60:63], v[80:83]
ds_read_b64_tr_b16 a[102:103], v164 offset:25600
v_mfma_f32_16x16x32_bf16 v[80:83], a[64:67], a[56:59], v[80:83]
s_waitcnt lgkmcnt(4)
buffer_load_dwordx4 v181, s[44:47], s66 offen offset:3072 lds
v_mfma_f32_16x16x32_bf16 v[36:39], a[80:83], a[32:35], v[36:39]
s_lshl_b32 s70, s63, 7
ds_read_b64_tr_b16 a[104:105], v165 offset:16384
v_mfma_f32_16x16x32_bf16 v[36:39], a[84:87], a[36:39], v[36:39]
s_add_u32 s70, s70, s64
ds_read_b64_tr_b16 a[106:107], v165 offset:17408
v_mfma_f32_16x16x32_bf16 v[100:103], a[92:95], a[36:39], v[100:103]
s_add_u32 m0, s68, 131072
ds_read_b64_tr_b16 a[108:109], v165 offset:24576
v_mfma_f32_16x16x32_bf16 v[100:103], a[88:91], a[32:35], v[100:103]
buffer_load_dwordx4 v174, s[32:35], s70 offen lds
v_mfma_f32_16x16x32_bf16 v[116:119], a[88:91], a[40:43], v[116:119]
ds_read_b64_tr_b16 a[110:111], v165 offset:25600
v_mfma_f32_16x16x32_bf16 v[116:119], a[92:95], a[44:47], v[116:119]
ds_read_b64_tr_b16 a[112:113], v166 offset:16384
v_mfma_f32_16x16x32_bf16 v[52:55], a[84:87], a[44:47], v[52:55]
ds_read_b64_tr_b16 a[114:115], v166 offset:17408
v_mfma_f32_16x16x32_bf16 v[52:55], a[80:83], a[40:43], v[52:55]
buffer_load_dwordx4 v175, s[32:35], s70 offen offset:1024 lds
v_mfma_f32_16x16x32_bf16 v[68:71], a[80:83], a[48:51], v[68:71]
ds_read_b64_tr_b16 a[116:117], v166 offset:24576
v_mfma_f32_16x16x32_bf16 v[68:71], a[84:87], a[52:55], v[68:71]
ds_read_b64_tr_b16 a[118:119], v166 offset:25600
v_mfma_f32_16x16x32_bf16 v[132:135], a[92:95], a[52:55], v[132:135]
ds_read_b64_tr_b16 a[120:121], v167 offset:16384
v_mfma_f32_16x16x32_bf16 v[132:135], a[88:91], a[48:51], v[132:135]
buffer_load_dwordx4 v176, s[32:35], s70 offen offset:2048 lds
v_mfma_f32_16x16x32_bf16 v[148:151], a[88:91], a[56:59], v[148:151]
ds_read_b64_tr_b16 a[122:123], v167 offset:17408
v_mfma_f32_16x16x32_bf16 v[148:151], a[92:95], a[60:63], v[148:151]
ds_read_b64_tr_b16 a[124:125], v167 offset:24576
v_mfma_f32_16x16x32_bf16 v[84:87], a[84:87], a[60:63], v[84:87]
ds_read_b64_tr_b16 a[126:127], v167 offset:25600
v_mfma_f32_16x16x32_bf16 v[84:87], a[80:83], a[56:59], v[84:87]
s_waitcnt lgkmcnt(8)
buffer_load_dwordx4 v177, s[32:35], s70 offen offset:3072 lds
v_mfma_f32_16x16x32_bf16 v[40:43], a[96:99], a[32:35], v[40:43]
s_add_u32 s71, s70, s79
ds_read_b64_tr_b16 a[148:149], v237 offset:0
v_mfma_f32_16x16x32_bf16 v[40:43], a[100:103], a[36:39], v[40:43]
s_add_u32 m0, s68, 135168
ds_read_b64_tr_b16 a[150:151], v31 offset:10240
v_mfma_f32_16x16x32_bf16 v[104:107], a[108:111], a[36:39], v[104:107]
s_add_u32 s63, s63, 1
ds_read_b64_tr_b16 a[152:153], v237 offset:32
v_mfma_f32_16x16x32_bf16 v[104:107], a[104:107], a[32:35], v[104:107]
buffer_load_dwordx4 v174, s[32:35], s71 offen lds
v_mfma_f32_16x16x32_bf16 v[120:123], a[104:107], a[40:43], v[120:123]
ds_read_b64_tr_b16 a[154:155], v31 offset:10272
v_mfma_f32_16x16x32_bf16 v[120:123], a[108:111], a[44:47], v[120:123]
ds_read_b64_tr_b16 a[156:157], v237 offset:64
v_mfma_f32_16x16x32_bf16 v[56:59], a[100:103], a[44:47], v[56:59]
s_cmp_eq_u32 s63, 10
s_cselect_b32 s63, 0, s63
ds_read_b64_tr_b16 a[158:159], v31 offset:10304
v_mfma_f32_16x16x32_bf16 v[56:59], a[96:99], a[40:43], v[56:59]
buffer_load_dwordx4 v175, s[32:35], s71 offen offset:1024 lds
v_mfma_f32_16x16x32_bf16 v[72:75], a[96:99], a[48:51], v[72:75]
ds_read_b64_tr_b16 a[160:161], v237 offset:96
v_mfma_f32_16x16x32_bf16 v[72:75], a[100:103], a[52:55], v[72:75]
ds_read_b64_tr_b16 a[162:163], v31 offset:10336
v_mfma_f32_16x16x32_bf16 v[136:139], a[108:111], a[52:55], v[136:139]
ds_read_b64_tr_b16 a[164:165], v237 offset:128
v_mfma_f32_16x16x32_bf16 v[136:139], a[104:107], a[48:51], v[136:139]
buffer_load_dwordx4 v176, s[32:35], s71 offen offset:2048 lds
v_mfma_f32_16x16x32_bf16 v[152:155], a[104:107], a[56:59], v[152:155]
ds_read_b64_tr_b16 a[166:167], v31 offset:10368
v_mfma_f32_16x16x32_bf16 v[152:155], a[108:111], a[60:63], v[152:155]
v_mfma_f32_16x16x32_bf16 v[88:91], a[100:103], a[60:63], v[88:91]
buffer_load_dwordx4 v177, s[32:35], s71 offen offset:3072 lds
v_mfma_f32_16x16x32_bf16 v[88:91], a[96:99], a[56:59], v[88:91]
s_waitcnt vmcnt(12) lgkmcnt(0)
s_barrier
v_mfma_f32_16x16x32_bf16 v[44:47], a[112:115], a[32:35], v[44:47]
ds_read_b64_tr_b16 a[64:65], v160 offset:49152
v_mfma_f32_16x16x32_bf16 v[44:47], a[116:119], a[36:39], v[44:47]
ds_read_b64_tr_b16 a[66:67], v160 offset:50176
v_mfma_f32_16x16x32_bf16 v[108:111], a[124:127], a[36:39], v[108:111]
ds_read_b64_tr_b16 a[68:69], v160 offset:57344
v_mfma_f32_16x16x32_bf16 v[108:111], a[120:123], a[32:35], v[108:111]
ds_read_b64_tr_b16 a[70:71], v160 offset:58368
v_mfma_f32_16x16x32_bf16 v[124:127], a[120:123], a[40:43], v[124:127]
ds_read_b128 a[0:3], v168 offset:0
v_mfma_f32_16x16x32_bf16 v[124:127], a[124:127], a[44:47], v[124:127]
ds_read_b128 a[4:7], v169 offset:0
v_mfma_f32_16x16x32_bf16 v[60:63], a[116:119], a[44:47], v[60:63]
ds_read_b64_tr_b16 a[72:73], v161 offset:49152
v_mfma_f32_16x16x32_bf16 v[60:63], a[112:115], a[40:43], v[60:63]
ds_read_b64_tr_b16 a[74:75], v161 offset:50176
v_mfma_f32_16x16x32_bf16 v[76:79], a[112:115], a[48:51], v[76:79]
ds_read_b64_tr_b16 a[76:77], v161 offset:57344
v_mfma_f32_16x16x32_bf16 v[76:79], a[116:119], a[52:55], v[76:79]
ds_read_b64_tr_b16 a[78:79], v161 offset:58368
v_mfma_f32_16x16x32_bf16 v[140:143], a[124:127], a[52:55], v[140:143]
ds_read_b128 a[8:11], v168 offset:2048
v_mfma_f32_16x16x32_bf16 v[140:143], a[120:123], a[48:51], v[140:143]
ds_read_b128 a[12:15], v169 offset:2048
v_mfma_f32_16x16x32_bf16 v[156:159], a[120:123], a[56:59], v[156:159]
ds_read_b128 a[16:19], v168 offset:4096
v_mfma_f32_16x16x32_bf16 v[156:159], a[124:127], a[60:63], v[156:159]
ds_read_b128 a[20:23], v169 offset:4096
v_mfma_f32_16x16x32_bf16 v[92:95], a[116:119], a[60:63], v[92:95]
ds_read_b128 a[24:27], v168 offset:6144
v_mfma_f32_16x16x32_bf16 v[92:95], a[112:115], a[56:59], v[92:95]
s_waitcnt lgkmcnt(9)
ds_read_b128 a[28:31], v169 offset:6144
v_mfma_f32_16x16x32_bf16 v[32:35], a[64:67], a[0:3], v[32:35]
s_lshl_b32 s66, s63, 19
ds_read_b64_tr_b16 a[80:81], v162 offset:49152
v_mfma_f32_16x16x32_bf16 v[32:35], a[68:71], a[4:7], v[32:35]
s_waitcnt lgkmcnt(7)
s_add_u32 s66, s66, s65
ds_read_b64_tr_b16 a[82:83], v162 offset:50176
v_mfma_f32_16x16x32_bf16 v[96:99], a[76:79], a[4:7], v[96:99]
s_add_u32 m0, s69, 49152
ds_read_b64_tr_b16 a[84:85], v162 offset:57344
v_mfma_f32_16x16x32_bf16 v[96:99], a[72:75], a[0:3], v[96:99]
s_waitcnt lgkmcnt(7)
buffer_load_dwordx4 v178, s[44:47], s66 offen lds
v_mfma_f32_16x16x32_bf16 v[112:115], a[72:75], a[8:11], v[112:115]
ds_read_b64_tr_b16 a[86:87], v162 offset:58368
v_mfma_f32_16x16x32_bf16 v[112:115], a[76:79], a[12:15], v[112:115]
ds_read_b64_tr_b16 a[88:89], v163 offset:49152
v_mfma_f32_16x16x32_bf16 v[48:51], a[68:71], a[12:15], v[48:51]
ds_read_b64_tr_b16 a[90:91], v163 offset:50176
v_mfma_f32_16x16x32_bf16 v[48:51], a[64:67], a[8:11], v[48:51]
s_waitcnt lgkmcnt(8)
buffer_load_dwordx4 v179, s[44:47], s66 offen offset:1024 lds
v_mfma_f32_16x16x32_bf16 v[64:67], a[64:67], a[16:19], v[64:67]
ds_read_b64_tr_b16 a[92:93], v163 offset:57344
v_mfma_f32_16x16x32_bf16 v[64:67], a[68:71], a[20:23], v[64:67]
ds_read_b64_tr_b16 a[94:95], v163 offset:58368
v_mfma_f32_16x16x32_bf16 v[128:131], a[76:79], a[20:23], v[128:131]
ds_read_b64_tr_b16 a[96:97], v164 offset:49152
v_mfma_f32_16x16x32_bf16 v[128:131], a[72:75], a[16:19], v[128:131]
s_waitcnt lgkmcnt(9)
buffer_load_dwordx4 v180, s[44:47], s66 offen offset:2048 lds
v_mfma_f32_16x16x32_bf16 v[144:147], a[72:75], a[24:27], v[144:147]
ds_read_b64_tr_b16 a[98:99], v164 offset:50176
v_mfma_f32_16x16x32_bf16 v[144:147], a[76:79], a[28:31], v[144:147]
ds_read_b64_tr_b16 a[100:101], v164 offset:57344
v_mfma_f32_16x16x32_bf16 v[80:83], a[68:71], a[28:31], v[80:83]
ds_read_b64_tr_b16 a[102:103], v164 offset:58368
v_mfma_f32_16x16x32_bf16 v[80:83], a[64:67], a[24:27], v[80:83]
s_waitcnt lgkmcnt(4)
buffer_load_dwordx4 v181, s[44:47], s66 offen offset:3072 lds
v_mfma_f32_16x16x32_bf16 v[36:39], a[80:83], a[0:3], v[36:39]
s_lshl_b32 s70, s63, 7
ds_read_b64_tr_b16 a[104:105], v165 offset:49152
v_mfma_f32_16x16x32_bf16 v[36:39], a[84:87], a[4:7], v[36:39]
s_add_u32 s70, s70, s64
ds_read_b64_tr_b16 a[106:107], v165 offset:50176
v_mfma_f32_16x16x32_bf16 v[100:103], a[92:95], a[4:7], v[100:103]
s_add_u32 m0, s68, 98304
ds_read_b64_tr_b16 a[108:109], v165 offset:57344
v_mfma_f32_16x16x32_bf16 v[100:103], a[88:91], a[0:3], v[100:103]
buffer_load_dwordx4 v174, s[32:35], s70 offen lds
v_mfma_f32_16x16x32_bf16 v[116:119], a[88:91], a[8:11], v[116:119]
ds_read_b64_tr_b16 a[110:111], v165 offset:58368
v_mfma_f32_16x16x32_bf16 v[116:119], a[92:95], a[12:15], v[116:119]
ds_read_b64_tr_b16 a[112:113], v166 offset:49152
v_mfma_f32_16x16x32_bf16 v[52:55], a[84:87], a[12:15], v[52:55]
ds_read_b64_tr_b16 a[114:115], v166 offset:50176
v_mfma_f32_16x16x32_bf16 v[52:55], a[80:83], a[8:11], v[52:55]
buffer_load_dwordx4 v175, s[32:35], s70 offen offset:1024 lds
v_mfma_f32_16x16x32_bf16 v[68:71], a[80:83], a[16:19], v[68:71]
ds_read_b64_tr_b16 a[116:117], v166 offset:57344
v_mfma_f32_16x16x32_bf16 v[68:71], a[84:87], a[20:23], v[68:71]
ds_read_b64_tr_b16 a[118:119], v166 offset:58368
v_mfma_f32_16x16x32_bf16 v[132:135], a[92:95], a[20:23], v[132:135]
ds_read_b64_tr_b16 a[120:121], v167 offset:49152
v_mfma_f32_16x16x32_bf16 v[132:135], a[88:91], a[16:19], v[132:135]
buffer_load_dwordx4 v176, s[32:35], s70 offen offset:2048 lds
v_mfma_f32_16x16x32_bf16 v[148:151], a[88:91], a[24:27], v[148:151]
ds_read_b64_tr_b16 a[122:123], v167 offset:50176
v_mfma_f32_16x16x32_bf16 v[148:151], a[92:95], a[28:31], v[148:151]
ds_read_b64_tr_b16 a[124:125], v167 offset:57344
v_mfma_f32_16x16x32_bf16 v[84:87], a[84:87], a[28:31], v[84:87]
ds_read_b64_tr_b16 a[126:127], v167 offset:58368
v_mfma_f32_16x16x32_bf16 v[84:87], a[80:83], a[24:27], v[84:87]
s_waitcnt lgkmcnt(8)
buffer_load_dwordx4 v177, s[32:35], s70 offen offset:3072 lds
v_mfma_f32_16x16x32_bf16 v[40:43], a[96:99], a[0:3], v[40:43]
s_add_u32 s71, s70, s79
v_mfma_f32_16x16x32_bf16 v[40:43], a[100:103], a[4:7], v[40:43]
s_add_u32 m0, s68, 102400
v_mfma_f32_16x16x32_bf16 v[104:107], a[108:111], a[4:7], v[104:107]
s_add_u32 s63, s63, 1
v_mfma_f32_16x16x32_bf16 v[104:107], a[104:107], a[0:3], v[104:107]
buffer_load_dwordx4 v174, s[32:35], s71 offen lds
v_mfma_f32_16x16x32_bf16 v[120:123], a[104:107], a[8:11], v[120:123]
v_mfma_f32_16x16x32_bf16 v[120:123], a[108:111], a[12:15], v[120:123]
v_mfma_f32_16x16x32_bf16 v[56:59], a[100:103], a[12:15], v[56:59]
s_cmp_eq_u32 s63, 10
s_cselect_b32 s63, 0, s63
v_mfma_f32_16x16x32_bf16 v[56:59], a[96:99], a[8:11], v[56:59]
buffer_load_dwordx4 v175, s[32:35], s71 offen offset:1024 lds
v_mfma_f32_16x16x32_bf16 v[72:75], a[96:99], a[16:19], v[72:75]
v_mfma_f32_16x16x32_bf16 v[72:75], a[100:103], a[20:23], v[72:75]
v_mfma_f32_16x16x32_bf16 v[136:139], a[108:111], a[20:23], v[136:139]
v_mfma_f32_16x16x32_bf16 v[136:139], a[104:107], a[16:19], v[136:139]
buffer_load_dwordx4 v176, s[32:35], s71 offen offset:2048 lds
v_mfma_f32_16x16x32_bf16 v[152:155], a[104:107], a[24:27], v[152:155]
v_mfma_f32_16x16x32_bf16 v[152:155], a[108:111], a[28:31], v[152:155]
v_mfma_f32_16x16x32_bf16 v[88:91], a[100:103], a[28:31], v[88:91]
buffer_load_dwordx4 v177, s[32:35], s71 offen offset:3072 lds
v_mfma_f32_16x16x32_bf16 v[88:91], a[96:99], a[24:27], v[88:91]
s_waitcnt vmcnt(12) lgkmcnt(0)
s_barrier
v_mfma_f32_16x16x32_bf16 v[44:47], a[112:115], a[0:3], v[44:47]
ds_read_b64_tr_b16 a[64:65], v160 offset:0
v_mfma_f32_16x16x32_bf16 v[44:47], a[116:119], a[4:7], v[44:47]
ds_read_b64_tr_b16 a[66:67], v160 offset:1024
v_mfma_f32_16x16x32_bf16 v[108:111], a[124:127], a[4:7], v[108:111]
ds_read_b64_tr_b16 a[68:69], v160 offset:8192
v_mfma_f32_16x16x32_bf16 v[108:111], a[120:123], a[0:3], v[108:111]
ds_read_b64_tr_b16 a[70:71], v160 offset:9216
v_mfma_f32_16x16x32_bf16 v[124:127], a[120:123], a[8:11], v[124:127]
ds_read_b128 a[32:35], v170 offset:0
v_mfma_f32_16x16x32_bf16 v[124:127], a[124:127], a[12:15], v[124:127]
ds_read_b128 a[36:39], v171 offset:0
v_mfma_f32_16x16x32_bf16 v[60:63], a[116:119], a[12:15], v[60:63]
ds_read_b64_tr_b16 a[72:73], v161 offset:0
v_mfma_f32_16x16x32_bf16 v[60:63], a[112:115], a[8:11], v[60:63]
ds_read_b64_tr_b16 a[74:75], v161 offset:1024
v_mfma_f32_16x16x32_bf16 v[76:79], a[112:115], a[16:19], v[76:79]
ds_read_b64_tr_b16 a[76:77], v161 offset:8192
v_mfma_f32_16x16x32_bf16 v[76:79], a[116:119], a[20:23], v[76:79]
ds_read_b64_tr_b16 a[78:79], v161 offset:9216
v_mfma_f32_16x16x32_bf16 v[140:143], a[124:127], a[20:23], v[140:143]
ds_read_b128 a[40:43], v170 offset:2048
v_mfma_f32_16x16x32_bf16 v[140:143], a[120:123], a[16:19], v[140:143]
ds_read_b128 a[44:47], v171 offset:2048
v_mfma_f32_16x16x32_bf16 v[156:159], a[120:123], a[24:27], v[156:159]
ds_read_b128 a[48:51], v170 offset:4096
v_mfma_f32_16x16x32_bf16 v[156:159], a[124:127], a[28:31], v[156:159]
ds_read_b128 a[52:55], v171 offset:4096
v_mfma_f32_16x16x32_bf16 v[92:95], a[116:119], a[28:31], v[92:95]
ds_read_b128 a[56:59], v170 offset:6144
v_mfma_f32_16x16x32_bf16 v[92:95], a[112:115], a[24:27], v[92:95]
s_waitcnt lgkmcnt(9)
ds_read_b128 a[60:63], v171 offset:6144
v_mfma_f32_16x16x32_bf16 v[32:35], a[64:67], a[32:35], v[32:35]
s_lshl_b32 s66, s63, 19
ds_read_b64_tr_b16 a[80:81], v162 offset:0
v_mfma_f32_16x16x32_bf16 v[32:35], a[68:71], a[36:39], v[32:35]
s_waitcnt lgkmcnt(7)
s_add_u32 s66, s66, s65
ds_read_b64_tr_b16 a[82:83], v162 offset:1024
v_mfma_f32_16x16x32_bf16 v[96:99], a[76:79], a[36:39], v[96:99]
s_add_u32 m0, s69, 81920
ds_read_b64_tr_b16 a[84:85], v162 offset:8192
v_mfma_f32_16x16x32_bf16 v[96:99], a[72:75], a[32:35], v[96:99]
s_waitcnt lgkmcnt(7)
buffer_load_dwordx4 v178, s[44:47], s66 offen lds
v_mfma_f32_16x16x32_bf16 v[112:115], a[72:75], a[40:43], v[112:115]
ds_read_b64_tr_b16 a[86:87], v162 offset:9216
v_mfma_f32_16x16x32_bf16 v[112:115], a[76:79], a[44:47], v[112:115]
ds_read_b64_tr_b16 a[88:89], v163 offset:0
v_mfma_f32_16x16x32_bf16 v[48:51], a[68:71], a[44:47], v[48:51]
ds_read_b64_tr_b16 a[90:91], v163 offset:1024
v_mfma_f32_16x16x32_bf16 v[48:51], a[64:67], a[40:43], v[48:51]
s_waitcnt lgkmcnt(8)
buffer_load_dwordx4 v179, s[44:47], s66 offen offset:1024 lds
v_mfma_f32_16x16x32_bf16 v[64:67], a[64:67], a[48:51], v[64:67]
ds_read_b64_tr_b16 a[92:93], v163 offset:8192
v_mfma_f32_16x16x32_bf16 v[64:67], a[68:71], a[52:55], v[64:67]
ds_read_b64_tr_b16 a[94:95], v163 offset:9216
v_mfma_f32_16x16x32_bf16 v[128:131], a[76:79], a[52:55], v[128:131]
ds_read_b64_tr_b16 a[96:97], v164 offset:0
v_mfma_f32_16x16x32_bf16 v[128:131], a[72:75], a[48:51], v[128:131]
s_waitcnt lgkmcnt(9)
buffer_load_dwordx4 v180, s[44:47], s66 offen offset:2048 lds
v_mfma_f32_16x16x32_bf16 v[144:147], a[72:75], a[56:59], v[144:147]
ds_read_b64_tr_b16 a[98:99], v164 offset:1024
v_mfma_f32_16x16x32_bf16 v[144:147], a[76:79], a[60:63], v[144:147]
ds_read_b64_tr_b16 a[100:101], v164 offset:8192
v_mfma_f32_16x16x32_bf16 v[80:83], a[68:71], a[60:63], v[80:83]
ds_read_b64_tr_b16 a[102:103], v164 offset:9216
v_mfma_f32_16x16x32_bf16 v[80:83], a[64:67], a[56:59], v[80:83]
s_waitcnt lgkmcnt(4)
buffer_load_dwordx4 v181, s[44:47], s66 offen offset:3072 lds
v_mfma_f32_16x16x32_bf16 v[36:39], a[80:83], a[32:35], v[36:39]
s_lshl_b32 s70, s63, 7
ds_read_b64_tr_b16 a[104:105], v165 offset:0
v_mfma_f32_16x16x32_bf16 v[36:39], a[84:87], a[36:39], v[36:39]
s_add_u32 s70, s70, s64
ds_read_b64_tr_b16 a[106:107], v165 offset:1024
v_mfma_f32_16x16x32_bf16 v[100:103], a[92:95], a[36:39], v[100:103]
s_add_u32 m0, s68, 131072
ds_read_b64_tr_b16 a[108:109], v165 offset:8192
v_mfma_f32_16x16x32_bf16 v[100:103], a[88:91], a[32:35], v[100:103]
buffer_load_dwordx4 v174, s[32:35], s70 offen lds
v_mfma_f32_16x16x32_bf16 v[116:119], a[88:91], a[40:43], v[116:119]
ds_read_b64_tr_b16 a[110:111], v165 offset:9216
v_mfma_f32_16x16x32_bf16 v[116:119], a[92:95], a[44:47], v[116:119]
ds_read_b64_tr_b16 a[112:113], v166 offset:0
v_mfma_f32_16x16x32_bf16 v[52:55], a[84:87], a[44:47], v[52:55]
ds_read_b64_tr_b16 a[114:115], v166 offset:1024
v_mfma_f32_16x16x32_bf16 v[52:55], a[80:83], a[40:43], v[52:55]
buffer_load_dwordx4 v175, s[32:35], s70 offen offset:1024 lds
v_mfma_f32_16x16x32_bf16 v[68:71], a[80:83], a[48:51], v[68:71]
ds_read_b64_tr_b16 a[116:117], v166 offset:8192
v_mfma_f32_16x16x32_bf16 v[68:71], a[84:87], a[52:55], v[68:71]
ds_read_b64_tr_b16 a[118:119], v166 offset:9216
v_mfma_f32_16x16x32_bf16 v[132:135], a[92:95], a[52:55], v[132:135]
ds_read_b64_tr_b16 a[120:121], v167 offset:0
v_mfma_f32_16x16x32_bf16 v[132:135], a[88:91], a[48:51], v[132:135]
buffer_load_dwordx4 v176, s[32:35], s70 offen offset:2048 lds
v_mfma_f32_16x16x32_bf16 v[148:151], a[88:91], a[56:59], v[148:151]
ds_read_b64_tr_b16 a[122:123], v167 offset:1024
v_mfma_f32_16x16x32_bf16 v[148:151], a[92:95], a[60:63], v[148:151]
ds_read_b64_tr_b16 a[124:125], v167 offset:8192
v_mfma_f32_16x16x32_bf16 v[84:87], a[84:87], a[60:63], v[84:87]
ds_read_b64_tr_b16 a[126:127], v167 offset:9216
v_mfma_f32_16x16x32_bf16 v[84:87], a[80:83], a[56:59], v[84:87]
s_waitcnt lgkmcnt(8)
buffer_load_dwordx4 v177, s[32:35], s70 offen offset:3072 lds
L_hop0_1:
s_cbranch_execz L_hop_ret0
v_mfma_f32_16x16x32_bf16 v[40:43], a[96:99], a[32:35], v[40:43]
s_add_u32 s71, s70, s79
v_mfma_f32_16x16x32_bf16 v[40:43], a[100:103], a[36:39], v[40:43]
s_add_u32 m0, s68, 135168
v_mfma_f32_16x16x32_bf16 v[104:107], a[108:111], a[36:39], v[104:107]
s_add_u32 s63, s63, 1
v_mfma_f32_16x16x32_bf16 v[104:107], a[104:107], a[32:35], v[104:107]
buffer_load_dwordx4 v174, s[32:35], s71 offen lds
v_mfma_f32_16x16x32_bf16 v[120:123], a[104:107], a[40:43], v[120:123]
v_mfma_f32_16x16x32_bf16 v[120:123], a[108:111], a[44:47], v[120:123]
v_mfma_f32_16x16x32_bf16 v[56:59], a[100:103], a[44:47], v[56:59]
s_cmp_eq_u32 s63, 10
s_cselect_b32 s63, 0, s63
v_mfma_f32_16x16x32_bf16 v[56:59], a[96:99], a[40:43], v[56:59]
buffer_load_dwordx4 v175, s[32:35], s71 offen offset:1024 lds
v_mfma_f32_16x16x32_bf16 v[72:75], a[96:99], a[48:51], v[72:75]
v_mfma_f32_16x16x32_bf16 v[72:75], a[100:103], a[52:55], v[72:75]
v_mfma_f32_16x16x32_bf16 v[136:139], a[108:111], a[52:55], v[136:139]
v_mfma_f32_16x16x32_bf16 v[136:139], a[104:107], a[48:51], v[136:139]
buffer_load_dwordx4 v176, s[32:35], s71 offen offset:2048 lds
v_mfma_f32_16x16x32_bf16 v[152:155], a[104:107], a[56:59], v[152:155]
v_mfma_f32_16x16x32_bf16 v[152:155], a[108:111], a[60:63], v[152:155]
v_mfma_f32_16x16x32_bf16 v[88:91], a[100:103], a[60:63], v[88:91]
buffer_load_dwordx4 v177, s[32:35], s71 offen offset:3072 lds
v_mfma_f32_16x16x32_bf16 v[88:91], a[96:99], a[56:59], v[88:91]
s_waitcnt vmcnt(12) lgkmcnt(0)
s_barrier
v_mfma_f32_16x16x32_bf16 v[44:47], a[112:115], a[32:35], v[44:47]
ds_read_b64_tr_b16 a[64:65], v160 offset:16384
v_mfma_f32_16x16x32_bf16 v[44:47], a[116:119], a[36:39], v[44:47]
ds_read_b64_tr_b16 a[66:67], v160 offset:17408
v_mfma_f32_16x16x32_bf16 v[108:111], a[124:127], a[36:39], v[108:111]
ds_read_b64_tr_b16 a[68:69], v160 offset:24576
v_mfma_f32_16x16x32_bf16 v[108:111], a[120:123], a[32:35], v[108:111]
ds_read_b64_tr_b16 a[70:71], v160 offset:25600
v_mfma_f32_16x16x32_bf16 v[124:127], a[120:123], a[40:43], v[124:127]
ds_read_b128 a[0:3], v168 offset:0
v_mfma_f32_16x16x32_bf16 v[124:127], a[124:127], a[44:47], v[124:127]
ds_read_b128 a[4:7], v169 offset:0
v_mfma_f32_16x16x32_bf16 v[60:63], a[116:119], a[44:47], v[60:63]
ds_read_b64_tr_b16 a[72:73], v161 offset:16384
v_mfma_f32_16x16x32_bf16 v[60:63], a[112:115], a[40:43], v[60:63]
ds_read_b64_tr_b16 a[74:75], v161 offset:17408
v_mfma_f32_16x16x32_bf16 v[76:79], a[112:115], a[48:51], v[76:79]
ds_read_b64_tr_b16 a[76:77], v161 offset:24576
v_mfma_f32_16x16x32_bf16 v[76:79], a[116:119], a[52:55], v[76:79]
ds_read_b64_tr_b16 a[78:79], v161 offset:25600
v_mfma_f32_16x16x32_bf16 v[140:143], a[124:127], a[52:55], v[140:143]
ds_read_b128 a[8:11], v168 offset:2048
v_mfma_f32_16x16x32_bf16 v[140:143], a[120:123], a[48:51], v[140:143]
ds_read_b128 a[12:15], v169 offset:2048
v_mfma_f32_16x16x32_bf16 v[156:159], a[120:123], a[56:59], v[156:159]
ds_read_b128 a[16:19], v168 offset:4096
v_mfma_f32_16x16x32_bf16 v[156:159], a[124:127], a[60:63], v[156:159]
ds_read_b128 a[20:23], v169 offset:4096
v_mfma_f32_16x16x32_bf16 v[92:95], a[116:119], a[60:63], v[92:95]
ds_read_b128 a[24:27], v168 offset:6144
v_mfma_f32_16x16x32_bf16 v[92:95], a[112:115], a[56:59], v[92:95]
s_waitcnt lgkmcnt(9)
ds_read_b128 a[28:31], v169 offset:6144
v_mfma_f32_16x16x32_bf16 v[32:35], a[64:67], a[0:3], v[32:35]
ds_read_b64_tr_b16 a[80:81], v162 offset:16384
v_mfma_f32_16x16x32_bf16 v[32:35], a[68:71], a[4:7], v[32:35]
s_waitcnt lgkmcnt(7)
s_xor_b32 s76, s67, 65536
ds_read_b64_tr_b16 a[82:83], v162 offset:17408
v_mfma_f32_16x16x32_bf16 v[96:99], a[76:79], a[4:7], v[96:99]
s_add_u32 m0, s69, 16384
ds_read_b64_tr_b16 a[84:85], v162 offset:24576
v_mfma_f32_16x16x32_bf16 v[96:99], a[72:75], a[0:3], v[96:99]
s_waitcnt lgkmcnt(7)
buffer_load_dwordx4 v14, s[36:39], s76 offen nt lds
v_mfma_f32_16x16x32_bf16 v[112:115], a[72:75], a[8:11], v[112:115]
ds_read_b64_tr_b16 a[86:87], v162 offset:25600
v_mfma_f32_16x16x32_bf16 v[112:115], a[76:79], a[12:15], v[112:115]
ds_read_b64_tr_b16 a[88:89], v163 offset:16384
v_mfma_f32_16x16x32_bf16 v[48:51], a[68:71], a[12:15], v[48:51]
ds_read_b64_tr_b16 a[90:91], v163 offset:17408
v_mfma_f32_16x16x32_bf16 v[48:51], a[64:67], a[8:11], v[48:51]
s_waitcnt lgkmcnt(8)
buffer_load_dwordx4 v15, s[36:39], s76 offen offset:1024 nt lds
v_mfma_f32_16x16x32_bf16 v[64:67], a[64:67], a[16:19], v[64:67]
ds_read_b64_tr_b16 a[92:93], v163 offset:24576
v_mfma_f32_16x16x32_bf16 v[64:67], a[68:71], a[20:23], v[64:67]
ds_read_b64_tr_b16 a[94:95], v163 offset:25600
v_mfma_f32_16x16x32_bf16 v[128:131], a[76:79], a[20:23], v[128:131]
ds_read_b64_tr_b16 a[96:97], v164 offset:16384
v_mfma_f32_16x16x32_bf16 v[128:131], a[72:75], a[16:19], v[128:131]
s_waitcnt lgkmcnt(9)
v_mfma_f32_16x16x32_bf16 v[144:147], a[72:75], a[24:27], v[144:147]
ds_read_b64_tr_b16 a[98:99], v164 offset:17408
v_mfma_f32_16x16x32_bf16 v[144:147], a[76:79], a[28:31], v[144:147]
ds_read_b64_tr_b16 a[100:101], v164 offset:24576
v_mfma_f32_16x16x32_bf16 v[80:83], a[68:71], a[28:31], v[80:83]
ds_read_b64_tr_b16 a[102:103], v164 offset:25600
v_mfma_f32_16x16x32_bf16 v[80:83], a[64:67], a[24:27], v[80:83]
s_waitcnt lgkmcnt(4)
buffer_load_dwordx4 v16, s[36:39], s76 offen offset:2048 nt lds
v_mfma_f32_16x16x32_bf16 v[36:39], a[80:83], a[0:3], v[36:39]
ds_read_b64_tr_b16 a[104:105], v165 offset:16384
v_mfma_f32_16x16x32_bf16 v[36:39], a[84:87], a[4:7], v[36:39]
ds_read_b64_tr_b16 a[106:107], v165 offset:17408
v_mfma_f32_16x16x32_bf16 v[100:103], a[92:95], a[4:7], v[100:103]
ds_read_b64_tr_b16 a[108:109], v165 offset:24576
v_mfma_f32_16x16x32_bf16 v[100:103], a[88:91], a[0:3], v[100:103]
v_mfma_f32_16x16x32_bf16 v[116:119], a[88:91], a[8:11], v[116:119]
ds_read_b64_tr_b16 a[110:111], v165 offset:25600
v_mfma_f32_16x16x32_bf16 v[116:119], a[92:95], a[12:15], v[116:119]
ds_read_b64_tr_b16 a[112:113], v166 offset:16384
v_mfma_f32_16x16x32_bf16 v[52:55], a[84:87], a[12:15], v[52:55]
ds_read_b64_tr_b16 a[114:115], v166 offset:17408
v_mfma_f32_16x16x32_bf16 v[52:55], a[80:83], a[8:11], v[52:55]
buffer_load_dwordx4 v17, s[36:39], s76 offen offset:3072 nt lds
v_mfma_f32_16x16x32_bf16 v[68:71], a[80:83], a[16:19], v[68:71]
ds_read_b64_tr_b16 a[116:117], v166 offset:24576
v_mfma_f32_16x16x32_bf16 v[68:71], a[84:87], a[20:23], v[68:71]
ds_read_b64_tr_b16 a[118:119], v166 offset:25600
v_mfma_f32_16x16x32_bf16 v[132:135], a[92:95], a[20:23], v[132:135]
ds_read_b64_tr_b16 a[120:121], v167 offset:16384
v_mfma_f32_16x16x32_bf16 v[132:135], a[88:91], a[16:19], v[132:135]
v_mfma_f32_16x16x32_bf16 v[148:151], a[88:91], a[24:27], v[148:151]
ds_read_b64_tr_b16 a[122:123], v167 offset:17408
v_mfma_f32_16x16x32_bf16 v[148:151], a[92:95], a[28:31], v[148:151]
s_xor_b32 s76, s67, 16384
ds_read_b64_tr_b16 a[124:125], v167 offset:24576
v_mfma_f32_16x16x32_bf16 v[84:87], a[84:87], a[28:31], v[84:87]
s_add_u32 m0, s69, 32768
ds_read_b64_tr_b16 a[126:127], v167 offset:25600
v_mfma_f32_16x16x32_bf16 v[84:87], a[80:83], a[24:27], v[84:87]
s_waitcnt lgkmcnt(8)
buffer_load_dwordx4 v14, s[36:39], s76 offen nt lds
v_mfma_f32_16x16x32_bf16 v[40:43], a[96:99], a[0:3], v[40:43]
ds_read_b128 v[192:195], v28 offset:0
v_mfma_f32_16x16x32_bf16 v[40:43], a[100:103], a[4:7], v[40:43]
ds_read_b128 v[196:199], v28 offset:64
v_mfma_f32_16x16x32_bf16 v[104:107], a[108:111], a[4:7], v[104:107]
ds_read_b128 v[200:203], v28 offset:128
v_mfma_f32_16x16x32_bf16 v[104:107], a[104:107], a[0:3], v[104:107]
ds_read_b128 v[204:207], v28 offset:192
v_mfma_f32_16x16x32_bf16 v[120:123], a[104:107], a[8:11], v[120:123]
v_mfma_f32_16x16x32_bf16 v[120:123], a[108:111], a[12:15], v[120:123]
v_mfma_f32_16x16x32_bf16 v[56:59], a[100:103], a[12:15], v[56:59]
v_mfma_f32_16x16x32_bf16 v[56:59], a[96:99], a[8:11], v[56:59]
buffer_load_dwordx4 v15, s[36:39], s76 offen offset:1024 nt lds
v_mfma_f32_16x16x32_bf16 v[72:75], a[96:99], a[16:19], v[72:75]
v_mfma_f32_16x16x32_bf16 v[72:75], a[100:103], a[20:23], v[72:75]
v_mfma_f32_16x16x32_bf16 v[136:139], a[108:111], a[20:23], v[136:139]
v_mfma_f32_16x16x32_bf16 v[136:139], a[104:107], a[16:19], v[136:139]
v_mfma_f32_16x16x32_bf16 v[152:155], a[104:107], a[24:27], v[152:155]
v_mfma_f32_16x16x32_bf16 v[152:155], a[108:111], a[28:31], v[152:155]
v_mfma_f32_16x16x32_bf16 v[88:91], a[100:103], a[28:31], v[88:91]
buffer_load_dwordx4 v16, s[36:39], s76 offen offset:2048 nt lds
v_mfma_f32_16x16x32_bf16 v[88:91], a[96:99], a[24:27], v[88:91]
s_waitcnt vmcnt(7) lgkmcnt(0)
s_barrier
v_mfma_f32_16x16x32_bf16 v[44:47], a[112:115], a[0:3], v[44:47]
ds_read_b64_tr_b16 a[64:65], v160 offset:49152
v_xor_b32 v192, 0x80008000, v192
v_mfma_f32_16x16x32_bf16 v[44:47], a[116:119], a[4:7], v[44:47]
ds_read_b64_tr_b16 a[66:67], v160 offset:50176
v_xor_b32 v193, 0x80008000, v193
v_mfma_f32_16x16x32_bf16 v[108:111], a[124:127], a[4:7], v[108:111]
ds_read_b64_tr_b16 a[68:69], v160 offset:57344
v_xor_b32 v194, 0x80008000, v194
v_mfma_f32_16x16x32_bf16 v[108:111], a[120:123], a[0:3], v[108:111]
ds_read_b64_tr_b16 a[70:71], v160 offset:58368
v_xor_b32 v195, 0x80008000, v195
v_mfma_f32_16x16x32_bf16 v[124:127], a[120:123], a[8:11], v[124:127]
ds_read_b128 a[32:35], v170 offset:0
v_xor_b32 v196, 0x80008000, v196
v_mfma_f32_16x16x32_bf16 v[124:127], a[124:127], a[12:15], v[124:127]
ds_read_b128 a[36:39], v171 offset:0
v_xor_b32 v197, 0x80008000, v197
v_mfma_f32_16x16x32_bf16 v[60:63], a[116:119], a[12:15], v[60:63]
ds_read_b64_tr_b16 a[72:73], v161 offset:49152
v_xor_b32 v198, 0x80008000, v198
v_mfma_f32_16x16x32_bf16 v[60:63], a[112:115], a[8:11], v[60:63]
ds_read_b64_tr_b16 a[74:75], v161 offset:50176
v_xor_b32 v199, 0x80008000, v199
v_mfma_f32_16x16x32_bf16 v[76:79], a[112:115], a[16:19], v[76:79]
ds_read_b64_tr_b16 a[76:77], v161 offset:57344
v_xor_b32 v200, 0x80008000, v200
v_mfma_f32_16x16x32_bf16 v[76:79], a[116:119], a[20:23], v[76:79]
ds_read_b64_tr_b16 a[78:79], v161 offset:58368
v_xor_b32 v201, 0x80008000, v201
v_mfma_f32_16x16x32_bf16 v[140:143], a[124:127], a[20:23], v[140:143]
ds_read_b128 a[40:43], v170 offset:2048
v_xor_b32 v202, 0x80008000, v202
v_mfma_f32_16x16x32_bf16 v[140:143], a[120:123], a[16:19], v[140:143]
ds_read_b128 a[44:47], v171 offset:2048
v_xor_b32 v203, 0x80008000, v203
v_mfma_f32_16x16x32_bf16 v[156:159], a[120:123], a[24:27], v[156:159]
ds_read_b128 a[48:51], v170 offset:4096
v_xor_b32 v204, 0x80008000, v204
v_mfma_f32_16x16x32_bf16 v[156:159], a[124:127], a[28:31], v[156:159]
ds_read_b128 a[52:55], v171 offset:4096
v_xor_b32 v205, 0x80008000, v205
v_mfma_f32_16x16x32_bf16 v[92:95], a[116:119], a[28:31], v[92:95]
ds_read_b128 a[56:59], v170 offset:6144
v_xor_b32 v206, 0x80008000, v206
v_mfma_f32_16x16x32_bf16 v[92:95], a[112:115], a[24:27], v[92:95]
s_waitcnt lgkmcnt(9)
ds_read_b128 a[60:63], v171 offset:6144
v_xor_b32 v207, 0x80008000, v207
v_mfma_f32_16x16x32_bf16 v[32:35], a[64:67], a[32:35], v[32:35]
ds_read_b64_tr_b16 a[80:81], v162 offset:49152
v_mfma_f32_16x16x32_bf16 v[32:35], a[68:71], a[36:39], v[32:35]
s_waitcnt lgkmcnt(7)
s_xor_b32 s76, s67, 16384
ds_read_b64_tr_b16 a[82:83], v162 offset:50176
v_mfma_f32_16x16x32_bf16 v[96:99], a[76:79], a[36:39], v[96:99]
s_add_u32 m0, s69, 32768
ds_read_b64_tr_b16 a[84:85], v162 offset:57344
v_mfma_f32_16x16x32_bf16 v[96:99], a[72:75], a[32:35], v[96:99]
s_waitcnt lgkmcnt(7)
buffer_load_dwordx4 v17, s[36:39], s76 offen offset:3072 nt lds
v_mfma_f32_16x16x32_bf16 v[112:115], a[72:75], a[40:43], v[112:115]
ds_read_b64_tr_b16 a[86:87], v162 offset:58368
v_mfma_f32_16x16x32_bf16 v[112:115], a[76:79], a[44:47], v[112:115]
s_xor_b32 s76, s67, 0
ds_read_b64_tr_b16 a[88:89], v163 offset:49152
v_mfma_f32_16x16x32_bf16 v[48:51], a[68:71], a[44:47], v[48:51]
s_add_u32 m0, s69, 65536
ds_read_b64_tr_b16 a[90:91], v163 offset:50176
v_mfma_f32_16x16x32_bf16 v[48:51], a[64:67], a[40:43], v[48:51]
s_waitcnt lgkmcnt(8)
buffer_load_dwordx4 v18, s[40:43], s76 offen nt lds
v_mfma_f32_16x16x32_bf16 v[64:67], a[64:67], a[48:51], v[64:67]
ds_read_b64_tr_b16 a[92:93], v163 offset:57344
v_mfma_f32_16x16x32_bf16 v[64:67], a[68:71], a[52:55], v[64:67]
ds_read_b64_tr_b16 a[94:95], v163 offset:58368
v_mul_f32 v32, s72, v32
v_mul_f32 v33, s72, v33
v_mul_f32 v34, s72, v34
v_mfma_f32_16x16x32_bf16 v[128:131], a[76:79], a[52:55], v[128:131]
ds_read_b64_tr_b16 a[96:97], v164 offset:49152
v_mul_f32 v35, s72, v35
v_mul_f32 v96, s72, v96
v_mul_f32 v97, s72, v97
v_mfma_f32_16x16x32_bf16 v[128:131], a[72:75], a[48:51], v[128:131]
s_waitcnt lgkmcnt(9)
v_mul_f32 v98, s72, v98
v_mul_f32 v99, s72, v99
v_cvt_pk_bf16_f32 v32, v32, v33
v_cvt_pk_bf16_f32 v33, v34, v35
v_mfma_f32_16x16x32_bf16 v[144:147], a[72:75], a[56:59], v[144:147]
ds_read_b64_tr_b16 a[98:99], v164 offset:50176
v_cvt_pk_bf16_f32 v34, v96, v97
v_cvt_pk_bf16_f32 v35, v98, v99
v_mul_f32 v48, s72, v48
v_mfma_f32_16x16x32_bf16 v[144:147], a[76:79], a[60:63], v[144:147]
ds_read_b64_tr_b16 a[100:101], v164 offset:57344
v_mul_f32 v49, s72, v49
v_permlane16_swap_b32 v32, v34
v_mfma_f32_16x16x32_bf16 v[80:83], a[68:71], a[60:63], v[80:83]
ds_read_b64_tr_b16 a[102:103], v164 offset:58368
v_permlane16_swap_b32 v33, v35
v_mul_f32 v50, s72, v50
v_mfma_f32_16x16x32_bf16 v[80:83], a[64:67], a[56:59], v[80:83]
s_waitcnt lgkmcnt(4)
buffer_load_dwordx4 v19, s[40:43], s76 offen offset:1024 nt lds
v_mul_f32 v51, s72, v51
v_mul_f32 v112, s72, v112
v_mul_f32 v113, s72, v113
v_mfma_f32_16x16x32_bf16 v[36:39], a[80:83], a[32:35], v[36:39]
ds_read_b64_tr_b16 a[104:105], v165 offset:49152
v_mul_f32 v114, s72, v114
v_mul_f32 v115, s72, v115
v_cvt_pk_bf16_f32 v48, v48, v49
v_mfma_f32_16x16x32_bf16 v[36:39], a[84:87], a[36:39], v[36:39]
ds_read_b64_tr_b16 a[106:107], v165 offset:50176
v_cvt_pk_bf16_f32 v49, v50, v51
v_cvt_pk_bf16_f32 v50, v112, v113
v_cvt_pk_bf16_f32 v51, v114, v115
v_mfma_f32_16x16x32_bf16 v[100:103], a[92:95], a[36:39], v[100:103]
ds_read_b64_tr_b16 a[108:109], v165 offset:57344
v_mul_f32 v64, s72, v64
v_mul_f32 v65, s72, v65
v_mfma_f32_16x16x32_bf16 v[100:103], a[88:91], a[32:35], v[100:103]
v_permlane16_swap_b32 v48, v50
v_permlane16_swap_b32 v49, v51
v_mul_f32 v66, s72, v66
v_mfma_f32_16x16x32_bf16 v[116:119], a[88:91], a[40:43], v[116:119]
ds_read_b64_tr_b16 a[110:111], v165 offset:58368
v_mul_f32 v67, s72, v67
v_mul_f32 v128, s72, v128
v_mul_f32 v129, s72, v129
v_mfma_f32_16x16x32_bf16 v[116:119], a[92:95], a[44:47], v[116:119]
ds_read_b64_tr_b16 a[112:113], v166 offset:49152
v_mul_f32 v130, s72, v130
v_mul_f32 v131, s72, v131
v_cvt_pk_bf16_f32 v64, v64, v65
v_mfma_f32_16x16x32_bf16 v[52:55], a[84:87], a[44:47], v[52:55]
ds_read_b64_tr_b16 a[114:115], v166 offset:50176
v_cvt_pk_bf16_f32 v65, v66, v67
v_cvt_pk_bf16_f32 v66, v128, v129
v_cvt_pk_bf16_f32 v67, v130, v131
v_mul_f32 v80, s72, v80
v_mfma_f32_16x16x32_bf16 v[52:55], a[80:83], a[40:43], v[52:55]
buffer_load_dwordx4 v18, s[40:43], s76 offen offset:2048 nt lds
v_mul_f32 v81, s72, v81
v_mfma_f32_16x16x32_bf16 v[68:71], a[80:83], a[48:51], v[68:71]
ds_read_b64_tr_b16 a[116:117], v166 offset:57344
v_permlane16_swap_b32 v64, v66
v_permlane16_swap_b32 v65, v67
v_mfma_f32_16x16x32_bf16 v[68:71], a[84:87], a[52:55], v[68:71]
ds_read_b64_tr_b16 a[118:119], v166 offset:58368
v_mul_f32 v82, s72, v82
v_mul_f32 v83, s72, v83
v_mul_f32 v144, s72, v144
v_mfma_f32_16x16x32_bf16 v[132:135], a[92:95], a[52:55], v[132:135]
ds_read_b64_tr_b16 a[120:121], v167 offset:49152
v_mul_f32 v145, s72, v145
v_mul_f32 v146, s72, v146
v_mul_f32 v147, s72, v147
v_mfma_f32_16x16x32_bf16 v[132:135], a[88:91], a[48:51], v[132:135]
v_cvt_pk_bf16_f32 v80, v80, v81
v_cvt_pk_bf16_f32 v81, v82, v83
v_cvt_pk_bf16_f32 v82, v144, v145
v_cvt_pk_bf16_f32 v83, v146, v147
v_mfma_f32_16x16x32_bf16 v[148:151], a[88:91], a[56:59], v[148:151]
ds_read_b64_tr_b16 a[122:123], v167 offset:50176
v_mul_f32 v36, s72, v36
v_mul_f32 v37, s72, v37
v_permlane16_swap_b32 v80, v82
v_mfma_f32_16x16x32_bf16 v[148:151], a[92:95], a[60:63], v[148:151]
ds_read_b64_tr_b16 a[124:125], v167 offset:57344
v_permlane16_swap_b32 v81, v83
v_mul_f32 v38, s72, v38
v_mfma_f32_16x16x32_bf16 v[84:87], a[84:87], a[60:63], v[84:87]
ds_read_b64_tr_b16 a[126:127], v167 offset:58368
v_mul_f32 v39, s72, v39
v_mul_f32 v100, s72, v100
v_mul_f32 v101, s72, v101
v_mfma_f32_16x16x32_bf16 v[84:87], a[80:83], a[56:59], v[84:87]
s_waitcnt lgkmcnt(8)
buffer_load_dwordx4 v19, s[40:43], s76 offen offset:3072 nt lds
v_mul_f32 v102, s72, v102
v_mul_f32 v103, s72, v103
v_mfma_f32_16x16x32_bf16 v[40:43], a[96:99], a[32:35], v[40:43]
v_cvt_pk_bf16_f32 v36, v36, v37
v_cvt_pk_bf16_f32 v37, v38, v39
v_cvt_pk_bf16_f32 v38, v100, v101
v_cvt_pk_bf16_f32 v39, v102, v103
v_mfma_f32_16x16x32_bf16 v[40:43], a[100:103], a[36:39], v[40:43]
v_mul_f32 v52, s72, v52
v_mul_f32 v53, s72, v53
v_permlane16_swap_b32 v36, v38
v_mfma_f32_16x16x32_bf16 v[104:107], a[108:111], a[36:39], v[104:107]
v_permlane16_swap_b32 v37, v39
v_mul_f32 v54, s72, v54
v_mul_f32 v55, s72, v55
v_mfma_f32_16x16x32_bf16 v[104:107], a[104:107], a[32:35], v[104:107]
v_mul_f32 v116, s72, v116
v_mul_f32 v117, s72, v117
v_mul_f32 v118, s72, v118
v_mul_f32 v119, s72, v119
v_cvt_pk_bf16_f32 v52, v52, v53
v_mfma_f32_16x16x32_bf16 v[120:123], a[104:107], a[40:43], v[120:123]
v_cvt_pk_bf16_f32 v53, v54, v55
v_cvt_pk_bf16_f32 v54, v116, v117
v_cvt_pk_bf16_f32 v55, v118, v119
v_mul_f32 v68, s72, v68
v_mfma_f32_16x16x32_bf16 v[120:123], a[108:111], a[44:47], v[120:123]
s_xor_b32 s76, s67, 81920
v_mul_f32 v69, s72, v69
v_permlane16_swap_b32 v52, v54
v_mfma_f32_16x16x32_bf16 v[56:59], a[100:103], a[44:47], v[56:59]
s_add_u32 m0, s69, 49152
v_permlane16_swap_b32 v53, v55
v_mul_f32 v70, s72, v70
v_mul_f32 v71, s72, v71
v_mul_f32 v132, s72, v132
v_mfma_f32_16x16x32_bf16 v[56:59], a[96:99], a[40:43], v[56:59]
buffer_load_dwordx4 v14, s[36:39], s76 offen nt lds
v_mul_f32 v133, s72, v133
v_mul_f32 v134, s72, v134
v_mfma_f32_16x16x32_bf16 v[72:75], a[96:99], a[48:51], v[72:75]
v_mul_f32 v135, s72, v135
v_cvt_pk_bf16_f32 v68, v68, v69
v_cvt_pk_bf16_f32 v69, v70, v71
v_cvt_pk_bf16_f32 v70, v132, v133
v_mfma_f32_16x16x32_bf16 v[72:75], a[100:103], a[52:55], v[72:75]
v_cvt_pk_bf16_f32 v71, v134, v135
v_mul_f32 v84, s72, v84
v_mul_f32 v85, s72, v85
v_mfma_f32_16x16x32_bf16 v[136:139], a[108:111], a[52:55], v[136:139]
v_permlane16_swap_b32 v68, v70
v_permlane16_swap_b32 v69, v71
v_mul_f32 v86, s72, v86
v_mul_f32 v87, s72, v87
v_mfma_f32_16x16x32_bf16 v[136:139], a[104:107], a[48:51], v[136:139]
v_mul_f32 v148, s72, v148
v_mul_f32 v149, s72, v149
v_mul_f32 v150, s72, v150
v_mul_f32 v151, s72, v151
v_mfma_f32_16x16x32_bf16 v[152:155], a[104:107], a[56:59], v[152:155]
v_cvt_pk_bf16_f32 v84, v84, v85
v_cvt_pk_bf16_f32 v85, v86, v87
v_cvt_pk_bf16_f32 v86, v148, v149
v_cvt_pk_bf16_f32 v87, v150, v151
v_mfma_f32_16x16x32_bf16 v[152:155], a[108:111], a[60:63], v[152:155]
v_mul_f32 v40, s72, v40
v_mul_f32 v41, s72, v41
v_permlane16_swap_b32 v84, v86
v_mfma_f32_16x16x32_bf16 v[88:91], a[100:103], a[60:63], v[88:91]
buffer_load_dwordx4 v15, s[36:39], s76 offen offset:1024 nt lds
v_permlane16_swap_b32 v85, v87
v_mfma_f32_16x16x32_bf16 v[88:91], a[96:99], a[56:59], v[88:91]
s_waitcnt lgkmcnt(0)
s_barrier
v_mul_f32 v42, s72, v42
v_mul_f32 v43, s72, v43
v_mul_f32 v104, s72, v104
v_mul_f32 v105, s72, v105
v_mfma_f32_16x16x32_bf16 v[44:47], a[112:115], a[32:35], v[44:47]
v_mul_f32 v106, s72, v106
v_mul_f32 v107, s72, v107
v_cvt_pk_bf16_f32 v40, v40, v41
v_cvt_pk_bf16_f32 v41, v42, v43
v_cvt_pk_bf16_f32 v42, v104, v105
v_mfma_f32_16x16x32_bf16 v[44:47], a[116:119], a[36:39], v[44:47]
v_cvt_pk_bf16_f32 v43, v106, v107
v_mul_f32 v56, s72, v56
v_mul_f32 v57, s72, v57
v_mfma_f32_16x16x32_bf16 v[108:111], a[124:127], a[36:39], v[108:111]
v_permlane16_swap_b32 v40, v42
v_permlane16_swap_b32 v41, v43
v_mul_f32 v58, s72, v58
v_mfma_f32_16x16x32_bf16 v[108:111], a[120:123], a[32:35], v[108:111]
v_mul_f32 v59, s72, v59
v_mul_f32 v120, s72, v120
v_mul_f32 v121, s72, v121
v_mul_f32 v122, s72, v122
v_mfma_f32_16x16x32_bf16 v[124:127], a[120:123], a[40:43], v[124:127]
v_mul_f32 v123, s72, v123
v_cvt_pk_bf16_f32 v56, v56, v57
v_cvt_pk_bf16_f32 v57, v58, v59
v_cvt_pk_bf16_f32 v58, v120, v121
v_mfma_f32_16x16x32_bf16 v[124:127], a[124:127], a[44:47], v[124:127]
v_cvt_pk_bf16_f32 v59, v122, v123
v_mul_f32 v72, s72, v72
v_mul_f32 v73, s72, v73
v_mfma_f32_16x16x32_bf16 v[60:63], a[116:119], a[44:47], v[60:63]
v_permlane16_swap_b32 v56, v58
v_permlane16_swap_b32 v57, v59
v_mul_f32 v74, s72, v74
v_mfma_f32_16x16x32_bf16 v[60:63], a[112:115], a[40:43], v[60:63]
v_mul_f32 v75, s72, v75
v_mul_f32 v136, s72, v136
v_mul_f32 v137, s72, v137
v_mul_f32 v138, s72, v138
v_mul_f32 v139, s72, v139
v_mfma_f32_16x16x32_bf16 v[76:79], a[112:115], a[48:51], v[76:79]
v_cvt_pk_bf16_f32 v72, v72, v73
v_cvt_pk_bf16_f32 v73, v74, v75
v_cvt_pk_bf16_f32 v74, v136, v137
v_cvt_pk_bf16_f32 v75, v138, v139
v_mfma_f32_16x16x32_bf16 v[76:79], a[116:119], a[52:55], v[76:79]
v_mul_f32 v88, s72, v88
v_mul_f32 v89, s72, v89
v_permlane16_swap_b32 v72, v74
v_mfma_f32_16x16x32_bf16 v[140:143], a[124:127], a[52:55], v[140:143]
v_permlane16_swap_b32 v73, v75
v_mul_f32 v90, s72, v90
v_mul_f32 v91, s72, v91
v_mfma_f32_16x16x32_bf16 v[140:143], a[120:123], a[48:51], v[140:143]
v_mul_f32 v152, s72, v152
v_mul_f32 v153, s72, v153
v_mul_f32 v154, s72, v154
v_mul_f32 v155, s72, v155
v_mfma_f32_16x16x32_bf16 v[156:159], a[120:123], a[56:59], v[156:159]
v_cvt_pk_bf16_f32 v88, v88, v89
v_cvt_pk_bf16_f32 v89, v90, v91
v_cvt_pk_bf16_f32 v90, v152, v153
v_cvt_pk_bf16_f32 v91, v154, v155
v_mfma_f32_16x16x32_bf16 v[156:159], a[124:127], a[60:63], v[156:159]
v_mul_f32 v44, s72, v44
v_mul_f32 v45, s72, v45
v_permlane16_swap_b32 v88, v90
v_mfma_f32_16x16x32_bf16 v[92:95], a[116:119], a[60:63], v[92:95]
v_permlane16_swap_b32 v89, v91
v_mul_f32 v46, s72, v46
v_mul_f32 v47, s72, v47
v_mul_f32 v108, s72, v108
v_mfma_f32_16x16x32_bf16 v[92:95], a[112:115], a[56:59], v[92:95]
v_mul_f32 v109, s72, v109
v_mul_f32 v110, s72, v110
v_mul_f32 v111, s72, v111
v_cvt_pk_bf16_f32 v44, v44, v45
v_mfma_f32_16x16x32_bf16 v[240:243], v[192:195], v[32:35], 0
s_xor_b32 s76, s67, 81920
ds_read_b128 a[224:227], v2 offset:0
v_cvt_pk_bf16_f32 v45, v46, v47
v_cvt_pk_bf16_f32 v46, v108, v109
v_cvt_pk_bf16_f32 v47, v110, v111
v_mfma_f32_16x16x32_bf16 v[244:247], v[192:195], v[48:51], 0
s_add_u32 m0, s69, 49152
ds_read_b128 a[228:231], v3 offset:0
v_mul_f32 v60, s72, v60
v_mul_f32 v61, s72, v61
v_mfma_f32_16x16x32_bf16 v[248:251], v[192:195], v[64:67], 0
s_bfe_u32 s4, s2, 0x10002
ds_read_b128 a[232:235], v4 offset:0
v_permlane16_swap_b32 v44, v46
v_permlane16_swap_b32 v45, v47
v_mfma_f32_16x16x32_bf16 v[252:255], v[192:195], v[80:83], 0
s_and_b32 s5, s2, 1
ds_read_b128 a[236:239], v5 offset:0
v_mul_f32 v62, s72, v62
v_mul_f32 v63, s72, v63
v_mul_f32 v124, s72, v124
v_mfma_f32_16x16x32_bf16 v[240:243], v[196:199], v[36:39], v[240:243]
s_lshl1_add_u32 s4, s4, s5
v_mul_f32 v125, s72, v125
v_mul_f32 v126, s72, v126
v_mul_f32 v127, s72, v127
v_cvt_pk_bf16_f32 v60, v60, v61
v_cvt_pk_bf16_f32 v61, v62, v63
v_mfma_f32_16x16x32_bf16 v[244:247], v[196:199], v[52:55], v[244:247]
s_bfe_u32 s5, s2, 0x20003
v_cvt_pk_bf16_f32 v62, v124, v125
v_cvt_pk_bf16_f32 v63, v126, v127
v_mul_f32 v76, s72, v76
v_mul_f32 v77, s72, v77
v_mfma_f32_16x16x32_bf16 v[248:251], v[196:199], v[68:71], v[248:251]
s_lshl2_add_u32 s4, s4, s5
v_permlane16_swap_b32 v60, v62
v_permlane16_swap_b32 v61, v63
v_mfma_f32_16x16x32_bf16 v[252:255], v[196:199], v[84:87], v[252:255]
s_lshr_b32 s7, s2, 5
v_mul_f32 v78, s72, v78
v_mul_f32 v79, s72, v79
v_mul_f32 v140, s72, v140
v_mul_f32 v141, s72, v141
v_mfma_f32_16x16x32_bf16 v[240:243], v[200:203], v[40:43], v[240:243]
s_bfe_u32 s5, s2, 0x10001
v_mul_f32 v142, s72, v142
v_mul_f32 v143, s72, v143
v_cvt_pk_bf16_f32 v76, v76, v77
v_cvt_pk_bf16_f32 v77, v78, v79
v_mfma_f32_16x16x32_bf16 v[244:247], v[200:203], v[56:59], v[244:247]
s_lshl1_add_u32 s6, s4, s5
v_cvt_pk_bf16_f32 v78, v140, v141
v_cvt_pk_bf16_f32 v79, v142, v143
v_mul_f32 v92, s72, v92
v_mul_f32 v93, s72, v93
v_mfma_f32_16x16x32_bf16 v[248:251], v[200:203], v[72:75], v[248:251]
s_xor_b32 s4, s6, 1
v_permlane16_swap_b32 v76, v78
v_permlane16_swap_b32 v77, v79
v_mfma_f32_16x16x32_bf16 v[252:255], v[200:203], v[88:91], v[252:255]
s_lshl_b32 s32, s4, 19
v_mul_f32 v94, s72, v94
v_mul_f32 v95, s72, v95
v_mul_f32 v156, s72, v156
v_mul_f32 v157, s72, v157
v_mul_f32 v158, s72, v158
v_mfma_f32_16x16x32_bf16 v[240:243], v[204:207], v[44:47], v[240:243]
s_add_u32 s32, s32, s69
v_mul_f32 v159, s72, v159
v_cvt_pk_bf16_f32 v92, v92, v93
v_cvt_pk_bf16_f32 v93, v94, v95
v_cvt_pk_bf16_f32 v94, v156, v157
v_mfma_f32_16x16x32_bf16 v[244:247], v[204:207], v[60:63], v[244:247]
s_lshl_b32 s26, s6, 19
v_cvt_pk_bf16_f32 v95, v158, v159
s_nop 1
v_mfma_f32_16x16x32_bf16 v[248:251], v[204:207], v[76:79], v[248:251]
s_add_u32 s26, s26, s69
v_permlane16_swap_b32 v92, v94
v_permlane16_swap_b32 v93, v95
s_nop 1
v_mfma_f32_16x16x32_bf16 v[252:255], v[204:207], v[92:95], v[252:255]
s_waitcnt lgkmcnt(0)
s_cmp_lg_u32 s73, 0
s_cbranch_scc1 L_maxpass
L_rerun:
v_mfma_f32_16x16x32_bf16 v[160:163], a[224:227], v[32:35], v[240:243]
s_mul_i32 s33, s7, 655360
ds_read_b128 a[240:243], v2 offset:4096
v_mfma_f32_16x16x32_bf16 v[160:163], a[228:231], v[36:39], v[160:163]
s_mul_i32 s5, s60, 5120
ds_read_b128 a[244:247], v3 offset:4096
v_mfma_f32_16x16x32_bf16 v[160:163], a[232:235], v[40:43], v[160:163]
buffer_load_dwordx4 v16, s[36:39], s76 offen offset:2048 nt lds
v_mfma_f32_16x16x32_bf16 v[160:163], a[236:239], v[44:47], v[160:163]
s_add_u32 s33, s33, s5
ds_read_b128 a[248:251], v4 offset:4096
v_mfma_f32_16x16x32_bf16 v[168:171], a[236:239], v[60:63], v[244:247]
s_add_u32 s33, s33, 16777216
ds_read_b128 a[252:255], v5 offset:4096
v_mfma_f32_16x16x32_bf16 v[168:171], a[232:235], v[56:59], v[168:171]
s_mul_i32 s5, s24, 5
v_mfma_f32_16x16x32_bf16 v[168:171], a[228:231], v[52:55], v[168:171]
s_add_u32 s16, s5, s33
v_mfma_f32_16x16x32_bf16 v[168:171], a[224:227], v[48:51], v[168:171]
s_mul_i32 s5, s25, 5
v_mfma_f32_16x16x32_bf16 v[176:179], a[224:227], v[64:67], v[248:251]
s_add_u32 s17, s5, s33
v_mfma_f32_16x16x32_bf16 v[176:179], a[228:231], v[68:71], v[176:179]
s_lshl2_add_u32 s18, s24, s32
v_mfma_f32_16x16x32_bf16 v[176:179], a[232:235], v[72:75], v[176:179]
s_lshl2_add_u32 s19, s25, s32
v_exp_f32 v224, v160
v_mfma_f32_16x16x32_bf16 v[176:179], a[236:239], v[76:79], v[176:179]
s_lshl2_add_u32 s20, s24, s26
v_exp_f32 v225, v161
v_mfma_f32_16x16x32_bf16 v[184:187], a[236:239], v[92:95], v[252:255]
s_lshl2_add_u32 s21, s25, s26
v_cvt_pk_bf16_f32 v128, v224, v225
v_mfma_f32_16x16x32_bf16 v[184:187], a[232:235], v[88:91], v[184:187]
s_lshr_b32 s28, s24, 4
v_exp_f32 v226, v162
v_mfma_f32_16x16x32_bf16 v[184:187], a[228:231], v[84:87], v[184:187]
s_lshl_b32 s5, s4, 14
v_mfma_f32_16x16x32_bf16 v[184:187], a[224:227], v[80:83], v[184:187]
s_waitcnt lgkmcnt(0)
v_exp_f32 v227, v163
v_mfma_f32_16x16x32_bf16 v[188:191], a[240:243], v[80:83], v[252:255]
L_hop0_2:
s_cbranch_execz L_hop_ret0
s_add_u32 s28, s28, s5
v_exp_f32 v228, v168
v_mfma_f32_16x16x32_bf16 v[188:191], a[244:247], v[84:87], v[188:191]
s_add_u32 s28, s28, 25165824
ds_read_b128 a[224:227], v2 offset:8192
v_cvt_pk_bf16_f32 v129, v226, v227
v_mfma_f32_16x16x32_bf16 v[188:191], a[248:251], v[88:91], v[188:191]
s_xor_b32 s31, s28, 16384
v_exp_f32 v229, v169
v_mfma_f32_16x16x32_bf16 v[188:191], a[252:255], v[92:95], v[188:191]
s_lshl3_add_u32 s5, s4, s7
ds_read_b128 a[228:231], v3 offset:8192
v_cvt_pk_bf16_f32 v132, v228, v229
v_mfma_f32_16x16x32_bf16 v[180:183], a[252:255], v[76:79], v[248:251]
s_lshl2_add_u32 s5, s5, s60
v_exp_f32 v230, v170
v_mfma_f32_16x16x32_bf16 v[180:183], a[248:251], v[72:75], v[180:183]
s_mul_i32 s64, s5, 5120
v_exp_f32 v231, v171
v_mfma_f32_16x16x32_bf16 v[180:183], a[244:247], v[68:71], v[180:183]
s_add_u32 s64, s64, 27262976
ds_read_b128 a[232:235], v4 offset:8192
v_cvt_pk_bf16_f32 v133, v230, v231
v_mfma_f32_16x16x32_bf16 v[180:183], a[240:243], v[64:67], v[180:183]
s_lshl_b32 s63, s5, 8
v_exp_f32 v224, v176
v_mfma_f32_16x16x32_bf16 v[172:175], a[240:243], v[48:51], v[244:247]
s_add_u32 s63, s63, 25690112
ds_read_b128 a[236:239], v5 offset:8192
v_mfma_f32_16x16x32_bf16 v[172:175], a[244:247], v[52:55], v[172:175]
s_xor_b32 s5, s5, 32
v_exp_f32 v225, v177
v_mfma_f32_16x16x32_bf16 v[172:175], a[248:251], v[56:59], v[172:175]
s_mul_i32 s65, s5, 5120
v_exp_f32 v226, v178
v_mfma_f32_16x16x32_bf16 v[172:175], a[252:255], v[60:63], v[172:175]
buffer_load_dwordx4 v17, s[36:39], s76 offen offset:3072 nt lds
v_mfma_f32_16x16x32_bf16 v[164:167], a[252:255], v[44:47], v[240:243]
s_xor_b32 s76, s67, 65536
v_exp_f32 v227, v179
v_mfma_f32_16x16x32_bf16 v[164:167], a[248:251], v[40:43], v[164:167]
s_add_u32 m0, s69, 98304
v_cvt_pk_bf16_f32 v136, v224, v225
v_mfma_f32_16x16x32_bf16 v[164:167], a[244:247], v[36:39], v[164:167]
s_add_u32 s65, s65, 27262976
v_exp_f32 v228, v184
v_mfma_f32_16x16x32_bf16 v[164:167], a[240:243], v[32:35], v[164:167]
s_waitcnt lgkmcnt(0)
v_exp_f32 v229, v185
v_mfma_f32_16x16x32_bf16 v[96:99], a[224:227], v[32:35], v[240:243]
s_xor_b32 s46, s63, 8192
ds_read_b128 a[240:243], v2 offset:12288
v_cvt_pk_bf16_f32 v137, v226, v227
v_mfma_f32_16x16x32_bf16 v[96:99], a[228:231], v[36:39], v[96:99]
s_and_b32 s5, s6, -2
v_exp_f32 v230, v186
v_mfma_f32_16x16x32_bf16 v[96:99], a[232:235], v[40:43], v[96:99]
s_lshr_b32 s4, s60, 1
ds_read_b128 a[244:247], v3 offset:12288
v_cvt_pk_bf16_f32 v140, v228, v229
v_mfma_f32_16x16x32_bf16 v[96:99], a[236:239], v[44:47], v[96:99]
s_add_u32 s5, s5, s4
v_exp_f32 v231, v187
v_mfma_f32_16x16x32_bf16 v[104:107], a[236:239], v[60:63], v[244:247]
s_and_b32 s4, s6, 1
v_exp_f32 v224, v188
v_mfma_f32_16x16x32_bf16 v[104:107], a[232:235], v[56:59], v[104:107]
s_lshl1_add_u32 s5, s5, s4
ds_read_b128 a[248:251], v4 offset:12288
v_cvt_pk_bf16_f32 v141, v230, v231
v_mfma_f32_16x16x32_bf16 v[104:107], a[228:231], v[52:55], v[104:107]
s_and_b32 s4, s60, 1
v_exp_f32 v225, v189
v_mfma_f32_16x16x32_bf16 v[104:107], a[224:227], v[48:51], v[104:107]
s_lshl1_add_u32 s35, s5, s4
ds_read_b128 a[252:255], v5 offset:12288
v_cvt_pk_bf16_f32 v142, v224, v225
v_mfma_f32_16x16x32_bf16 v[112:115], a[224:227], v[64:67], v[248:251]
s_mul_i32 s35, s35, 20480
v_exp_f32 v226, v190
v_mfma_f32_16x16x32_bf16 v[112:115], a[228:231], v[68:71], v[112:115]
s_mul_i32 s7, s7, 160
v_exp_f32 v227, v191
v_mfma_f32_16x16x32_bf16 v[112:115], a[232:235], v[72:75], v[112:115]
buffer_load_dwordx4 v18, s[40:43], s76 offen nt lds
v_mfma_f32_16x16x32_bf16 v[112:115], a[236:239], v[76:79], v[112:115]
s_add_u32 s35, s35, s7
v_exp_f32 v228, v180
v_mfma_f32_16x16x32_bf16 v[120:123], a[236:239], v[92:95], v[252:255]
v_cvt_pk_bf16_f32 v143, v226, v227
v_mfma_f32_16x16x32_bf16 v[120:123], a[232:235], v[88:91], v[120:123]
v_exp_f32 v229, v181
v_mfma_f32_16x16x32_bf16 v[120:123], a[228:231], v[84:87], v[120:123]
v_exp_f32 v230, v182
v_mfma_f32_16x16x32_bf16 v[120:123], a[224:227], v[80:83], v[120:123]
s_waitcnt lgkmcnt(0)
v_cvt_pk_bf16_f32 v138, v228, v229
v_mfma_f32_16x16x32_bf16 v[124:127], a[240:243], v[80:83], v[252:255]
v_exp_f32 v231, v183
v_mfma_f32_16x16x32_bf16 v[124:127], a[244:247], v[84:87], v[124:127]
s_waitcnt vmcnt(13)
s_barrier
ds_read_b128 a[224:227], v2 offset:16384
v_mfma_f32_16x16x32_bf16 v[124:127], a[248:251], v[88:91], v[124:127]
s_xor_b32 s76, s67, 65536
v_exp_f32 v224, v172
v_mfma_f32_16x16x32_bf16 v[124:127], a[252:255], v[92:95], v[124:127]
s_add_u32 m0, s69, 98304
v_exp_f32 v225, v173
v_mfma_f32_16x16x32_bf16 v[116:119], a[252:255], v[76:79], v[248:251]
ds_read_b128 a[228:231], v3 offset:16384
v_cvt_pk_bf16_f32 v139, v230, v231
v_mfma_f32_16x16x32_bf16 v[116:119], a[248:251], v[72:75], v[116:119]
v_exp_f32 v226, v174
v_mfma_f32_16x16x32_bf16 v[116:119], a[244:247], v[68:71], v[116:119]
ds_read_b128 a[232:235], v4 offset:16384
v_cvt_pk_bf16_f32 v134, v224, v225
v_mfma_f32_16x16x32_bf16 v[116:119], a[240:243], v[64:67], v[116:119]
v_exp_f32 v227, v175
v_mfma_f32_16x16x32_bf16 v[108:111], a[240:243], v[48:51], v[244:247]
v_exp_f32 v228, v164
v_mfma_f32_16x16x32_bf16 v[108:111], a[244:247], v[52:55], v[108:111]
ds_read_b128 a[236:239], v5 offset:16384
v_cvt_pk_bf16_f32 v135, v226, v227
v_mfma_f32_16x16x32_bf16 v[108:111], a[248:251], v[56:59], v[108:111]
v_exp_f32 v229, v165
v_mfma_f32_16x16x32_bf16 v[108:111], a[252:255], v[60:63], v[108:111]
buffer_load_dwordx4 v19, s[40:43], s76 offen offset:1024 nt lds
v_mfma_f32_16x16x32_bf16 v[100:103], a[252:255], v[44:47], v[240:243]
v_exp_f32 v230, v166
v_mfma_f32_16x16x32_bf16 v[100:103], a[248:251], v[40:43], v[100:103]
v_exp_f32 v231, v167
v_mfma_f32_16x16x32_bf16 v[100:103], a[244:247], v[36:39], v[100:103]
v_cvt_pk_bf16_f32 v130, v228, v229
v_mfma_f32_16x16x32_bf16 v[100:103], a[240:243], v[32:35], v[100:103]
s_waitcnt lgkmcnt(0)
v_cvt_pk_bf16_f32 v131, v230, v231
v_mfma_f32_16x16x32_bf16 v[160:163], a[224:227], v[32:35], v[240:243]
ds_read_b128 a[240:243], v2 offset:20480
v_exp_f32 v224, v96
v_mfma_f32_16x16x32_bf16 v[160:163], a[228:231], v[36:39], v[160:163]
ds_read_b128 a[244:247], v3 offset:20480
v_exp_f32 v225, v97
v_mfma_f32_16x16x32_bf16 v[160:163], a[232:235], v[40:43], v[160:163]
ds_read_b128 a[248:251], v4 offset:20480
v_cvt_pk_bf16_f32 v144, v224, v225
v_exp_f32 v226, v98
v_mfma_f32_16x16x32_bf16 v[160:163], a[236:239], v[44:47], v[160:163]
ds_read_b128 a[252:255], v5 offset:20480
v_exp_f32 v227, v99
v_mfma_f32_16x16x32_bf16 v[168:171], a[236:239], v[60:63], v[244:247]
v_cvt_pk_bf16_f32 v145, v226, v227
v_exp_f32 v228, v104
v_mfma_f32_16x16x32_bf16 v[168:171], a[232:235], v[56:59], v[168:171]
v_exp_f32 v229, v105
v_mfma_f32_16x16x32_bf16 v[168:171], a[228:231], v[52:55], v[168:171]
v_cvt_pk_bf16_f32 v148, v228, v229
v_exp_f32 v230, v106
v_mfma_f32_16x16x32_bf16 v[168:171], a[224:227], v[48:51], v[168:171]
v_exp_f32 v231, v107
v_mfma_f32_16x16x32_bf16 v[176:179], a[224:227], v[64:67], v[248:251]
buffer_load_dwordx4 v18, s[40:43], s76 offen offset:2048 nt lds
v_cvt_pk_bf16_f32 v149, v230, v231
v_exp_f32 v224, v112
v_mfma_f32_16x16x32_bf16 v[176:179], a[228:231], v[68:71], v[176:179]
v_exp_f32 v225, v113
v_mfma_f32_16x16x32_bf16 v[176:179], a[232:235], v[72:75], v[176:179]
v_cvt_pk_bf16_f32 v152, v224, v225
v_exp_f32 v226, v114
v_mfma_f32_16x16x32_bf16 v[176:179], a[236:239], v[76:79], v[176:179]
v_exp_f32 v227, v115
v_mfma_f32_16x16x32_bf16 v[184:187], a[236:239], v[92:95], v[252:255]
v_cvt_pk_bf16_f32 v153, v226, v227
v_exp_f32 v228, v120
v_mfma_f32_16x16x32_bf16 v[184:187], a[232:235], v[88:91], v[184:187]
v_exp_f32 v229, v121
v_mfma_f32_16x16x32_bf16 v[184:187], a[228:231], v[84:87], v[184:187]
v_cvt_pk_bf16_f32 v156, v228, v229
v_exp_f32 v230, v122
v_mfma_f32_16x16x32_bf16 v[184:187], a[224:227], v[80:83], v[184:187]
s_waitcnt lgkmcnt(0)
v_exp_f32 v231, v123
v_mfma_f32_16x16x32_bf16 v[188:191], a[240:243], v[80:83], v[252:255]
ds_read_b128 a[224:227], v2 offset:24576
v_cvt_pk_bf16_f32 v157, v230, v231
v_exp_f32 v224, v124
v_mfma_f32_16x16x32_bf16 v[188:191], a[244:247], v[84:87], v[188:191]
ds_read_b128 a[228:231], v3 offset:24576
v_exp_f32 v225, v125
v_mfma_f32_16x16x32_bf16 v[188:191], a[248:251], v[88:91], v[188:191]
ds_read_b128 a[232:235], v4 offset:24576
v_cvt_pk_bf16_f32 v158, v224, v225
v_exp_f32 v226, v126
v_mfma_f32_16x16x32_bf16 v[188:191], a[252:255], v[92:95], v[188:191]
ds_read_b128 a[236:239], v5 offset:24576
v_exp_f32 v227, v127
v_mfma_f32_16x16x32_bf16 v[180:183], a[252:255], v[76:79], v[248:251]
v_cvt_pk_bf16_f32 v159, v226, v227
v_exp_f32 v228, v116
v_mfma_f32_16x16x32_bf16 v[180:183], a[248:251], v[72:75], v[180:183]
v_exp_f32 v229, v117
v_mfma_f32_16x16x32_bf16 v[180:183], a[244:247], v[68:71], v[180:183]
v_cvt_pk_bf16_f32 v154, v228, v229
v_exp_f32 v230, v118
v_mfma_f32_16x16x32_bf16 v[180:183], a[240:243], v[64:67], v[180:183]
buffer_load_dwordx4 v19, s[40:43], s76 offen offset:3072 nt lds
v_exp_f32 v231, v119
v_mfma_f32_16x16x32_bf16 v[172:175], a[240:243], v[48:51], v[244:247]
s_xor_b32 s76, s67, 512
v_cvt_pk_bf16_f32 v155, v230, v231
v_exp_f32 v224, v108
v_mfma_f32_16x16x32_bf16 v[172:175], a[244:247], v[52:55], v[172:175]
s_add_u32 m0, s69, 0
v_exp_f32 v225, v109
v_mfma_f32_16x16x32_bf16 v[172:175], a[248:251], v[56:59], v[172:175]
v_cvt_pk_bf16_f32 v150, v224, v225
v_exp_f32 v226, v110
v_mfma_f32_16x16x32_bf16 v[172:175], a[252:255], v[60:63], v[172:175]
v_exp_f32 v227, v111
v_mfma_f32_16x16x32_bf16 v[164:167], a[252:255], v[44:47], v[240:243]
v_cvt_pk_bf16_f32 v151, v226, v227
v_exp_f32 v228, v100
v_mfma_f32_16x16x32_bf16 v[164:167], a[248:251], v[40:43], v[164:167]
v_exp_f32 v229, v101
v_mfma_f32_16x16x32_bf16 v[164:167], a[244:247], v[36:39], v[164:167]
v_cvt_pk_bf16_f32 v146, v228, v229
v_exp_f32 v230, v102
v_mfma_f32_16x16x32_bf16 v[164:167], a[240:243], v[32:35], v[164:167]
s_waitcnt lgkmcnt(0)
v_exp_f32 v231, v103
v_mfma_f32_16x16x32_bf16 v[96:99], a[224:227], v[32:35], v[240:243]
v_exp_f32 v224, v160
v_mfma_f32_16x16x32_bf16 v[96:99], a[228:231], v[36:39], v[96:99]
ds_read_b128 a[240:243], v2 offset:28672
v_cvt_pk_bf16_f32 v147, v230, v231
v_mfma_f32_16x16x32_bf16 v[96:99], a[232:235], v[40:43], v[96:99]
v_exp_f32 v225, v161
v_mfma_f32_16x16x32_bf16 v[96:99], a[236:239], v[44:47], v[96:99]
ds_read_b128 a[244:247], v3 offset:28672
v_cvt_pk_bf16_f32 v192, v224, v225
v_mfma_f32_16x16x32_bf16 v[104:107], a[236:239], v[60:63], v[244:247]
v_exp_f32 v226, v162
v_mfma_f32_16x16x32_bf16 v[104:107], a[232:235], v[56:59], v[104:107]
ds_read_b128 a[248:251], v4 offset:28672
v_mfma_f32_16x16x32_bf16 v[104:107], a[228:231], v[52:55], v[104:107]
v_exp_f32 v227, v163
v_mfma_f32_16x16x32_bf16 v[104:107], a[224:227], v[48:51], v[104:107]
buffer_load_dwordx4 v14, s[36:39], s76 offen nt lds
v_mfma_f32_16x16x32_bf16 v[112:115], a[224:227], v[64:67], v[248:251]
v_exp_f32 v228, v168
v_mfma_f32_16x16x32_bf16 v[112:115], a[228:231], v[68:71], v[112:115]
ds_read_b128 a[252:255], v5 offset:28672
v_cvt_pk_bf16_f32 v193, v226, v227
v_mfma_f32_16x16x32_bf16 v[112:115], a[232:235], v[72:75], v[112:115]
v_exp_f32 v229, v169
v_mfma_f32_16x16x32_bf16 v[112:115], a[236:239], v[76:79], v[112:115]
v_cvt_pk_bf16_f32 v196, v228, v229
v_mfma_f32_16x16x32_bf16 v[120:123], a[236:239], v[92:95], v[252:255]
v_exp_f32 v230, v170
v_mfma_f32_16x16x32_bf16 v[120:123], a[232:235], v[88:91], v[120:123]
v_mfma_f32_16x16x32_bf16 v[120:123], a[228:231], v[84:87], v[120:123]
v_exp_f32 v231, v171
v_mfma_f32_16x16x32_bf16 v[120:123], a[224:227], v[80:83], v[120:123]
s_waitcnt vmcnt(9) lgkmcnt(0)
s_barrier
ds_read_b64_tr_b16 a[224:225], v6 offset:0
v_mfma_f32_16x16x32_bf16 v[124:127], a[240:243], v[80:83], v[252:255]
s_xor_b32 s76, s67, 512
v_exp_f32 v224, v176
v_mfma_f32_16x16x32_bf16 v[124:127], a[244:247], v[84:87], v[124:127]
s_add_u32 m0, s69, 0
ds_read_b64_tr_b16 a[226:227], v6 offset:4096
v_cvt_pk_bf16_f32 v197, v230, v231
v_mfma_f32_16x16x32_bf16 v[124:127], a[248:251], v[88:91], v[124:127]
v_exp_f32 v225, v177
v_mfma_f32_16x16x32_bf16 v[124:127], a[252:255], v[92:95], v[124:127]
ds_read_b64_tr_b16 a[228:229], v6 offset:8192
v_cvt_pk_bf16_f32 v200, v224, v225
v_mfma_f32_16x16x32_bf16 v[116:119], a[252:255], v[76:79], v[248:251]
ds_read_b64_tr_b16 a[230:231], v6 offset:12288
v_mfma_f32_16x16x32_bf16 v[116:119], a[248:251], v[72:75], v[116:119]
v_exp_f32 v226, v178
v_mfma_f32_16x16x32_bf16 v[116:119], a[244:247], v[68:71], v[116:119]
buffer_load_dwordx4 v15, s[36:39], s76 offen offset:1024 nt lds
v_mfma_f32_16x16x32_bf16 v[116:119], a[240:243], v[64:67], v[116:119]
v_exp_f32 v227, v179
v_mfma_f32_16x16x32_bf16 v[108:111], a[240:243], v[48:51], v[244:247]
ds_read_b64_tr_b16 a[232:233], v7 offset:0
v_cvt_pk_bf16_f32 v201, v226, v227
v_mfma_f32_16x16x32_bf16 v[108:111], a[244:247], v[52:55], v[108:111]
v_exp_f32 v228, v184
v_mfma_f32_16x16x32_bf16 v[108:111], a[248:251], v[56:59], v[108:111]
ds_read_b64_tr_b16 a[234:235], v7 offset:4096
v_mfma_f32_16x16x32_bf16 v[108:111], a[252:255], v[60:63], v[108:111]
v_exp_f32 v229, v185
v_mfma_f32_16x16x32_bf16 v[100:103], a[252:255], v[44:47], v[240:243]
ds_read_b64_tr_b16 a[236:237], v7 offset:8192
v_cvt_pk_bf16_f32 v204, v228, v229
v_mfma_f32_16x16x32_bf16 v[100:103], a[248:251], v[40:43], v[100:103]
v_exp_f32 v230, v186
v_mfma_f32_16x16x32_bf16 v[100:103], a[244:247], v[36:39], v[100:103]
ds_read_b64_tr_b16 a[238:239], v7 offset:12288
v_mfma_f32_16x16x32_bf16 v[100:103], a[240:243], v[32:35], v[100:103]
s_waitcnt lgkmcnt(4)
ds_read_b64_tr_b16 a[240:241], v8 offset:0
v_mfma_f32_16x16x32_bf16 a[0:3], a[224:227], v[128:131], 0
v_exp_f32 v231, v187
v_mfma_f32_16x16x32_bf16 a[0:3], a[228:231], v[144:147], a[0:3]
ds_read_b64_tr_b16 a[242:243], v8 offset:4096
v_cvt_pk_bf16_f32 v205, v230, v231
v_mfma_f32_16x16x32_bf16 a[4:7], a[228:231], v[148:151], 0
v_exp_f32 v224, v188
v_mfma_f32_16x16x32_bf16 a[4:7], a[224:227], v[132:135], a[4:7]
buffer_load_dwordx4 v16, s[36:39], s76 offen offset:2048 nt lds
v_mfma_f32_16x16x32_bf16 a[8:11], a[224:227], v[136:139], 0
v_exp_f32 v225, v189
v_mfma_f32_16x16x32_bf16 a[8:11], a[228:231], v[152:155], a[8:11]
ds_read_b64_tr_b16 a[244:245], v8 offset:8192
v_cvt_pk_bf16_f32 v206, v224, v225
v_mfma_f32_16x16x32_bf16 a[12:15], a[228:231], v[156:159], 0
v_exp_f32 v226, v190
v_mfma_f32_16x16x32_bf16 a[12:15], a[224:227], v[140:143], a[12:15]
s_waitcnt lgkmcnt(3)
ds_read_b64_tr_b16 a[246:247], v8 offset:12288
v_mfma_f32_16x16x32_bf16 a[28:31], a[232:235], v[140:143], 0
v_exp_f32 v227, v191
v_mfma_f32_16x16x32_bf16 a[28:31], a[236:239], v[156:159], a[28:31]
ds_read_b64_tr_b16 a[248:249], v9 offset:0
v_cvt_pk_bf16_f32 v207, v226, v227
v_mfma_f32_16x16x32_bf16 a[24:27], a[236:239], v[152:155], 0
ds_read_b64_tr_b16 a[250:251], v9 offset:4096
v_mfma_f32_16x16x32_bf16 a[24:27], a[232:235], v[136:139], a[24:27]
v_exp_f32 v228, v180
v_mfma_f32_16x16x32_bf16 a[20:23], a[232:235], v[132:135], 0
ds_read_b64_tr_b16 a[252:253], v9 offset:8192
v_mfma_f32_16x16x32_bf16 a[20:23], a[236:239], v[148:151], a[20:23]
v_exp_f32 v229, v181
v_mfma_f32_16x16x32_bf16 a[16:19], a[236:239], v[144:147], 0
buffer_store_dword v232, v235, s[52:55], s78 offen sc1
v_mfma_f32_16x16x32_bf16 a[16:19], a[232:235], v[128:131], a[16:19]
s_waitcnt lgkmcnt(3)
v_exp_f32 v230, v182
v_mfma_f32_16x16x32_bf16 a[32:35], a[240:243], v[128:131], 0
ds_read_b64_tr_b16 a[254:255], v9 offset:12288
v_cvt_pk_bf16_f32 v202, v228, v229
v_mfma_f32_16x16x32_bf16 a[32:35], a[244:247], v[144:147], a[32:35]
v_exp_f32 v231, v183
v_mfma_f32_16x16x32_bf16 a[36:39], a[244:247], v[148:151], 0
v_cvt_pk_bf16_f32 v203, v230, v231
v_mfma_f32_16x16x32_bf16 a[36:39], a[240:243], v[132:135], a[36:39]
v_exp_f32 v224, v172
v_mfma_f32_16x16x32_bf16 a[40:43], a[240:243], v[136:139], 0
ds_read_b128 a[224:227], v2 offset:32768
v_mfma_f32_16x16x32_bf16 a[40:43], a[244:247], v[152:155], a[40:43]
ds_read_b128 a[228:231], v3 offset:32768
v_mfma_f32_16x16x32_bf16 a[44:47], a[244:247], v[156:159], 0
v_exp_f32 v225, v173
v_mfma_f32_16x16x32_bf16 a[44:47], a[240:243], v[140:143], a[44:47]
s_waitcnt lgkmcnt(2)
ds_read_b128 a[232:235], v4 offset:32768
v_cvt_pk_bf16_f32 v198, v224, v225
v_mfma_f32_16x16x32_bf16 a[60:63], a[248:251], v[140:143], 0
v_exp_f32 v226, v174
v_mfma_f32_16x16x32_bf16 a[60:63], a[252:255], v[156:159], a[60:63]
ds_read_b128 a[236:239], v5 offset:32768
v_mfma_f32_16x16x32_bf16 a[56:59], a[252:255], v[152:155], 0
v_exp_f32 v227, v175
v_mfma_f32_16x16x32_bf16 a[56:59], a[248:251], v[136:139], a[56:59]
buffer_load_dwordx4 v17, s[36:39], s76 offen offset:3072 nt lds
v_mfma_f32_16x16x32_bf16 a[52:55], a[248:251], v[132:135], 0
s_xor_b32 s76, s67, 16384
v_exp_f32 v228, v164
v_mfma_f32_16x16x32_bf16 a[52:55], a[252:255], v[148:151], a[52:55]
s_add_u32 m0, s69, 114688
v_cvt_pk_bf16_f32 v199, v226, v227
v_mfma_f32_16x16x32_bf16 a[48:51], a[252:255], v[144:147], 0
v_exp_f32 v229, v165
v_mfma_f32_16x16x32_bf16 a[48:51], a[248:251], v[128:131], a[48:51]
v_cvt_pk_bf16_f32 v194, v228, v229
v_mfma_f32_16x16x32_bf16 a[128:131], a[144:147], v[128:131], 0
v_exp_f32 v230, v166
v_mfma_f32_16x16x32_bf16 a[128:131], a[144:147], v[144:147], a[128:131]
v_mfma_f32_16x16x32_bf16 a[132:135], a[144:147], v[132:135], 0
v_exp_f32 v231, v167
v_mfma_f32_16x16x32_bf16 a[132:135], a[144:147], v[148:151], a[132:135]
s_waitcnt lgkmcnt(0)
v_cvt_pk_bf16_f32 v195, v230, v231
v_mfma_f32_16x16x32_bf16 v[160:163], a[224:227], v[32:35], v[240:243]
v_exp_f32 v224, v96
v_mfma_f32_16x16x32_bf16 v[160:163], a[228:231], v[36:39], v[160:163]
ds_read_b128 a[240:243], v2 offset:36864
v_mfma_f32_16x16x32_bf16 v[160:163], a[232:235], v[40:43], v[160:163]
v_exp_f32 v225, v97
v_mfma_f32_16x16x32_bf16 v[160:163], a[236:239], v[44:47], v[160:163]
buffer_load_dwordx4 v18, s[40:43], s76 offen nt lds
v_mfma_f32_16x16x32_bf16 v[168:171], a[236:239], v[60:63], v[244:247]
v_exp_f32 v226, v98
v_mfma_f32_16x16x32_bf16 v[168:171], a[232:235], v[56:59], v[168:171]
ds_read_b128 a[244:247], v3 offset:36864
v_cvt_pk_bf16_f32 v208, v224, v225
v_mfma_f32_16x16x32_bf16 v[168:171], a[228:231], v[52:55], v[168:171]
v_exp_f32 v227, v99
v_mfma_f32_16x16x32_bf16 v[168:171], a[224:227], v[48:51], v[168:171]
ds_read_b128 a[248:251], v4 offset:36864
v_cvt_pk_bf16_f32 v209, v226, v227
v_mfma_f32_16x16x32_bf16 v[176:179], a[224:227], v[64:67], v[248:251]
v_exp_f32 v228, v100
v_mfma_f32_16x16x32_bf16 v[176:179], a[228:231], v[68:71], v[176:179]
ds_read_b128 a[252:255], v5 offset:36864
v_mfma_f32_16x16x32_bf16 v[176:179], a[232:235], v[72:75], v[176:179]
v_exp_f32 v229, v101
v_mfma_f32_16x16x32_bf16 v[176:179], a[236:239], v[76:79], v[176:179]
v_cvt_pk_bf16_f32 v210, v228, v229
v_mfma_f32_16x16x32_bf16 v[184:187], a[236:239], v[92:95], v[252:255]
v_exp_f32 v230, v102
v_mfma_f32_16x16x32_bf16 v[184:187], a[232:235], v[88:91], v[184:187]
v_mfma_f32_16x16x32_bf16 v[184:187], a[228:231], v[84:87], v[184:187]
v_exp_f32 v231, v103
v_mfma_f32_16x16x32_bf16 v[184:187], a[224:227], v[80:83], v[184:187]
s_waitcnt lgkmcnt(0)
buffer_store_dword v232, v235, s[52:55], s27 offen sc1
v_mfma_f32_16x16x32_bf16 v[188:191], a[240:243], v[80:83], v[252:255]
v_exp_f32 v224, v104
v_mfma_f32_16x16x32_bf16 v[188:191], a[244:247], v[84:87], v[188:191]
ds_read_b64_tr_b16 a[224:225], v10 offset:0
v_cvt_pk_bf16_f32 v211, v230, v231
v_mfma_f32_16x16x32_bf16 v[188:191], a[248:251], v[88:91], v[188:191]
v_exp_f32 v225, v105
v_mfma_f32_16x16x32_bf16 v[188:191], a[252:255], v[92:95], v[188:191]
ds_read_b64_tr_b16 a[226:227], v10 offset:4096
v_cvt_pk_bf16_f32 v212, v224, v225
v_mfma_f32_16x16x32_bf16 v[180:183], a[252:255], v[76:79], v[248:251]
ds_read_b64_tr_b16 a[228:229], v10 offset:8192
v_mfma_f32_16x16x32_bf16 v[180:183], a[248:251], v[72:75], v[180:183]
v_exp_f32 v226, v106
v_mfma_f32_16x16x32_bf16 v[180:183], a[244:247], v[68:71], v[180:183]
ds_read_b64_tr_b16 a[230:231], v10 offset:12288
v_mfma_f32_16x16x32_bf16 v[180:183], a[240:243], v[64:67], v[180:183]
v_exp_f32 v227, v107
v_mfma_f32_16x16x32_bf16 v[172:175], a[240:243], v[48:51], v[244:247]
ds_read_b64_tr_b16 a[232:233], v11 offset:0
v_cvt_pk_bf16_f32 v213, v226, v227
v_mfma_f32_16x16x32_bf16 v[172:175], a[244:247], v[52:55], v[172:175]
v_exp_f32 v228, v108
v_mfma_f32_16x16x32_bf16 v[172:175], a[248:251], v[56:59], v[172:175]
buffer_load_dwordx4 v19, s[40:43], s76 offen offset:1024 nt lds
v_mfma_f32_16x16x32_bf16 v[172:175], a[252:255], v[60:63], v[172:175]
v_exp_f32 v229, v109
v_mfma_f32_16x16x32_bf16 v[164:167], a[252:255], v[44:47], v[240:243]
ds_read_b64_tr_b16 a[234:235], v11 offset:4096
v_cvt_pk_bf16_f32 v214, v228, v229
v_mfma_f32_16x16x32_bf16 v[164:167], a[248:251], v[40:43], v[164:167]
v_exp_f32 v230, v110
v_mfma_f32_16x16x32_bf16 v[164:167], a[244:247], v[36:39], v[164:167]
ds_read_b64_tr_b16 a[236:237], v11 offset:8192
v_mfma_f32_16x16x32_bf16 v[164:167], a[240:243], v[32:35], v[164:167]
s_waitcnt lgkmcnt(3)
ds_read_b64_tr_b16 a[238:239], v11 offset:12288
v_mfma_f32_16x16x32_bf16 a[64:67], a[224:227], v[128:131], 0
v_exp_f32 v231, v111
v_mfma_f32_16x16x32_bf16 a[64:67], a[228:231], v[144:147], a[64:67]
ds_read_b64_tr_b16 a[240:241], v12 offset:0
v_cvt_pk_bf16_f32 v215, v230, v231
v_mfma_f32_16x16x32_bf16 a[68:71], a[228:231], v[148:151], 0
v_exp_f32 v224, v112
v_mfma_f32_16x16x32_bf16 a[68:71], a[224:227], v[132:135], a[68:71]
ds_read_b64_tr_b16 a[242:243], v12 offset:4096
v_mfma_f32_16x16x32_bf16 a[72:75], a[224:227], v[136:139], 0
v_exp_f32 v225, v113
v_mfma_f32_16x16x32_bf16 a[72:75], a[228:231], v[152:155], a[72:75]
ds_read_b64_tr_b16 a[244:245], v12 offset:8192
v_cvt_pk_bf16_f32 v216, v224, v225
v_mfma_f32_16x16x32_bf16 a[76:79], a[228:231], v[156:159], 0
v_exp_f32 v226, v114
v_mfma_f32_16x16x32_bf16 a[76:79], a[224:227], v[140:143], a[76:79]
s_waitcnt lgkmcnt(3)
buffer_load_dwordx4 v18, s[40:43], s76 offen offset:2048 nt lds
v_mfma_f32_16x16x32_bf16 a[92:95], a[232:235], v[140:143], 0
v_exp_f32 v227, v115
v_mfma_f32_16x16x32_bf16 a[92:95], a[236:239], v[156:159], a[92:95]
ds_read_b64_tr_b16 a[246:247], v12 offset:12288
v_cvt_pk_bf16_f32 v217, v226, v227
v_mfma_f32_16x16x32_bf16 a[88:91], a[236:239], v[152:155], 0
ds_read_b64_tr_b16 a[248:249], v13 offset:0
v_mfma_f32_16x16x32_bf16 a[88:91], a[232:235], v[136:139], a[88:91]
v_exp_f32 v228, v116
v_mfma_f32_16x16x32_bf16 a[84:87], a[232:235], v[132:135], 0
ds_read_b64_tr_b16 a[250:251], v13 offset:4096
v_mfma_f32_16x16x32_bf16 a[84:87], a[236:239], v[148:151], a[84:87]
v_exp_f32 v229, v117
v_mfma_f32_16x16x32_bf16 a[80:83], a[236:239], v[144:147], 0
ds_read_b64_tr_b16 a[252:253], v13 offset:8192
v_cvt_pk_bf16_f32 v218, v228, v229
v_mfma_f32_16x16x32_bf16 a[80:83], a[232:235], v[128:131], a[80:83]
s_waitcnt lgkmcnt(3)
v_exp_f32 v230, v118
v_mfma_f32_16x16x32_bf16 a[96:99], a[240:243], v[128:131], 0
ds_read_b64_tr_b16 a[254:255], v13 offset:12288
v_mfma_f32_16x16x32_bf16 a[96:99], a[244:247], v[144:147], a[96:99]
v_exp_f32 v231, v119
v_mfma_f32_16x16x32_bf16 a[100:103], a[244:247], v[148:151], 0
buffer_load_dwordx4 v19, s[40:43], s76 offen offset:3072 nt lds
v_mfma_f32_16x16x32_bf16 a[100:103], a[240:243], v[132:135], a[100:103]
v_exp_f32 v224, v120
v_mfma_f32_16x16x32_bf16 a[104:107], a[240:243], v[136:139], 0
ds_read_b128 a[224:227], v2 offset:40960
v_cvt_pk_bf16_f32 v219, v230, v231
v_mfma_f32_16x16x32_bf16 a[104:107], a[244:247], v[152:155], a[104:107]
ds_read_b128 a[228:231], v3 offset:40960
v_mfma_f32_16x16x32_bf16 a[108:111], a[244:247], v[156:159], 0
v_exp_f32 v225, v121
v_mfma_f32_16x16x32_bf16 a[108:111], a[240:243], v[140:143], a[108:111]
s_waitcnt lgkmcnt(2)
ds_read_b128 a[232:235], v4 offset:40960
v_cvt_pk_bf16_f32 v220, v224, v225
v_mfma_f32_16x16x32_bf16 a[124:127], a[248:251], v[140:143], 0
v_exp_f32 v226, v122
v_mfma_f32_16x16x32_bf16 a[124:127], a[252:255], v[156:159], a[124:127]
ds_read_b128 a[236:239], v5 offset:40960
v_mfma_f32_16x16x32_bf16 a[120:123], a[252:255], v[152:155], 0
v_exp_f32 v227, v123
v_mfma_f32_16x16x32_bf16 a[120:123], a[248:251], v[136:139], a[120:123]
v_cvt_pk_bf16_f32 v221, v226, v227
v_mfma_f32_16x16x32_bf16 a[116:119], a[248:251], v[132:135], 0
v_exp_f32 v228, v124
v_mfma_f32_16x16x32_bf16 a[116:119], a[252:255], v[148:151], a[116:119]
v_mfma_f32_16x16x32_bf16 a[112:115], a[252:255], v[144:147], 0
v_exp_f32 v229, v125
v_mfma_f32_16x16x32_bf16 a[112:115], a[248:251], v[128:131], a[112:115]
buffer_store_dword v232, v235, s[52:55], s63 offen sc1
v_mfma_f32_16x16x32_bf16 a[136:139], a[144:147], v[136:139], 0
s_xor_b32 s76, s67, 66048
v_exp_f32 v230, v126
v_mfma_f32_16x16x32_bf16 a[136:139], a[144:147], v[152:155], a[136:139]
s_add_u32 m0, s69, 16384
v_cvt_pk_bf16_f32 v222, v228, v229
v_mfma_f32_16x16x32_bf16 a[140:143], a[144:147], v[140:143], 0
v_exp_f32 v231, v127
v_mfma_f32_16x16x32_bf16 a[140:143], a[144:147], v[156:159], a[140:143]
s_waitcnt lgkmcnt(0)
v_cvt_pk_bf16_f32 v223, v230, v231
v_mfma_f32_16x16x32_bf16 v[96:99], a[224:227], v[32:35], v[240:243]
v_exp_f32 v224, v160
v_mfma_f32_16x16x32_bf16 v[96:99], a[228:231], v[36:39], v[96:99]
ds_read_b128 a[240:243], v2 offset:45056
v_mfma_f32_16x16x32_bf16 v[96:99], a[232:235], v[40:43], v[96:99]
v_exp_f32 v225, v161
v_mfma_f32_16x16x32_bf16 v[96:99], a[236:239], v[44:47], v[96:99]
ds_read_b128 a[244:247], v3 offset:45056
v_cvt_pk_bf16_f32 v128, v224, v225
v_mfma_f32_16x16x32_bf16 v[104:107], a[236:239], v[60:63], v[244:247]
v_exp_f32 v226, v162
v_mfma_f32_16x16x32_bf16 v[104:107], a[232:235], v[56:59], v[104:107]
ds_read_b128 a[248:251], v4 offset:45056
v_mfma_f32_16x16x32_bf16 v[104:107], a[228:231], v[52:55], v[104:107]
v_exp_f32 v227, v163
v_mfma_f32_16x16x32_bf16 v[104:107], a[224:227], v[48:51], v[104:107]
buffer_load_dwordx4 v14, s[36:39], s76 offen nt lds
v_mfma_f32_16x16x32_bf16 v[112:115], a[224:227], v[64:67], v[248:251]
v_exp_f32 v228, v164
v_mfma_f32_16x16x32_bf16 v[112:115], a[228:231], v[68:71], v[112:115]
ds_read_b128 a[252:255], v5 offset:45056
v_cvt_pk_bf16_f32 v129, v226, v227
v_mfma_f32_16x16x32_bf16 v[112:115], a[232:235], v[72:75], v[112:115]
v_exp_f32 v229, v165
v_mfma_f32_16x16x32_bf16 v[112:115], a[236:239], v[76:79], v[112:115]
v_cvt_pk_bf16_f32 v130, v228, v229
v_mfma_f32_16x16x32_bf16 v[120:123], a[236:239], v[92:95], v[252:255]
v_exp_f32 v230, v166
v_mfma_f32_16x16x32_bf16 v[120:123], a[232:235], v[88:91], v[120:123]
v_mfma_f32_16x16x32_bf16 v[120:123], a[228:231], v[84:87], v[120:123]
v_exp_f32 v231, v167
v_mfma_f32_16x16x32_bf16 v[120:123], a[224:227], v[80:83], v[120:123]
s_waitcnt vmcnt(12) lgkmcnt(0)
s_barrier
ds_read_b64_tr_b16 a[224:225], v6 offset:32768
v_mfma_f32_16x16x32_bf16 v[124:127], a[240:243], v[80:83], v[252:255]
s_xor_b32 s76, s67, 66048
v_exp_f32 v224, v168
v_mfma_f32_16x16x32_bf16 v[124:127], a[244:247], v[84:87], v[124:127]
s_add_u32 m0, s69, 16384
ds_read_b64_tr_b16 a[226:227], v6 offset:36864
v_cvt_pk_bf16_f32 v131, v230, v231
v_mfma_f32_16x16x32_bf16 v[124:127], a[248:251], v[88:91], v[124:127]
v_exp_f32 v225, v169
v_mfma_f32_16x16x32_bf16 v[124:127], a[252:255], v[92:95], v[124:127]
ds_read_b64_tr_b16 a[228:229], v6 offset:40960
v_cvt_pk_bf16_f32 v132, v224, v225
v_mfma_f32_16x16x32_bf16 v[116:119], a[252:255], v[76:79], v[248:251]
ds_read_b64_tr_b16 a[230:231], v6 offset:45056
v_mfma_f32_16x16x32_bf16 v[116:119], a[248:251], v[72:75], v[116:119]
v_exp_f32 v226, v170
v_mfma_f32_16x16x32_bf16 v[116:119], a[244:247], v[68:71], v[116:119]
ds_read_b64_tr_b16 a[232:233], v7 offset:32768
v_mfma_f32_16x16x32_bf16 v[116:119], a[240:243], v[64:67], v[116:119]
v_exp_f32 v227, v171
v_mfma_f32_16x16x32_bf16 v[108:111], a[240:243], v[48:51], v[244:247]
buffer_load_dwordx4 v15, s[36:39], s76 offen offset:1024 nt lds
L_hop0_3:
s_cbranch_execz L_hop_ret0
v_mfma_f32_16x16x32_bf16 v[108:111], a[244:247], v[52:55], v[108:111]
v_exp_f32 v228, v172
v_mfma_f32_16x16x32_bf16 v[108:111], a[248:251], v[56:59], v[108:111]
ds_read_b64_tr_b16 a[234:235], v7 offset:36864
v_cvt_pk_bf16_f32 v133, v226, v227
v_mfma_f32_16x16x32_bf16 v[108:111], a[252:255], v[60:63], v[108:111]
v_exp_f32 v229, v173
v_mfma_f32_16x16x32_bf16 v[100:103], a[252:255], v[44:47], v[240:243]
ds_read_b64_tr_b16 a[236:237], v7 offset:40960
v_cvt_pk_bf16_f32 v134, v228, v229
v_mfma_f32_16x16x32_bf16 v[100:103], a[248:251], v[40:43], v[100:103]
v_exp_f32 v230, v174
v_mfma_f32_16x16x32_bf16 v[100:103], a[244:247], v[36:39], v[100:103]
ds_read_b64_tr_b16 a[238:239], v7 offset:45056
v_mfma_f32_16x16x32_bf16 v[100:103], a[240:243], v[32:35], v[100:103]
s_waitcnt lgkmcnt(4)
ds_read_b64_tr_b16 a[240:241], v8 offset:32768
v_mfma_f32_16x16x32_bf16 a[0:3], a[224:227], v[192:195], a[0:3]
v_exp_f32 v231, v175
v_mfma_f32_16x16x32_bf16 a[0:3], a[228:231], v[208:211], a[0:3]
ds_read_b64_tr_b16 a[242:243], v8 offset:36864
v_cvt_pk_bf16_f32 v135, v230, v231
v_mfma_f32_16x16x32_bf16 a[4:7], a[228:231], v[212:215], a[4:7]
v_exp_f32 v224, v176
v_mfma_f32_16x16x32_bf16 a[4:7], a[224:227], v[196:199], a[4:7]
ds_read_b64_tr_b16 a[244:245], v8 offset:40960
v_mfma_f32_16x16x32_bf16 a[8:11], a[224:227], v[200:203], a[8:11]
v_exp_f32 v225, v177
v_mfma_f32_16x16x32_bf16 a[8:11], a[228:231], v[216:219], a[8:11]
ds_read_b64_tr_b16 a[246:247], v8 offset:45056
v_cvt_pk_bf16_f32 v136, v224, v225
v_mfma_f32_16x16x32_bf16 a[12:15], a[228:231], v[220:223], a[12:15]
v_exp_f32 v226, v178
v_mfma_f32_16x16x32_bf16 a[12:15], a[224:227], v[204:207], a[12:15]
s_waitcnt lgkmcnt(4)
buffer_load_dwordx4 v16, s[36:39], s76 offen offset:2048 nt lds
v_mfma_f32_16x16x32_bf16 a[28:31], a[232:235], v[204:207], a[28:31]
v_exp_f32 v227, v179
v_mfma_f32_16x16x32_bf16 a[28:31], a[236:239], v[220:223], a[28:31]
ds_read_b64_tr_b16 a[248:249], v9 offset:32768
v_cvt_pk_bf16_f32 v137, v226, v227
v_mfma_f32_16x16x32_bf16 a[24:27], a[236:239], v[216:219], a[24:27]
ds_read_b64_tr_b16 a[250:251], v9 offset:36864
v_mfma_f32_16x16x32_bf16 a[24:27], a[232:235], v[200:203], a[24:27]
v_exp_f32 v228, v180
v_mfma_f32_16x16x32_bf16 a[20:23], a[232:235], v[196:199], a[20:23]
ds_read_b64_tr_b16 a[252:253], v9 offset:40960
v_mfma_f32_16x16x32_bf16 a[20:23], a[236:239], v[212:215], a[20:23]
v_exp_f32 v229, v181
v_mfma_f32_16x16x32_bf16 a[16:19], a[236:239], v[208:211], a[16:19]
ds_read_b64_tr_b16 a[254:255], v9 offset:45056
v_cvt_pk_bf16_f32 v138, v228, v229
v_mfma_f32_16x16x32_bf16 a[16:19], a[232:235], v[192:195], a[16:19]
s_waitcnt lgkmcnt(4)
v_exp_f32 v230, v182
v_mfma_f32_16x16x32_bf16 a[32:35], a[240:243], v[192:195], a[32:35]
v_mfma_f32_16x16x32_bf16 a[32:35], a[244:247], v[208:211], a[32:35]
v_exp_f32 v231, v183
v_mfma_f32_16x16x32_bf16 a[36:39], a[244:247], v[212:215], a[36:39]
v_cvt_pk_bf16_f32 v139, v230, v231
v_mfma_f32_16x16x32_bf16 a[36:39], a[240:243], v[196:199], a[36:39]
v_exp_f32 v224, v184
v_mfma_f32_16x16x32_bf16 a[40:43], a[240:243], v[200:203], a[40:43]
buffer_load_dwordx4 v17, s[36:39], s76 offen offset:3072 nt lds
v_mfma_f32_16x16x32_bf16 a[40:43], a[244:247], v[216:219], a[40:43]
s_xor_b32 s76, s67, 81920
ds_read_b128 a[224:227], v2 offset:49152
v_mfma_f32_16x16x32_bf16 a[44:47], a[244:247], v[220:223], a[44:47]
s_add_u32 m0, s69, 81920
v_exp_f32 v225, v185
v_mfma_f32_16x16x32_bf16 a[44:47], a[240:243], v[204:207], a[44:47]
s_waitcnt lgkmcnt(1)
ds_read_b128 a[228:231], v3 offset:49152
v_cvt_pk_bf16_f32 v140, v224, v225
v_mfma_f32_16x16x32_bf16 a[60:63], a[248:251], v[204:207], a[60:63]
v_exp_f32 v226, v186
v_mfma_f32_16x16x32_bf16 a[60:63], a[252:255], v[220:223], a[60:63]
ds_read_b128 a[232:235], v4 offset:49152
v_mfma_f32_16x16x32_bf16 a[56:59], a[252:255], v[216:219], a[56:59]
v_exp_f32 v227, v187
v_mfma_f32_16x16x32_bf16 a[56:59], a[248:251], v[200:203], a[56:59]
ds_read_b128 a[236:239], v5 offset:49152
v_cvt_pk_bf16_f32 v141, v226, v227
v_mfma_f32_16x16x32_bf16 a[52:55], a[248:251], v[196:199], a[52:55]
v_exp_f32 v228, v188
v_mfma_f32_16x16x32_bf16 a[52:55], a[252:255], v[212:215], a[52:55]
v_mfma_f32_16x16x32_bf16 a[48:51], a[252:255], v[208:211], a[48:51]
v_exp_f32 v229, v189
v_mfma_f32_16x16x32_bf16 a[48:51], a[248:251], v[192:195], a[48:51]
v_cvt_pk_bf16_f32 v142, v228, v229
v_mfma_f32_16x16x32_bf16 a[128:131], a[144:147], v[192:195], a[128:131]
v_exp_f32 v230, v190
v_mfma_f32_16x16x32_bf16 a[128:131], a[144:147], v[208:211], a[128:131]
v_mfma_f32_16x16x32_bf16 a[132:135], a[144:147], v[196:199], a[132:135]
v_exp_f32 v231, v191
v_mfma_f32_16x16x32_bf16 a[132:135], a[144:147], v[212:215], a[132:135]
s_waitcnt lgkmcnt(0)
buffer_load_dwordx4 v18, s[40:43], s76 offen nt lds
v_mfma_f32_16x16x32_bf16 v[160:163], a[224:227], v[32:35], v[240:243]
v_exp_f32 v224, v96
v_mfma_f32_16x16x32_bf16 v[160:163], a[228:231], v[36:39], v[160:163]
ds_read_b128 a[240:243], v2 offset:53248
v_cvt_pk_bf16_f32 v143, v230, v231
v_mfma_f32_16x16x32_bf16 v[160:163], a[232:235], v[40:43], v[160:163]
v_exp_f32 v225, v97
v_mfma_f32_16x16x32_bf16 v[160:163], a[236:239], v[44:47], v[160:163]
ds_read_b128 a[244:247], v3 offset:53248
v_cvt_pk_bf16_f32 v144, v224, v225
v_mfma_f32_16x16x32_bf16 v[168:171], a[236:239], v[60:63], v[244:247]
v_exp_f32 v226, v98
v_mfma_f32_16x16x32_bf16 v[168:171], a[232:235], v[56:59], v[168:171]
ds_read_b128 a[248:251], v4 offset:53248
v_mfma_f32_16x16x32_bf16 v[168:171], a[228:231], v[52:55], v[168:171]
v_exp_f32 v227, v99
v_mfma_f32_16x16x32_bf16 v[168:171], a[224:227], v[48:51], v[168:171]
ds_read_b128 a[252:255], v5 offset:53248
v_cvt_pk_bf16_f32 v145, v226, v227
v_mfma_f32_16x16x32_bf16 v[176:179], a[224:227], v[64:67], v[248:251]
v_exp_f32 v228, v100
v_mfma_f32_16x16x32_bf16 v[176:179], a[228:231], v[68:71], v[176:179]
v_mfma_f32_16x16x32_bf16 v[176:179], a[232:235], v[72:75], v[176:179]
v_exp_f32 v229, v101
v_mfma_f32_16x16x32_bf16 v[176:179], a[236:239], v[76:79], v[176:179]
v_cvt_pk_bf16_f32 v146, v228, v229
v_mfma_f32_16x16x32_bf16 v[184:187], a[236:239], v[92:95], v[252:255]
v_exp_f32 v230, v102
v_mfma_f32_16x16x32_bf16 v[184:187], a[232:235], v[88:91], v[184:187]
v_mfma_f32_16x16x32_bf16 v[184:187], a[228:231], v[84:87], v[184:187]
v_exp_f32 v231, v103
v_mfma_f32_16x16x32_bf16 v[184:187], a[224:227], v[80:83], v[184:187]
s_waitcnt lgkmcnt(0)
buffer_store_dwordx4 a[148:151], v238, s[52:55], s11 offen offset:0 sc1
v_mfma_f32_16x16x32_bf16 v[188:191], a[240:243], v[80:83], v[252:255]
v_exp_f32 v224, v104
v_mfma_f32_16x16x32_bf16 v[188:191], a[244:247], v[84:87], v[188:191]
ds_read_b64_tr_b16 a[224:225], v10 offset:32768
v_cvt_pk_bf16_f32 v147, v230, v231
v_mfma_f32_16x16x32_bf16 v[188:191], a[248:251], v[88:91], v[188:191]
v_exp_f32 v225, v105
v_mfma_f32_16x16x32_bf16 v[188:191], a[252:255], v[92:95], v[188:191]
ds_read_b64_tr_b16 a[226:227], v10 offset:36864
v_cvt_pk_bf16_f32 v148, v224, v225
v_mfma_f32_16x16x32_bf16 v[180:183], a[252:255], v[76:79], v[248:251]
ds_read_b64_tr_b16 a[228:229], v10 offset:40960
v_mfma_f32_16x16x32_bf16 v[180:183], a[248:251], v[72:75], v[180:183]
v_exp_f32 v226, v106
v_mfma_f32_16x16x32_bf16 v[180:183], a[244:247], v[68:71], v[180:183]
ds_read_b64_tr_b16 a[230:231], v10 offset:45056
v_mfma_f32_16x16x32_bf16 v[180:183], a[240:243], v[64:67], v[180:183]
v_exp_f32 v227, v107
v_mfma_f32_16x16x32_bf16 v[172:175], a[240:243], v[48:51], v[244:247]
ds_read_b64_tr_b16 a[232:233], v11 offset:32768
v_cvt_pk_bf16_f32 v149, v226, v227
v_mfma_f32_16x16x32_bf16 v[172:175], a[244:247], v[52:55], v[172:175]
v_exp_f32 v228, v108
v_mfma_f32_16x16x32_bf16 v[172:175], a[248:251], v[56:59], v[172:175]
ds_read_b64_tr_b16 a[234:235], v11 offset:36864
v_mfma_f32_16x16x32_bf16 v[172:175], a[252:255], v[60:63], v[172:175]
v_exp_f32 v229, v109
v_mfma_f32_16x16x32_bf16 v[164:167], a[252:255], v[44:47], v[240:243]
buffer_load_dwordx4 v19, s[40:43], s76 offen offset:1024 nt lds
v_mfma_f32_16x16x32_bf16 v[164:167], a[248:251], v[40:43], v[164:167]
v_exp_f32 v230, v110
v_mfma_f32_16x16x32_bf16 v[164:167], a[244:247], v[36:39], v[164:167]
ds_read_b64_tr_b16 a[236:237], v11 offset:40960
v_cvt_pk_bf16_f32 v150, v228, v229
v_mfma_f32_16x16x32_bf16 v[164:167], a[240:243], v[32:35], v[164:167]
s_waitcnt lgkmcnt(3)
ds_read_b64_tr_b16 a[238:239], v11 offset:45056
v_mfma_f32_16x16x32_bf16 a[64:67], a[224:227], v[192:195], a[64:67]
v_exp_f32 v231, v111
v_mfma_f32_16x16x32_bf16 a[64:67], a[228:231], v[208:211], a[64:67]
ds_read_b64_tr_b16 a[240:241], v12 offset:32768
v_cvt_pk_bf16_f32 v151, v230, v231
v_mfma_f32_16x16x32_bf16 a[68:71], a[228:231], v[212:215], a[68:71]
v_exp_f32 v224, v112
v_mfma_f32_16x16x32_bf16 a[68:71], a[224:227], v[196:199], a[68:71]
ds_read_b64_tr_b16 a[242:243], v12 offset:36864
v_mfma_f32_16x16x32_bf16 a[72:75], a[224:227], v[200:203], a[72:75]
v_exp_f32 v225, v113
v_mfma_f32_16x16x32_bf16 a[72:75], a[228:231], v[216:219], a[72:75]
ds_read_b64_tr_b16 a[244:245], v12 offset:40960
v_cvt_pk_bf16_f32 v152, v224, v225
v_mfma_f32_16x16x32_bf16 a[76:79], a[228:231], v[220:223], a[76:79]
v_exp_f32 v226, v114
v_mfma_f32_16x16x32_bf16 a[76:79], a[224:227], v[204:207], a[76:79]
s_waitcnt lgkmcnt(3)
ds_read_b64_tr_b16 a[246:247], v12 offset:45056
v_mfma_f32_16x16x32_bf16 a[92:95], a[232:235], v[204:207], a[92:95]
v_exp_f32 v227, v115
v_mfma_f32_16x16x32_bf16 a[92:95], a[236:239], v[220:223], a[92:95]
ds_read_b64_tr_b16 a[248:249], v13 offset:32768
v_cvt_pk_bf16_f32 v153, v226, v227
v_mfma_f32_16x16x32_bf16 a[88:91], a[236:239], v[216:219], a[88:91]
ds_read_b64_tr_b16 a[250:251], v13 offset:36864
v_mfma_f32_16x16x32_bf16 a[88:91], a[232:235], v[200:203], a[88:91]
v_exp_f32 v228, v116
v_mfma_f32_16x16x32_bf16 a[84:87], a[232:235], v[196:199], a[84:87]
buffer_load_dwordx4 v18, s[40:43], s76 offen offset:2048 nt lds
v_mfma_f32_16x16x32_bf16 a[84:87], a[236:239], v[212:215], a[84:87]
v_exp_f32 v229, v117
v_mfma_f32_16x16x32_bf16 a[80:83], a[236:239], v[208:211], a[80:83]
ds_read_b64_tr_b16 a[252:253], v13 offset:40960
v_cvt_pk_bf16_f32 v154, v228, v229
v_mfma_f32_16x16x32_bf16 a[80:83], a[232:235], v[192:195], a[80:83]
s_waitcnt lgkmcnt(3)
v_exp_f32 v230, v118
v_mfma_f32_16x16x32_bf16 a[96:99], a[240:243], v[192:195], a[96:99]
ds_read_b64_tr_b16 a[254:255], v13 offset:45056
v_mfma_f32_16x16x32_bf16 a[96:99], a[244:247], v[208:211], a[96:99]
v_exp_f32 v231, v119
v_mfma_f32_16x16x32_bf16 a[100:103], a[244:247], v[212:215], a[100:103]
v_cvt_pk_bf16_f32 v155, v230, v231
v_mfma_f32_16x16x32_bf16 a[100:103], a[240:243], v[196:199], a[100:103]
v_exp_f32 v224, v120
v_mfma_f32_16x16x32_bf16 a[104:107], a[240:243], v[200:203], a[104:107]
ds_read_b128 a[224:227], v2 offset:57344
v_mfma_f32_16x16x32_bf16 a[104:107], a[244:247], v[216:219], a[104:107]
ds_read_b128 a[228:231], v3 offset:57344
v_mfma_f32_16x16x32_bf16 a[108:111], a[244:247], v[220:223], a[108:111]
v_exp_f32 v225, v121
v_mfma_f32_16x16x32_bf16 a[108:111], a[240:243], v[204:207], a[108:111]
s_waitcnt lgkmcnt(2)
ds_read_b128 a[232:235], v4 offset:57344
v_cvt_pk_bf16_f32 v156, v224, v225
v_mfma_f32_16x16x32_bf16 a[124:127], a[248:251], v[204:207], a[124:127]
v_exp_f32 v226, v122
v_mfma_f32_16x16x32_bf16 a[124:127], a[252:255], v[220:223], a[124:127]
ds_read_b128 a[236:239], v5 offset:57344
v_mfma_f32_16x16x32_bf16 a[120:123], a[252:255], v[216:219], a[120:123]
v_exp_f32 v227, v123
v_mfma_f32_16x16x32_bf16 a[120:123], a[248:251], v[200:203], a[120:123]
buffer_load_dwordx4 v19, s[40:43], s76 offen offset:3072 nt lds
v_mfma_f32_16x16x32_bf16 a[116:119], a[248:251], v[196:199], a[116:119]
s_xor_b32 s76, s67, 16896
v_exp_f32 v228, v124
v_mfma_f32_16x16x32_bf16 a[116:119], a[252:255], v[212:215], a[116:119]
s_add_u32 m0, s69, 32768
v_cvt_pk_bf16_f32 v157, v226, v227
v_mfma_f32_16x16x32_bf16 a[112:115], a[252:255], v[208:211], a[112:115]
v_exp_f32 v229, v125
v_mfma_f32_16x16x32_bf16 a[112:115], a[248:251], v[192:195], a[112:115]
v_cvt_pk_bf16_f32 v158, v228, v229
v_mfma_f32_16x16x32_bf16 a[136:139], a[144:147], v[200:203], a[136:139]
v_exp_f32 v230, v126
v_mfma_f32_16x16x32_bf16 a[136:139], a[144:147], v[216:219], a[136:139]
v_mfma_f32_16x16x32_bf16 a[140:143], a[144:147], v[204:207], a[140:143]
v_exp_f32 v231, v127
v_mfma_f32_16x16x32_bf16 a[140:143], a[144:147], v[220:223], a[140:143]
s_waitcnt lgkmcnt(0)
v_cvt_pk_bf16_f32 v159, v230, v231
v_mfma_f32_16x16x32_bf16 v[96:99], a[224:227], v[32:35], v[240:243]
v_exp_f32 v224, v160
v_mfma_f32_16x16x32_bf16 v[96:99], a[228:231], v[36:39], v[96:99]
ds_read_b128 a[240:243], v2 offset:61440
v_mfma_f32_16x16x32_bf16 v[96:99], a[232:235], v[40:43], v[96:99]
v_exp_f32 v225, v161
v_mfma_f32_16x16x32_bf16 v[96:99], a[236:239], v[44:47], v[96:99]
ds_read_b128 a[244:247], v3 offset:61440
v_cvt_pk_bf16_f32 v192, v224, v225
v_mfma_f32_16x16x32_bf16 v[104:107], a[236:239], v[60:63], v[244:247]
v_exp_f32 v226, v162
v_mfma_f32_16x16x32_bf16 v[104:107], a[232:235], v[56:59], v[104:107]
buffer_load_dwordx4 v14, s[36:39], s76 offen nt lds
v_mfma_f32_16x16x32_bf16 v[104:107], a[228:231], v[52:55], v[104:107]
v_exp_f32 v227, v163
v_mfma_f32_16x16x32_bf16 v[104:107], a[224:227], v[48:51], v[104:107]
ds_read_b128 a[248:251], v4 offset:61440
v_cvt_pk_bf16_f32 v193, v226, v227
v_mfma_f32_16x16x32_bf16 v[112:115], a[224:227], v[64:67], v[248:251]
v_exp_f32 v228, v164
v_mfma_f32_16x16x32_bf16 v[112:115], a[228:231], v[68:71], v[112:115]
ds_read_b128 a[252:255], v5 offset:61440
v_mfma_f32_16x16x32_bf16 v[112:115], a[232:235], v[72:75], v[112:115]
v_exp_f32 v229, v165
v_mfma_f32_16x16x32_bf16 v[112:115], a[236:239], v[76:79], v[112:115]
v_cvt_pk_bf16_f32 v194, v228, v229
v_mfma_f32_16x16x32_bf16 v[120:123], a[236:239], v[92:95], v[252:255]
v_exp_f32 v230, v166
v_mfma_f32_16x16x32_bf16 v[120:123], a[232:235], v[88:91], v[120:123]
v_mfma_f32_16x16x32_bf16 v[120:123], a[228:231], v[84:87], v[120:123]
v_exp_f32 v231, v167
v_mfma_f32_16x16x32_bf16 v[120:123], a[224:227], v[80:83], v[120:123]
s_waitcnt vmcnt(11) lgkmcnt(0)
s_barrier
ds_read_b64_tr_b16 a[224:225], v6 offset:49152
v_mfma_f32_16x16x32_bf16 v[124:127], a[240:243], v[80:83], v[252:255]
s_xor_b32 s76, s67, 16896
v_exp_f32 v224, v168
v_mfma_f32_16x16x32_bf16 v[124:127], a[244:247], v[84:87], v[124:127]
s_add_u32 m0, s69, 32768
ds_read_b64_tr_b16 a[226:227], v6 offset:53248
v_cvt_pk_bf16_f32 v195, v230, v231
v_mfma_f32_16x16x32_bf16 v[124:127], a[248:251], v[88:91], v[124:127]
v_exp_f32 v225, v169
v_mfma_f32_16x16x32_bf16 v[124:127], a[252:255], v[92:95], v[124:127]
ds_read_b64_tr_b16 a[228:229], v6 offset:57344
v_cvt_pk_bf16_f32 v196, v224, v225
v_mfma_f32_16x16x32_bf16 v[116:119], a[252:255], v[76:79], v[248:251]
ds_read_b64_tr_b16 a[230:231], v6 offset:61440
v_mfma_f32_16x16x32_bf16 v[116:119], a[248:251], v[72:75], v[116:119]
v_exp_f32 v226, v170
v_mfma_f32_16x16x32_bf16 v[116:119], a[244:247], v[68:71], v[116:119]
ds_read_b64_tr_b16 a[232:233], v7 offset:49152
v_mfma_f32_16x16x32_bf16 v[116:119], a[240:243], v[64:67], v[116:119]
v_exp_f32 v227, v171
v_mfma_f32_16x16x32_bf16 v[108:111], a[240:243], v[48:51], v[244:247]
buffer_load_dwordx4 v15, s[36:39], s76 offen offset:1024 nt lds
v_mfma_f32_16x16x32_bf16 v[108:111], a[244:247], v[52:55], v[108:111]
v_exp_f32 v228, v172
v_mfma_f32_16x16x32_bf16 v[108:111], a[248:251], v[56:59], v[108:111]
ds_read_b64_tr_b16 a[234:235], v7 offset:53248
v_cvt_pk_bf16_f32 v197, v226, v227
v_mfma_f32_16x16x32_bf16 v[108:111], a[252:255], v[60:63], v[108:111]
v_exp_f32 v229, v173
v_mfma_f32_16x16x32_bf16 v[100:103], a[252:255], v[44:47], v[240:243]
ds_read_b64_tr_b16 a[236:237], v7 offset:57344
v_cvt_pk_bf16_f32 v198, v228, v229
v_mfma_f32_16x16x32_bf16 v[100:103], a[248:251], v[40:43], v[100:103]
v_exp_f32 v230, v174
v_mfma_f32_16x16x32_bf16 v[100:103], a[244:247], v[36:39], v[100:103]
ds_read_b64_tr_b16 a[238:239], v7 offset:61440
v_mfma_f32_16x16x32_bf16 v[100:103], a[240:243], v[32:35], v[100:103]
s_waitcnt lgkmcnt(4)
ds_read_b64_tr_b16 a[240:241], v8 offset:49152
v_mfma_f32_16x16x32_bf16 a[0:3], a[224:227], v[128:131], a[0:3]
v_exp_f32 v231, v175
v_mfma_f32_16x16x32_bf16 a[0:3], a[228:231], v[144:147], a[0:3]
ds_read_b64_tr_b16 a[242:243], v8 offset:53248
v_cvt_pk_bf16_f32 v199, v230, v231
v_mfma_f32_16x16x32_bf16 a[4:7], a[228:231], v[148:151], a[4:7]
v_exp_f32 v224, v176
v_mfma_f32_16x16x32_bf16 a[4:7], a[224:227], v[132:135], a[4:7]
ds_read_b64_tr_b16 a[244:245], v8 offset:57344
v_mfma_f32_16x16x32_bf16 a[8:11], a[224:227], v[136:139], a[8:11]
v_exp_f32 v225, v177
v_mfma_f32_16x16x32_bf16 a[8:11], a[228:231], v[152:155], a[8:11]
ds_read_b64_tr_b16 a[246:247], v8 offset:61440
v_cvt_pk_bf16_f32 v200, v224, v225
v_mfma_f32_16x16x32_bf16 a[12:15], a[228:231], v[156:159], a[12:15]
v_exp_f32 v226, v178
v_mfma_f32_16x16x32_bf16 a[12:15], a[224:227], v[140:143], a[12:15]
s_waitcnt lgkmcnt(4)
buffer_load_dwordx4 v16, s[36:39], s76 offen offset:2048 nt lds
v_mfma_f32_16x16x32_bf16 a[28:31], a[232:235], v[140:143], a[28:31]
v_exp_f32 v227, v179
v_mfma_f32_16x16x32_bf16 a[28:31], a[236:239], v[156:159], a[28:31]
ds_read_b64_tr_b16 a[248:249], v9 offset:49152
v_cvt_pk_bf16_f32 v201, v226, v227
v_mfma_f32_16x16x32_bf16 a[24:27], a[236:239], v[152:155], a[24:27]
ds_read_b64_tr_b16 a[250:251], v9 offset:53248
v_mfma_f32_16x16x32_bf16 a[24:27], a[232:235], v[136:139], a[24:27]
v_exp_f32 v228, v180
v_mfma_f32_16x16x32_bf16 a[20:23], a[232:235], v[132:135], a[20:23]
ds_read_b64_tr_b16 a[252:253], v9 offset:57344
v_mfma_f32_16x16x32_bf16 a[20:23], a[236:239], v[148:151], a[20:23]
v_exp_f32 v229, v181
v_mfma_f32_16x16x32_bf16 a[16:19], a[236:239], v[144:147], a[16:19]
ds_read_b64_tr_b16 a[254:255], v9 offset:61440
v_cvt_pk_bf16_f32 v202, v228, v229
v_mfma_f32_16x16x32_bf16 a[16:19], a[232:235], v[128:131], a[16:19]
s_waitcnt lgkmcnt(4)
v_exp_f32 v230, v182
v_mfma_f32_16x16x32_bf16 a[32:35], a[240:243], v[128:131], a[32:35]
v_mfma_f32_16x16x32_bf16 a[32:35], a[244:247], v[144:147], a[32:35]
v_exp_f32 v231, v183
v_mfma_f32_16x16x32_bf16 a[36:39], a[244:247], v[148:151], a[36:39]
v_cvt_pk_bf16_f32 v203, v230, v231
v_mfma_f32_16x16x32_bf16 a[36:39], a[240:243], v[132:135], a[36:39]
v_exp_f32 v224, v184
v_mfma_f32_16x16x32_bf16 a[40:43], a[240:243], v[136:139], a[40:43]
buffer_load_dwordx4 v17, s[36:39], s76 offen offset:3072 nt lds
v_mfma_f32_16x16x32_bf16 a[40:43], a[244:247], v[152:155], a[40:43]
s_xor_b32 s76, s67, 512
ds_read_b128 a[224:227], v2 offset:0
v_mfma_f32_16x16x32_bf16 a[44:47], a[244:247], v[156:159], a[44:47]
s_add_u32 m0, s69, 65536
v_exp_f32 v225, v185
v_mfma_f32_16x16x32_bf16 a[44:47], a[240:243], v[140:143], a[44:47]
s_waitcnt lgkmcnt(1)
ds_read_b128 a[228:231], v3 offset:0
v_cvt_pk_bf16_f32 v204, v224, v225
v_mfma_f32_16x16x32_bf16 a[60:63], a[248:251], v[140:143], a[60:63]
v_exp_f32 v226, v186
v_mfma_f32_16x16x32_bf16 a[60:63], a[252:255], v[156:159], a[60:63]
ds_read_b128 a[232:235], v4 offset:0
v_mfma_f32_16x16x32_bf16 a[56:59], a[252:255], v[152:155], a[56:59]
v_exp_f32 v227, v187
v_mfma_f32_16x16x32_bf16 a[56:59], a[248:251], v[136:139], a[56:59]
ds_read_b128 a[236:239], v5 offset:0
v_cvt_pk_bf16_f32 v205, v226, v227
v_mfma_f32_16x16x32_bf16 a[52:55], a[248:251], v[132:135], a[52:55]
v_exp_f32 v228, v188
v_mfma_f32_16x16x32_bf16 a[52:55], a[252:255], v[148:151], a[52:55]
v_mfma_f32_16x16x32_bf16 a[48:51], a[252:255], v[144:147], a[48:51]
v_exp_f32 v229, v189
v_mfma_f32_16x16x32_bf16 a[48:51], a[248:251], v[128:131], a[48:51]
v_cvt_pk_bf16_f32 v206, v228, v229
v_mfma_f32_16x16x32_bf16 a[128:131], a[144:147], v[128:131], a[128:131]
v_exp_f32 v230, v190
v_mfma_f32_16x16x32_bf16 a[128:131], a[144:147], v[144:147], a[128:131]
v_mfma_f32_16x16x32_bf16 a[132:135], a[144:147], v[132:135], a[132:135]
v_exp_f32 v231, v191
v_mfma_f32_16x16x32_bf16 a[132:135], a[144:147], v[148:151], a[132:135]
s_waitcnt lgkmcnt(0)
buffer_load_dwordx4 v18, s[40:43], s76 offen nt lds
v_mfma_f32_16x16x32_bf16 v[160:163], a[224:227], v[32:35], v[240:243]
v_exp_f32 v224, v96
v_mfma_f32_16x16x32_bf16 v[160:163], a[228:231], v[36:39], v[160:163]
ds_read_b128 a[240:243], v2 offset:4096
v_cvt_pk_bf16_f32 v207, v230, v231
v_mfma_f32_16x16x32_bf16 v[160:163], a[232:235], v[40:43], v[160:163]
v_exp_f32 v225, v97
v_mfma_f32_16x16x32_bf16 v[160:163], a[236:239], v[44:47], v[160:163]
ds_read_b128 a[244:247], v3 offset:4096
v_cvt_pk_bf16_f32 v208, v224, v225
v_mfma_f32_16x16x32_bf16 v[168:171], a[236:239], v[60:63], v[244:247]
v_exp_f32 v226, v98
v_mfma_f32_16x16x32_bf16 v[168:171], a[232:235], v[56:59], v[168:171]
ds_read_b128 a[248:251], v4 offset:4096
v_mfma_f32_16x16x32_bf16 v[168:171], a[228:231], v[52:55], v[168:171]
v_exp_f32 v227, v99
v_mfma_f32_16x16x32_bf16 v[168:171], a[224:227], v[48:51], v[168:171]
ds_read_b128 a[252:255], v5 offset:4096
v_cvt_pk_bf16_f32 v209, v226, v227
v_mfma_f32_16x16x32_bf16 v[176:179], a[224:227], v[64:67], v[248:251]
v_exp_f32 v228, v100
v_mfma_f32_16x16x32_bf16 v[176:179], a[228:231], v[68:71], v[176:179]
v_mfma_f32_16x16x32_bf16 v[176:179], a[232:235], v[72:75], v[176:179]
v_exp_f32 v229, v101
v_mfma_f32_16x16x32_bf16 v[176:179], a[236:239], v[76:79], v[176:179]
v_cvt_pk_bf16_f32 v210, v228, v229
v_mfma_f32_16x16x32_bf16 v[184:187], a[236:239], v[92:95], v[252:255]
v_exp_f32 v230, v102
v_mfma_f32_16x16x32_bf16 v[184:187], a[232:235], v[88:91], v[184:187]
v_mfma_f32_16x16x32_bf16 v[184:187], a[228:231], v[84:87], v[184:187]
v_exp_f32 v231, v103
v_mfma_f32_16x16x32_bf16 v[184:187], a[224:227], v[80:83], v[184:187]
s_waitcnt lgkmcnt(0)
buffer_store_dwordx4 a[152:155], v238, s[52:55], s11 offen offset:1024 sc1
v_mfma_f32_16x16x32_bf16 v[188:191], a[240:243], v[80:83], v[252:255]
v_exp_f32 v224, v104
v_mfma_f32_16x16x32_bf16 v[188:191], a[244:247], v[84:87], v[188:191]
ds_read_b64_tr_b16 a[224:225], v10 offset:49152
v_cvt_pk_bf16_f32 v211, v230, v231
v_mfma_f32_16x16x32_bf16 v[188:191], a[248:251], v[88:91], v[188:191]
v_exp_f32 v225, v105
v_mfma_f32_16x16x32_bf16 v[188:191], a[252:255], v[92:95], v[188:191]
ds_read_b64_tr_b16 a[226:227], v10 offset:53248
v_cvt_pk_bf16_f32 v212, v224, v225
v_mfma_f32_16x16x32_bf16 v[180:183], a[252:255], v[76:79], v[248:251]
ds_read_b64_tr_b16 a[228:229], v10 offset:57344
v_mfma_f32_16x16x32_bf16 v[180:183], a[248:251], v[72:75], v[180:183]
v_exp_f32 v226, v106
v_mfma_f32_16x16x32_bf16 v[180:183], a[244:247], v[68:71], v[180:183]
ds_read_b64_tr_b16 a[230:231], v10 offset:61440
v_mfma_f32_16x16x32_bf16 v[180:183], a[240:243], v[64:67], v[180:183]
v_exp_f32 v227, v107
v_mfma_f32_16x16x32_bf16 v[172:175], a[240:243], v[48:51], v[244:247]
ds_read_b64_tr_b16 a[232:233], v11 offset:49152
v_cvt_pk_bf16_f32 v213, v226, v227
v_mfma_f32_16x16x32_bf16 v[172:175], a[244:247], v[52:55], v[172:175]
v_exp_f32 v228, v108
v_mfma_f32_16x16x32_bf16 v[172:175], a[248:251], v[56:59], v[172:175]
ds_read_b64_tr_b16 a[234:235], v11 offset:53248
v_mfma_f32_16x16x32_bf16 v[172:175], a[252:255], v[60:63], v[172:175]
v_exp_f32 v229, v109
v_mfma_f32_16x16x32_bf16 v[164:167], a[252:255], v[44:47], v[240:243]
buffer_load_dwordx4 v19, s[40:43], s76 offen offset:1024 nt lds
v_mfma_f32_16x16x32_bf16 v[164:167], a[248:251], v[40:43], v[164:167]
v_exp_f32 v230, v110
v_mfma_f32_16x16x32_bf16 v[164:167], a[244:247], v[36:39], v[164:167]
ds_read_b64_tr_b16 a[236:237], v11 offset:57344
v_cvt_pk_bf16_f32 v214, v228, v229
v_mfma_f32_16x16x32_bf16 v[164:167], a[240:243], v[32:35], v[164:167]
s_waitcnt lgkmcnt(3)
ds_read_b64_tr_b16 a[238:239], v11 offset:61440
v_mfma_f32_16x16x32_bf16 a[64:67], a[224:227], v[128:131], a[64:67]
v_exp_f32 v231, v111
v_mfma_f32_16x16x32_bf16 a[64:67], a[228:231], v[144:147], a[64:67]
ds_read_b64_tr_b16 a[240:241], v12 offset:49152
v_cvt_pk_bf16_f32 v215, v230, v231
v_mfma_f32_16x16x32_bf16 a[68:71], a[228:231], v[148:151], a[68:71]
v_exp_f32 v224, v112
v_mfma_f32_16x16x32_bf16 a[68:71], a[224:227], v[132:135], a[68:71]
ds_read_b64_tr_b16 a[242:243], v12 offset:53248
v_mfma_f32_16x16x32_bf16 a[72:75], a[224:227], v[136:139], a[72:75]
v_exp_f32 v225, v113
v_mfma_f32_16x16x32_bf16 a[72:75], a[228:231], v[152:155], a[72:75]
ds_read_b64_tr_b16 a[244:245], v12 offset:57344
v_cvt_pk_bf16_f32 v216, v224, v225
v_mfma_f32_16x16x32_bf16 a[76:79], a[228:231], v[156:159], a[76:79]
v_exp_f32 v226, v114
v_mfma_f32_16x16x32_bf16 a[76:79], a[224:227], v[140:143], a[76:79]
s_waitcnt lgkmcnt(3)
ds_read_b64_tr_b16 a[246:247], v12 offset:61440
v_mfma_f32_16x16x32_bf16 a[92:95], a[232:235], v[140:143], a[92:95]
v_exp_f32 v227, v115
v_mfma_f32_16x16x32_bf16 a[92:95], a[236:239], v[156:159], a[92:95]
ds_read_b64_tr_b16 a[248:249], v13 offset:49152
v_cvt_pk_bf16_f32 v217, v226, v227
v_mfma_f32_16x16x32_bf16 a[88:91], a[236:239], v[152:155], a[88:91]
ds_read_b64_tr_b16 a[250:251], v13 offset:53248
v_mfma_f32_16x16x32_bf16 a[88:91], a[232:235], v[136:139], a[88:91]
v_exp_f32 v228, v116
v_mfma_f32_16x16x32_bf16 a[84:87], a[232:235], v[132:135], a[84:87]
buffer_load_dwordx4 v18, s[40:43], s76 offen offset:2048 nt lds
v_mfma_f32_16x16x32_bf16 a[84:87], a[236:239], v[148:151], a[84:87]
v_exp_f32 v229, v117
v_mfma_f32_16x16x32_bf16 a[80:83], a[236:239], v[144:147], a[80:83]
ds_read_b64_tr_b16 a[252:253], v13 offset:57344
v_cvt_pk_bf16_f32 v218, v228, v229
v_mfma_f32_16x16x32_bf16 a[80:83], a[232:235], v[128:131], a[80:83]
s_waitcnt lgkmcnt(3)
v_exp_f32 v230, v118
v_mfma_f32_16x16x32_bf16 a[96:99], a[240:243], v[128:131], a[96:99]
ds_read_b64_tr_b16 a[254:255], v13 offset:61440
v_mfma_f32_16x16x32_bf16 a[96:99], a[244:247], v[144:147], a[96:99]
v_exp_f32 v231, v119
v_mfma_f32_16x16x32_bf16 a[100:103], a[244:247], v[148:151], a[100:103]
v_cvt_pk_bf16_f32 v219, v230, v231
v_mfma_f32_16x16x32_bf16 a[100:103], a[240:243], v[132:135], a[100:103]
v_exp_f32 v224, v120
v_mfma_f32_16x16x32_bf16 a[104:107], a[240:243], v[136:139], a[104:107]
ds_read_b128 a[224:227], v2 offset:8192
v_mfma_f32_16x16x32_bf16 a[104:107], a[244:247], v[152:155], a[104:107]
ds_read_b128 a[228:231], v3 offset:8192
v_mfma_f32_16x16x32_bf16 a[108:111], a[244:247], v[156:159], a[108:111]
v_exp_f32 v225, v121
v_mfma_f32_16x16x32_bf16 a[108:111], a[240:243], v[140:143], a[108:111]
s_waitcnt lgkmcnt(2)
ds_read_b128 a[232:235], v4 offset:8192
v_cvt_pk_bf16_f32 v220, v224, v225
v_mfma_f32_16x16x32_bf16 a[124:127], a[248:251], v[140:143], a[124:127]
v_exp_f32 v226, v122
v_mfma_f32_16x16x32_bf16 a[124:127], a[252:255], v[156:159], a[124:127]
ds_read_b128 a[236:239], v5 offset:8192
v_mfma_f32_16x16x32_bf16 a[120:123], a[252:255], v[152:155], a[120:123]
v_exp_f32 v227, v123
v_mfma_f32_16x16x32_bf16 a[120:123], a[248:251], v[136:139], a[120:123]
buffer_load_dwordx4 v19, s[40:43], s76 offen offset:3072 nt lds
v_mfma_f32_16x16x32_bf16 a[116:119], a[248:251], v[132:135], a[116:119]
s_xor_b32 s76, s67, 82432
v_exp_f32 v228, v124
v_mfma_f32_16x16x32_bf16 a[116:119], a[252:255], v[148:151], a[116:119]
s_add_u32 m0, s69, 49152
v_cvt_pk_bf16_f32 v221, v226, v227
v_mfma_f32_16x16x32_bf16 a[112:115], a[252:255], v[144:147], a[112:115]
v_exp_f32 v229, v125
v_mfma_f32_16x16x32_bf16 a[112:115], a[248:251], v[128:131], a[112:115]
v_cvt_pk_bf16_f32 v222, v228, v229
v_mfma_f32_16x16x32_bf16 a[136:139], a[144:147], v[136:139], a[136:139]
v_exp_f32 v230, v126
v_mfma_f32_16x16x32_bf16 a[136:139], a[144:147], v[152:155], a[136:139]
v_mfma_f32_16x16x32_bf16 a[140:143], a[144:147], v[140:143], a[140:143]
v_exp_f32 v231, v127
v_mfma_f32_16x16x32_bf16 a[140:143], a[144:147], v[156:159], a[140:143]
s_waitcnt lgkmcnt(0)
v_cvt_pk_bf16_f32 v223, v230, v231
v_mfma_f32_16x16x32_bf16 v[96:99], a[224:227], v[32:35], v[240:243]
v_exp_f32 v224, v160
v_mfma_f32_16x16x32_bf16 v[96:99], a[228:231], v[36:39], v[96:99]
ds_read_b128 a[240:243], v2 offset:12288
v_mfma_f32_16x16x32_bf16 v[96:99], a[232:235], v[40:43], v[96:99]
v_exp_f32 v225, v161
v_mfma_f32_16x16x32_bf16 v[96:99], a[236:239], v[44:47], v[96:99]
ds_read_b128 a[244:247], v3 offset:12288
v_cvt_pk_bf16_f32 v128, v224, v225
v_mfma_f32_16x16x32_bf16 v[104:107], a[236:239], v[60:63], v[244:247]
v_exp_f32 v226, v162
v_mfma_f32_16x16x32_bf16 v[104:107], a[232:235], v[56:59], v[104:107]
buffer_load_dwordx4 v14, s[36:39], s76 offen nt lds
v_mfma_f32_16x16x32_bf16 v[104:107], a[228:231], v[52:55], v[104:107]
v_exp_f32 v227, v163
v_mfma_f32_16x16x32_bf16 v[104:107], a[224:227], v[48:51], v[104:107]
ds_read_b128 a[248:251], v4 offset:12288
v_cvt_pk_bf16_f32 v129, v226, v227
v_mfma_f32_16x16x32_bf16 v[112:115], a[224:227], v[64:67], v[248:251]
v_exp_f32 v228, v164
v_mfma_f32_16x16x32_bf16 v[112:115], a[228:231], v[68:71], v[112:115]
ds_read_b128 a[252:255], v5 offset:12288
v_mfma_f32_16x16x32_bf16 v[112:115], a[232:235], v[72:75], v[112:115]
v_exp_f32 v229, v165
v_mfma_f32_16x16x32_bf16 v[112:115], a[236:239], v[76:79], v[112:115]
v_cvt_pk_bf16_f32 v130, v228, v229
L_hop1_0:
s_cbranch_execz L_hop_ret1
v_mfma_f32_16x16x32_bf16 v[120:123], a[236:239], v[92:95], v[252:255]
v_exp_f32 v230, v166
v_mfma_f32_16x16x32_bf16 v[120:123], a[232:235], v[88:91], v[120:123]
v_mfma_f32_16x16x32_bf16 v[120:123], a[228:231], v[84:87], v[120:123]
v_exp_f32 v231, v167
v_mfma_f32_16x16x32_bf16 v[120:123], a[224:227], v[80:83], v[120:123]
s_waitcnt vmcnt(10) lgkmcnt(0)
s_barrier
ds_read_b64_tr_b16 a[224:225], v6 offset:16384
v_mfma_f32_16x16x32_bf16 v[124:127], a[240:243], v[80:83], v[252:255]
s_xor_b32 s76, s67, 82432
v_exp_f32 v224, v168
v_mfma_f32_16x16x32_bf16 v[124:127], a[244:247], v[84:87], v[124:127]
s_add_u32 m0, s69, 49152
ds_read_b64_tr_b16 a[226:227], v6 offset:20480
v_cvt_pk_bf16_f32 v131, v230, v231
v_mfma_f32_16x16x32_bf16 v[124:127], a[248:251], v[88:91], v[124:127]
v_exp_f32 v225, v169
v_mfma_f32_16x16x32_bf16 v[124:127], a[252:255], v[92:95], v[124:127]
ds_read_b64_tr_b16 a[228:229], v6 offset:24576
v_cvt_pk_bf16_f32 v132, v224, v225
v_mfma_f32_16x16x32_bf16 v[116:119], a[252:255], v[76:79], v[248:251]
ds_read_b64_tr_b16 a[230:231], v6 offset:28672
v_mfma_f32_16x16x32_bf16 v[116:119], a[248:251], v[72:75], v[116:119]
v_exp_f32 v226, v170
v_mfma_f32_16x16x32_bf16 v[116:119], a[244:247], v[68:71], v[116:119]
ds_read_b64_tr_b16 a[232:233], v7 offset:16384
v_mfma_f32_16x16x32_bf16 v[116:119], a[240:243], v[64:67], v[116:119]
v_exp_f32 v227, v171
v_mfma_f32_16x16x32_bf16 v[108:111], a[240:243], v[48:51], v[244:247]
buffer_load_dwordx4 v15, s[36:39], s76 offen offset:1024 nt lds
v_mfma_f32_16x16x32_bf16 v[108:111], a[244:247], v[52:55], v[108:111]
v_exp_f32 v228, v172
v_mfma_f32_16x16x32_bf16 v[108:111], a[248:251], v[56:59], v[108:111]
ds_read_b64_tr_b16 a[234:235], v7 offset:20480
v_cvt_pk_bf16_f32 v133, v226, v227
v_mfma_f32_16x16x32_bf16 v[108:111], a[252:255], v[60:63], v[108:111]
v_exp_f32 v229, v173
v_mfma_f32_16x16x32_bf16 v[100:103], a[252:255], v[44:47], v[240:243]
ds_read_b64_tr_b16 a[236:237], v7 offset:24576
v_cvt_pk_bf16_f32 v134, v228, v229
v_mfma_f32_16x16x32_bf16 v[100:103], a[248:251], v[40:43], v[100:103]
v_exp_f32 v230, v174
v_mfma_f32_16x16x32_bf16 v[100:103], a[244:247], v[36:39], v[100:103]
ds_read_b64_tr_b16 a[238:239], v7 offset:28672
v_mfma_f32_16x16x32_bf16 v[100:103], a[240:243], v[32:35], v[100:103]
s_waitcnt lgkmcnt(4)
ds_read_b64_tr_b16 a[240:241], v8 offset:16384
v_mfma_f32_16x16x32_bf16 a[0:3], a[224:227], v[192:195], a[0:3]
v_exp_f32 v231, v175
v_mfma_f32_16x16x32_bf16 a[0:3], a[228:231], v[208:211], a[0:3]
ds_read_b64_tr_b16 a[242:243], v8 offset:20480
v_cvt_pk_bf16_f32 v135, v230, v231
v_mfma_f32_16x16x32_bf16 a[4:7], a[228:231], v[212:215], a[4:7]
v_exp_f32 v224, v176
v_mfma_f32_16x16x32_bf16 a[4:7], a[224:227], v[196:199], a[4:7]
ds_read_b64_tr_b16 a[244:245], v8 offset:24576
v_mfma_f32_16x16x32_bf16 a[8:11], a[224:227], v[200:203], a[8:11]
v_exp_f32 v225, v177
v_mfma_f32_16x16x32_bf16 a[8:11], a[228:231], v[216:219], a[8:11]
ds_read_b64_tr_b16 a[246:247], v8 offset:28672
v_cvt_pk_bf16_f32 v136, v224, v225
v_mfma_f32_16x16x32_bf16 a[12:15], a[228:231], v[220:223], a[12:15]
v_exp_f32 v226, v178
v_mfma_f32_16x16x32_bf16 a[12:15], a[224:227], v[204:207], a[12:15]
s_waitcnt lgkmcnt(4)
buffer_load_dwordx4 v16, s[36:39], s76 offen offset:2048 nt lds
v_mfma_f32_16x16x32_bf16 a[28:31], a[232:235], v[204:207], a[28:31]
v_exp_f32 v227, v179
v_mfma_f32_16x16x32_bf16 a[28:31], a[236:239], v[220:223], a[28:31]
ds_read_b64_tr_b16 a[248:249], v9 offset:16384
v_cvt_pk_bf16_f32 v137, v226, v227
v_mfma_f32_16x16x32_bf16 a[24:27], a[236:239], v[216:219], a[24:27]
ds_read_b64_tr_b16 a[250:251], v9 offset:20480
v_mfma_f32_16x16x32_bf16 a[24:27], a[232:235], v[200:203], a[24:27]
v_exp_f32 v228, v180
v_mfma_f32_16x16x32_bf16 a[20:23], a[232:235], v[196:199], a[20:23]
ds_read_b64_tr_b16 a[252:253], v9 offset:24576
v_mfma_f32_16x16x32_bf16 a[20:23], a[236:239], v[212:215], a[20:23]
v_exp_f32 v229, v181
v_mfma_f32_16x16x32_bf16 a[16:19], a[236:239], v[208:211], a[16:19]
ds_read_b64_tr_b16 a[254:255], v9 offset:28672
v_cvt_pk_bf16_f32 v138, v228, v229
v_mfma_f32_16x16x32_bf16 a[16:19], a[232:235], v[192:195], a[16:19]
s_waitcnt lgkmcnt(4)
v_exp_f32 v230, v182
v_mfma_f32_16x16x32_bf16 a[32:35], a[240:243], v[192:195], a[32:35]
v_mfma_f32_16x16x32_bf16 a[32:35], a[244:247], v[208:211], a[32:35]
v_exp_f32 v231, v183
v_mfma_f32_16x16x32_bf16 a[36:39], a[244:247], v[212:215], a[36:39]
v_cvt_pk_bf16_f32 v139, v230, v231
v_mfma_f32_16x16x32_bf16 a[36:39], a[240:243], v[196:199], a[36:39]
v_exp_f32 v224, v184
v_mfma_f32_16x16x32_bf16 a[40:43], a[240:243], v[200:203], a[40:43]
buffer_load_dwordx4 v17, s[36:39], s76 offen offset:3072 nt lds
v_mfma_f32_16x16x32_bf16 a[40:43], a[244:247], v[216:219], a[40:43]
s_xor_b32 s76, s67, 66048
ds_read_b128 a[224:227], v2 offset:16384
v_mfma_f32_16x16x32_bf16 a[44:47], a[244:247], v[220:223], a[44:47]
s_add_u32 m0, s69, 98304
v_exp_f32 v225, v185
v_mfma_f32_16x16x32_bf16 a[44:47], a[240:243], v[204:207], a[44:47]
s_waitcnt lgkmcnt(1)
ds_read_b128 a[228:231], v3 offset:16384
v_cvt_pk_bf16_f32 v140, v224, v225
v_mfma_f32_16x16x32_bf16 a[60:63], a[248:251], v[204:207], a[60:63]
v_exp_f32 v226, v186
v_mfma_f32_16x16x32_bf16 a[60:63], a[252:255], v[220:223], a[60:63]
ds_read_b128 a[232:235], v4 offset:16384
v_mfma_f32_16x16x32_bf16 a[56:59], a[252:255], v[216:219], a[56:59]
v_exp_f32 v227, v187
v_mfma_f32_16x16x32_bf16 a[56:59], a[248:251], v[200:203], a[56:59]
ds_read_b128 a[236:239], v5 offset:16384
v_cvt_pk_bf16_f32 v141, v226, v227
v_mfma_f32_16x16x32_bf16 a[52:55], a[248:251], v[196:199], a[52:55]
v_exp_f32 v228, v188
v_mfma_f32_16x16x32_bf16 a[52:55], a[252:255], v[212:215], a[52:55]
v_mfma_f32_16x16x32_bf16 a[48:51], a[252:255], v[208:211], a[48:51]
v_exp_f32 v229, v189
v_mfma_f32_16x16x32_bf16 a[48:51], a[248:251], v[192:195], a[48:51]
v_cvt_pk_bf16_f32 v142, v228, v229
v_mfma_f32_16x16x32_bf16 a[128:131], a[144:147], v[192:195], a[128:131]
v_exp_f32 v230, v190
v_mfma_f32_16x16x32_bf16 a[128:131], a[144:147], v[208:211], a[128:131]
v_mfma_f32_16x16x32_bf16 a[132:135], a[144:147], v[196:199], a[132:135]
v_exp_f32 v231, v191
v_mfma_f32_16x16x32_bf16 a[132:135], a[144:147], v[212:215], a[132:135]
s_waitcnt lgkmcnt(0)
buffer_load_dwordx4 v18, s[40:43], s76 offen nt lds
v_mfma_f32_16x16x32_bf16 v[160:163], a[224:227], v[32:35], v[240:243]
v_exp_f32 v224, v96
v_mfma_f32_16x16x32_bf16 v[160:163], a[228:231], v[36:39], v[160:163]
ds_read_b128 a[240:243], v2 offset:20480
v_cvt_pk_bf16_f32 v143, v230, v231
v_mfma_f32_16x16x32_bf16 v[160:163], a[232:235], v[40:43], v[160:163]
v_exp_f32 v225, v97
v_mfma_f32_16x16x32_bf16 v[160:163], a[236:239], v[44:47], v[160:163]
ds_read_b128 a[244:247], v3 offset:20480
v_cvt_pk_bf16_f32 v144, v224, v225
v_mfma_f32_16x16x32_bf16 v[168:171], a[236:239], v[60:63], v[244:247]
v_exp_f32 v226, v98
v_mfma_f32_16x16x32_bf16 v[168:171], a[232:235], v[56:59], v[168:171]
ds_read_b128 a[248:251], v4 offset:20480
v_mfma_f32_16x16x32_bf16 v[168:171], a[228:231], v[52:55], v[168:171]
v_exp_f32 v227, v99
v_mfma_f32_16x16x32_bf16 v[168:171], a[224:227], v[48:51], v[168:171]
ds_read_b128 a[252:255], v5 offset:20480
v_cvt_pk_bf16_f32 v145, v226, v227
v_mfma_f32_16x16x32_bf16 v[176:179], a[224:227], v[64:67], v[248:251]
v_exp_f32 v228, v100
v_mfma_f32_16x16x32_bf16 v[176:179], a[228:231], v[68:71], v[176:179]
v_mfma_f32_16x16x32_bf16 v[176:179], a[232:235], v[72:75], v[176:179]
v_exp_f32 v229, v101
v_mfma_f32_16x16x32_bf16 v[176:179], a[236:239], v[76:79], v[176:179]
v_cvt_pk_bf16_f32 v146, v228, v229
v_mfma_f32_16x16x32_bf16 v[184:187], a[236:239], v[92:95], v[252:255]
v_exp_f32 v230, v102
v_mfma_f32_16x16x32_bf16 v[184:187], a[232:235], v[88:91], v[184:187]
v_mfma_f32_16x16x32_bf16 v[184:187], a[228:231], v[84:87], v[184:187]
v_exp_f32 v231, v103
v_mfma_f32_16x16x32_bf16 v[184:187], a[224:227], v[80:83], v[184:187]
s_waitcnt lgkmcnt(0)
buffer_store_dwordx4 a[156:159], v238, s[52:55], s11 offen offset:2048 sc1
v_mfma_f32_16x16x32_bf16 v[188:191], a[240:243], v[80:83], v[252:255]
v_exp_f32 v224, v104
v_mfma_f32_16x16x32_bf16 v[188:191], a[244:247], v[84:87], v[188:191]
ds_read_b64_tr_b16 a[224:225], v10 offset:16384
v_cvt_pk_bf16_f32 v147, v230, v231
v_mfma_f32_16x16x32_bf16 v[188:191], a[248:251], v[88:91], v[188:191]
v_exp_f32 v225, v105
v_mfma_f32_16x16x32_bf16 v[188:191], a[252:255], v[92:95], v[188:191]
ds_read_b64_tr_b16 a[226:227], v10 offset:20480
v_cvt_pk_bf16_f32 v148, v224, v225
v_mfma_f32_16x16x32_bf16 v[180:183], a[252:255], v[76:79], v[248:251]
ds_read_b64_tr_b16 a[228:229], v10 offset:24576
v_mfma_f32_16x16x32_bf16 v[180:183], a[248:251], v[72:75], v[180:183]
v_exp_f32 v226, v106
v_mfma_f32_16x16x32_bf16 v[180:183], a[244:247], v[68:71], v[180:183]
ds_read_b64_tr_b16 a[230:231], v10 offset:28672
v_mfma_f32_16x16x32_bf16 v[180:183], a[240:243], v[64:67], v[180:183]
v_exp_f32 v227, v107
v_mfma_f32_16x16x32_bf16 v[172:175], a[240:243], v[48:51], v[244:247]
ds_read_b64_tr_b16 a[232:233], v11 offset:16384
v_cvt_pk_bf16_f32 v149, v226, v227
v_mfma_f32_16x16x32_bf16 v[172:175], a[244:247], v[52:55], v[172:175]
v_exp_f32 v228, v108
v_mfma_f32_16x16x32_bf16 v[172:175], a[248:251], v[56:59], v[172:175]
ds_read_b64_tr_b16 a[234:235], v11 offset:20480
v_mfma_f32_16x16x32_bf16 v[172:175], a[252:255], v[60:63], v[172:175]
v_exp_f32 v229, v109
v_mfma_f32_16x16x32_bf16 v[164:167], a[252:255], v[44:47], v[240:243]
buffer_load_dwordx4 v19, s[40:43], s76 offen offset:1024 nt lds
v_mfma_f32_16x16x32_bf16 v[164:167], a[248:251], v[40:43], v[164:167]
v_exp_f32 v230, v110
v_mfma_f32_16x16x32_bf16 v[164:167], a[244:247], v[36:39], v[164:167]
ds_read_b64_tr_b16 a[236:237], v11 offset:24576
v_cvt_pk_bf16_f32 v150, v228, v229
v_mfma_f32_16x16x32_bf16 v[164:167], a[240:243], v[32:35], v[164:167]
s_waitcnt lgkmcnt(3)
ds_read_b64_tr_b16 a[238:239], v11 offset:28672
v_mfma_f32_16x16x32_bf16 a[64:67], a[224:227], v[192:195], a[64:67]
v_exp_f32 v231, v111
v_mfma_f32_16x16x32_bf16 a[64:67], a[228:231], v[208:211], a[64:67]
ds_read_b64_tr_b16 a[240:241], v12 offset:16384
v_cvt_pk_bf16_f32 v151, v230, v231
v_mfma_f32_16x16x32_bf16 a[68:71], a[228:231], v[212:215], a[68:71]
v_exp_f32 v224, v112
v_mfma_f32_16x16x32_bf16 a[68:71], a[224:227], v[196:199], a[68:71]
ds_read_b64_tr_b16 a[242:243], v12 offset:20480
v_mfma_f32_16x16x32_bf16 a[72:75], a[224:227], v[200:203], a[72:75]
v_exp_f32 v225, v113
v_mfma_f32_16x16x32_bf16 a[72:75], a[228:231], v[216:219], a[72:75]
ds_read_b64_tr_b16 a[244:245], v12 offset:24576
v_cvt_pk_bf16_f32 v152, v224, v225
v_mfma_f32_16x16x32_bf16 a[76:79], a[228:231], v[220:223], a[76:79]
v_exp_f32 v226, v114
v_mfma_f32_16x16x32_bf16 a[76:79], a[224:227], v[204:207], a[76:79]
s_waitcnt lgkmcnt(3)
ds_read_b64_tr_b16 a[246:247], v12 offset:28672
v_mfma_f32_16x16x32_bf16 a[92:95], a[232:235], v[204:207], a[92:95]
v_exp_f32 v227, v115
v_mfma_f32_16x16x32_bf16 a[92:95], a[236:239], v[220:223], a[92:95]
ds_read_b64_tr_b16 a[248:249], v13 offset:16384
v_cvt_pk_bf16_f32 v153, v226, v227
v_mfma_f32_16x16x32_bf16 a[88:91], a[236:239], v[216:219], a[88:91]
ds_read_b64_tr_b16 a[250:251], v13 offset:20480
v_mfma_f32_16x16x32_bf16 a[88:91], a[232:235], v[200:203], a[88:91]
v_exp_f32 v228, v116
v_mfma_f32_16x16x32_bf16 a[84:87], a[232:235], v[196:199], a[84:87]
buffer_load_dwordx4 v18, s[40:43], s76 offen offset:2048 nt lds
v_mfma_f32_16x16x32_bf16 a[84:87], a[236:239], v[212:215], a[84:87]
v_exp_f32 v229, v117
v_mfma_f32_16x16x32_bf16 a[80:83], a[236:239], v[208:211], a[80:83]
ds_read_b64_tr_b16 a[252:253], v13 offset:24576
v_cvt_pk_bf16_f32 v154, v228, v229
v_mfma_f32_16x16x32_bf16 a[80:83], a[232:235], v[192:195], a[80:83]
s_waitcnt lgkmcnt(3)
v_exp_f32 v230, v118
v_mfma_f32_16x16x32_bf16 a[96:99], a[240:243], v[192:195], a[96:99]
ds_read_b64_tr_b16 a[254:255], v13 offset:28672
v_mfma_f32_16x16x32_bf16 a[96:99], a[244:247], v[208:211], a[96:99]
v_exp_f32 v231, v119
v_mfma_f32_16x16x32_bf16 a[100:103], a[244:247], v[212:215], a[100:103]
v_cvt_pk_bf16_f32 v155, v230, v231
v_mfma_f32_16x16x32_bf16 a[100:103], a[240:243], v[196:199], a[100:103]
v_exp_f32 v224, v120
v_mfma_f32_16x16x32_bf16 a[104:107], a[240:243], v[200:203], a[104:107]
ds_read_b128 a[224:227], v2 offset:24576
v_mfma_f32_16x16x32_bf16 a[104:107], a[244:247], v[216:219], a[104:107]
ds_read_b128 a[228:231], v3 offset:24576
v_mfma_f32_16x16x32_bf16 a[108:111], a[244:247], v[220:223], a[108:111]
v_exp_f32 v225, v121
v_mfma_f32_16x16x32_bf16 a[108:111], a[240:243], v[204:207], a[108:111]
s_waitcnt lgkmcnt(2)
ds_read_b128 a[232:235], v4 offset:24576
v_cvt_pk_bf16_f32 v156, v224, v225
v_mfma_f32_16x16x32_bf16 a[124:127], a[248:251], v[204:207], a[124:127]
v_exp_f32 v226, v122
v_mfma_f32_16x16x32_bf16 a[124:127], a[252:255], v[220:223], a[124:127]
ds_read_b128 a[236:239], v5 offset:24576
v_mfma_f32_16x16x32_bf16 a[120:123], a[252:255], v[216:219], a[120:123]
v_exp_f32 v227, v123
v_mfma_f32_16x16x32_bf16 a[120:123], a[248:251], v[200:203], a[120:123]
buffer_load_dwordx4 v19, s[40:43], s76 offen offset:3072 nt lds
v_mfma_f32_16x16x32_bf16 a[116:119], a[248:251], v[196:199], a[116:119]
s_xor_b32 s76, s67, 131072
v_exp_f32 v228, v124
v_mfma_f32_16x16x32_bf16 a[116:119], a[252:255], v[212:215], a[116:119]
s_add_u32 m0, s69, 0
v_cvt_pk_bf16_f32 v157, v226, v227
v_mfma_f32_16x16x32_bf16 a[112:115], a[252:255], v[208:211], a[112:115]
v_exp_f32 v229, v125
v_mfma_f32_16x16x32_bf16 a[112:115], a[248:251], v[192:195], a[112:115]
v_cvt_pk_bf16_f32 v158, v228, v229
v_mfma_f32_16x16x32_bf16 a[136:139], a[144:147], v[200:203], a[136:139]
v_exp_f32 v230, v126
v_mfma_f32_16x16x32_bf16 a[136:139], a[144:147], v[216:219], a[136:139]
v_mfma_f32_16x16x32_bf16 a[140:143], a[144:147], v[204:207], a[140:143]
v_exp_f32 v231, v127
v_mfma_f32_16x16x32_bf16 a[140:143], a[144:147], v[220:223], a[140:143]
s_waitcnt lgkmcnt(0)
v_cvt_pk_bf16_f32 v159, v230, v231
v_mfma_f32_16x16x32_bf16 v[96:99], a[224:227], v[32:35], v[240:243]
v_exp_f32 v224, v160
v_mfma_f32_16x16x32_bf16 v[96:99], a[228:231], v[36:39], v[96:99]
ds_read_b128 a[240:243], v2 offset:28672
v_mfma_f32_16x16x32_bf16 v[96:99], a[232:235], v[40:43], v[96:99]
v_exp_f32 v225, v161
v_mfma_f32_16x16x32_bf16 v[96:99], a[236:239], v[44:47], v[96:99]
ds_read_b128 a[244:247], v3 offset:28672
v_cvt_pk_bf16_f32 v192, v224, v225
v_mfma_f32_16x16x32_bf16 v[104:107], a[236:239], v[60:63], v[244:247]
v_exp_f32 v226, v162
v_mfma_f32_16x16x32_bf16 v[104:107], a[232:235], v[56:59], v[104:107]
buffer_load_dwordx4 v14, s[36:39], s76 offen nt lds
v_mfma_f32_16x16x32_bf16 v[104:107], a[228:231], v[52:55], v[104:107]
v_exp_f32 v227, v163
v_mfma_f32_16x16x32_bf16 v[104:107], a[224:227], v[48:51], v[104:107]
ds_read_b128 a[248:251], v4 offset:28672
v_cvt_pk_bf16_f32 v193, v226, v227
v_mfma_f32_16x16x32_bf16 v[112:115], a[224:227], v[64:67], v[248:251]
v_exp_f32 v228, v164
v_mfma_f32_16x16x32_bf16 v[112:115], a[228:231], v[68:71], v[112:115]
ds_read_b128 a[252:255], v5 offset:28672
v_mfma_f32_16x16x32_bf16 v[112:115], a[232:235], v[72:75], v[112:115]
v_exp_f32 v229, v165
v_mfma_f32_16x16x32_bf16 v[112:115], a[236:239], v[76:79], v[112:115]
v_cvt_pk_bf16_f32 v194, v228, v229
v_mfma_f32_16x16x32_bf16 v[120:123], a[236:239], v[92:95], v[252:255]
v_exp_f32 v230, v166
v_mfma_f32_16x16x32_bf16 v[120:123], a[232:235], v[88:91], v[120:123]
v_mfma_f32_16x16x32_bf16 v[120:123], a[228:231], v[84:87], v[120:123]
v_exp_f32 v231, v167
v_mfma_f32_16x16x32_bf16 v[120:123], a[224:227], v[80:83], v[120:123]
s_waitcnt vmcnt(10) lgkmcnt(0)
s_barrier
ds_read_b64_tr_b16 a[224:225], v6 offset:0
v_mfma_f32_16x16x32_bf16 v[124:127], a[240:243], v[80:83], v[252:255]
s_xor_b32 s76, s67, 131072
v_exp_f32 v224, v168
v_mfma_f32_16x16x32_bf16 v[124:127], a[244:247], v[84:87], v[124:127]
s_add_u32 m0, s69, 0
ds_read_b64_tr_b16 a[226:227], v6 offset:4096
v_cvt_pk_bf16_f32 v195, v230, v231
v_mfma_f32_16x16x32_bf16 v[124:127], a[248:251], v[88:91], v[124:127]
v_exp_f32 v225, v169
v_mfma_f32_16x16x32_bf16 v[124:127], a[252:255], v[92:95], v[124:127]
ds_read_b64_tr_b16 a[228:229], v6 offset:8192
v_cvt_pk_bf16_f32 v196, v224, v225
v_mfma_f32_16x16x32_bf16 v[116:119], a[252:255], v[76:79], v[248:251]
ds_read_b64_tr_b16 a[230:231], v6 offset:12288
v_mfma_f32_16x16x32_bf16 v[116:119], a[248:251], v[72:75], v[116:119]
v_exp_f32 v226, v170
v_mfma_f32_16x16x32_bf16 v[116:119], a[244:247], v[68:71], v[116:119]
ds_read_b64_tr_b16 a[232:233], v7 offset:0
v_mfma_f32_16x16x32_bf16 v[116:119], a[240:243], v[64:67], v[116:119]
v_exp_f32 v227, v171
v_mfma_f32_16x16x32_bf16 v[108:111], a[240:243], v[48:51], v[244:247]
buffer_load_dwordx4 v15, s[36:39], s76 offen offset:1024 nt lds
v_mfma_f32_16x16x32_bf16 v[108:111], a[244:247], v[52:55], v[108:111]
v_exp_f32 v228, v172
v_mfma_f32_16x16x32_bf16 v[108:111], a[248:251], v[56:59], v[108:111]
ds_read_b64_tr_b16 a[234:235], v7 offset:4096
v_cvt_pk_bf16_f32 v197, v226, v227
v_mfma_f32_16x16x32_bf16 v[108:111], a[252:255], v[60:63], v[108:111]
v_exp_f32 v229, v173
v_mfma_f32_16x16x32_bf16 v[100:103], a[252:255], v[44:47], v[240:243]
ds_read_b64_tr_b16 a[236:237], v7 offset:8192
v_cvt_pk_bf16_f32 v198, v228, v229
v_mfma_f32_16x16x32_bf16 v[100:103], a[248:251], v[40:43], v[100:103]
v_exp_f32 v230, v174
v_mfma_f32_16x16x32_bf16 v[100:103], a[244:247], v[36:39], v[100:103]
ds_read_b64_tr_b16 a[238:239], v7 offset:12288
v_mfma_f32_16x16x32_bf16 v[100:103], a[240:243], v[32:35], v[100:103]
s_waitcnt lgkmcnt(4)
ds_read_b64_tr_b16 a[240:241], v8 offset:0
v_mfma_f32_16x16x32_bf16 a[0:3], a[224:227], v[128:131], a[0:3]
v_exp_f32 v231, v175
v_mfma_f32_16x16x32_bf16 a[0:3], a[228:231], v[144:147], a[0:3]
ds_read_b64_tr_b16 a[242:243], v8 offset:4096
v_cvt_pk_bf16_f32 v199, v230, v231
v_mfma_f32_16x16x32_bf16 a[4:7], a[228:231], v[148:151], a[4:7]
v_exp_f32 v224, v176
v_mfma_f32_16x16x32_bf16 a[4:7], a[224:227], v[132:135], a[4:7]
ds_read_b64_tr_b16 a[244:245], v8 offset:8192
v_mfma_f32_16x16x32_bf16 a[8:11], a[224:227], v[136:139], a[8:11]
v_exp_f32 v225, v177
v_mfma_f32_16x16x32_bf16 a[8:11], a[228:231], v[152:155], a[8:11]
ds_read_b64_tr_b16 a[246:247], v8 offset:12288
v_cvt_pk_bf16_f32 v200, v224, v225
v_mfma_f32_16x16x32_bf16 a[12:15], a[228:231], v[156:159], a[12:15]
v_exp_f32 v226, v178
v_mfma_f32_16x16x32_bf16 a[12:15], a[224:227], v[140:143], a[12:15]
s_waitcnt lgkmcnt(4)
buffer_load_dwordx4 v16, s[36:39], s76 offen offset:2048 nt lds
v_mfma_f32_16x16x32_bf16 a[28:31], a[232:235], v[140:143], a[28:31]
v_exp_f32 v227, v179
v_mfma_f32_16x16x32_bf16 a[28:31], a[236:239], v[156:159], a[28:31]
ds_read_b64_tr_b16 a[248:249], v9 offset:0
v_cvt_pk_bf16_f32 v201, v226, v227
v_mfma_f32_16x16x32_bf16 a[24:27], a[236:239], v[152:155], a[24:27]
ds_read_b64_tr_b16 a[250:251], v9 offset:4096
v_mfma_f32_16x16x32_bf16 a[24:27], a[232:235], v[136:139], a[24:27]
v_exp_f32 v228, v180
v_mfma_f32_16x16x32_bf16 a[20:23], a[232:235], v[132:135], a[20:23]
ds_read_b64_tr_b16 a[252:253], v9 offset:8192
v_mfma_f32_16x16x32_bf16 a[20:23], a[236:239], v[148:151], a[20:23]
v_exp_f32 v229, v181
v_mfma_f32_16x16x32_bf16 a[16:19], a[236:239], v[144:147], a[16:19]
ds_read_b64_tr_b16 a[254:255], v9 offset:12288
v_cvt_pk_bf16_f32 v202, v228, v229
v_mfma_f32_16x16x32_bf16 a[16:19], a[232:235], v[128:131], a[16:19]
s_waitcnt lgkmcnt(4)
v_exp_f32 v230, v182
v_mfma_f32_16x16x32_bf16 a[32:35], a[240:243], v[128:131], a[32:35]
v_mfma_f32_16x16x32_bf16 a[32:35], a[244:247], v[144:147], a[32:35]
v_exp_f32 v231, v183
v_mfma_f32_16x16x32_bf16 a[36:39], a[244:247], v[148:151], a[36:39]
v_cvt_pk_bf16_f32 v203, v230, v231
v_mfma_f32_16x16x32_bf16 a[36:39], a[240:243], v[132:135], a[36:39]
v_exp_f32 v224, v184
v_mfma_f32_16x16x32_bf16 a[40:43], a[240:243], v[136:139], a[40:43]
buffer_load_dwordx4 v17, s[36:39], s76 offen offset:3072 nt lds
v_mfma_f32_16x16x32_bf16 a[40:43], a[244:247], v[152:155], a[40:43]
s_xor_b32 s76, s67, 16896
ds_read_b128 a[224:227], v2 offset:32768
v_mfma_f32_16x16x32_bf16 a[44:47], a[244:247], v[156:159], a[44:47]
s_add_u32 m0, s69, 114688
v_exp_f32 v225, v185
v_mfma_f32_16x16x32_bf16 a[44:47], a[240:243], v[140:143], a[44:47]
s_waitcnt lgkmcnt(1)
ds_read_b128 a[228:231], v3 offset:32768
v_cvt_pk_bf16_f32 v204, v224, v225
v_mfma_f32_16x16x32_bf16 a[60:63], a[248:251], v[140:143], a[60:63]
v_exp_f32 v226, v186
v_mfma_f32_16x16x32_bf16 a[60:63], a[252:255], v[156:159], a[60:63]
ds_read_b128 a[232:235], v4 offset:32768
v_mfma_f32_16x16x32_bf16 a[56:59], a[252:255], v[152:155], a[56:59]
v_exp_f32 v227, v187
v_mfma_f32_16x16x32_bf16 a[56:59], a[248:251], v[136:139], a[56:59]
ds_read_b128 a[236:239], v5 offset:32768
v_cvt_pk_bf16_f32 v205, v226, v227
v_mfma_f32_16x16x32_bf16 a[52:55], a[248:251], v[132:135], a[52:55]
v_exp_f32 v228, v188
v_mfma_f32_16x16x32_bf16 a[52:55], a[252:255], v[148:151], a[52:55]
v_mfma_f32_16x16x32_bf16 a[48:51], a[252:255], v[144:147], a[48:51]
v_exp_f32 v229, v189
v_mfma_f32_16x16x32_bf16 a[48:51], a[248:251], v[128:131], a[48:51]
v_cvt_pk_bf16_f32 v206, v228, v229
v_mfma_f32_16x16x32_bf16 a[128:131], a[144:147], v[128:131], a[128:131]
v_exp_f32 v230, v190
v_mfma_f32_16x16x32_bf16 a[128:131], a[144:147], v[144:147], a[128:131]
v_mfma_f32_16x16x32_bf16 a[132:135], a[144:147], v[132:135], a[132:135]
v_exp_f32 v231, v191
v_mfma_f32_16x16x32_bf16 a[132:135], a[144:147], v[148:151], a[132:135]
s_waitcnt lgkmcnt(0)
buffer_load_dwordx4 v18, s[40:43], s76 offen nt lds
v_mfma_f32_16x16x32_bf16 v[160:163], a[224:227], v[32:35], v[240:243]
v_exp_f32 v224, v96
v_mfma_f32_16x16x32_bf16 v[160:163], a[228:231], v[36:39], v[160:163]
ds_read_b128 a[240:243], v2 offset:36864
v_cvt_pk_bf16_f32 v207, v230, v231
v_mfma_f32_16x16x32_bf16 v[160:163], a[232:235], v[40:43], v[160:163]
v_exp_f32 v225, v97
v_mfma_f32_16x16x32_bf16 v[160:163], a[236:239], v[44:47], v[160:163]
ds_read_b128 a[244:247], v3 offset:36864
v_cvt_pk_bf16_f32 v208, v224, v225
v_mfma_f32_16x16x32_bf16 v[168:171], a[236:239], v[60:63], v[244:247]
v_exp_f32 v226, v98
v_mfma_f32_16x16x32_bf16 v[168:171], a[232:235], v[56:59], v[168:171]
ds_read_b128 a[248:251], v4 offset:36864
v_mfma_f32_16x16x32_bf16 v[168:171], a[228:231], v[52:55], v[168:171]
v_exp_f32 v227, v99
v_mfma_f32_16x16x32_bf16 v[168:171], a[224:227], v[48:51], v[168:171]
ds_read_b128 a[252:255], v5 offset:36864
v_cvt_pk_bf16_f32 v209, v226, v227
v_mfma_f32_16x16x32_bf16 v[176:179], a[224:227], v[64:67], v[248:251]
v_exp_f32 v228, v100
v_mfma_f32_16x16x32_bf16 v[176:179], a[228:231], v[68:71], v[176:179]
v_mfma_f32_16x16x32_bf16 v[176:179], a[232:235], v[72:75], v[176:179]
v_exp_f32 v229, v101
v_mfma_f32_16x16x32_bf16 v[176:179], a[236:239], v[76:79], v[176:179]
v_cvt_pk_bf16_f32 v210, v228, v229
v_mfma_f32_16x16x32_bf16 v[184:187], a[236:239], v[92:95], v[252:255]
v_exp_f32 v230, v102
v_mfma_f32_16x16x32_bf16 v[184:187], a[232:235], v[88:91], v[184:187]
v_mfma_f32_16x16x32_bf16 v[184:187], a[228:231], v[84:87], v[184:187]
v_exp_f32 v231, v103
v_mfma_f32_16x16x32_bf16 v[184:187], a[224:227], v[80:83], v[184:187]
s_waitcnt lgkmcnt(0)
buffer_store_dwordx4 a[160:163], v238, s[52:55], s11 offen offset:3072 sc1
v_mfma_f32_16x16x32_bf16 v[188:191], a[240:243], v[80:83], v[252:255]
v_exp_f32 v224, v104
v_mfma_f32_16x16x32_bf16 v[188:191], a[244:247], v[84:87], v[188:191]
ds_read_b64_tr_b16 a[224:225], v10 offset:0
v_cvt_pk_bf16_f32 v211, v230, v231
v_mfma_f32_16x16x32_bf16 v[188:191], a[248:251], v[88:91], v[188:191]
v_exp_f32 v225, v105
v_mfma_f32_16x16x32_bf16 v[188:191], a[252:255], v[92:95], v[188:191]
ds_read_b64_tr_b16 a[226:227], v10 offset:4096
v_cvt_pk_bf16_f32 v212, v224, v225
v_mfma_f32_16x16x32_bf16 v[180:183], a[252:255], v[76:79], v[248:251]
ds_read_b64_tr_b16 a[228:229], v10 offset:8192
v_mfma_f32_16x16x32_bf16 v[180:183], a[248:251], v[72:75], v[180:183]
v_exp_f32 v226, v106
v_mfma_f32_16x16x32_bf16 v[180:183], a[244:247], v[68:71], v[180:183]
ds_read_b64_tr_b16 a[230:231], v10 offset:12288
v_mfma_f32_16x16x32_bf16 v[180:183], a[240:243], v[64:67], v[180:183]
v_exp_f32 v227, v107
v_mfma_f32_16x16x32_bf16 v[172:175], a[240:243], v[48:51], v[244:247]
ds_read_b64_tr_b16 a[232:233], v11 offset:0
v_cvt_pk_bf16_f32 v213, v226, v227
v_mfma_f32_16x16x32_bf16 v[172:175], a[244:247], v[52:55], v[172:175]
v_exp_f32 v228, v108
v_mfma_f32_16x16x32_bf16 v[172:175], a[248:251], v[56:59], v[172:175]
ds_read_b64_tr_b16 a[234:235], v11 offset:4096
v_mfma_f32_16x16x32_bf16 v[172:175], a[252:255], v[60:63], v[172:175]
v_exp_f32 v229, v109
v_mfma_f32_16x16x32_bf16 v[164:167], a[252:255], v[44:47], v[240:243]
buffer_load_dwordx4 v19, s[40:43], s76 offen offset:1024 nt lds
v_mfma_f32_16x16x32_bf16 v[164:167], a[248:251], v[40:43], v[164:167]
v_exp_f32 v230, v110
v_mfma_f32_16x16x32_bf16 v[164:167], a[244:247], v[36:39], v[164:167]
ds_read_b64_tr_b16 a[236:237], v11 offset:8192
v_cvt_pk_bf16_f32 v214, v228, v229
v_mfma_f32_16x16x32_bf16 v[164:167], a[240:243], v[32:35], v[164:167]
s_waitcnt lgkmcnt(3)
ds_read_b64_tr_b16 a[238:239], v11 offset:12288
v_mfma_f32_16x16x32_bf16 a[64:67], a[224:227], v[128:131], a[64:67]
v_exp_f32 v231, v111
v_mfma_f32_16x16x32_bf16 a[64:67], a[228:231], v[144:147], a[64:67]
ds_read_b64_tr_b16 a[240:241], v12 offset:0
v_cvt_pk_bf16_f32 v215, v230, v231
v_mfma_f32_16x16x32_bf16 a[68:71], a[228:231], v[148:151], a[68:71]
v_exp_f32 v224, v112
v_mfma_f32_16x16x32_bf16 a[68:71], a[224:227], v[132:135], a[68:71]
ds_read_b64_tr_b16 a[242:243], v12 offset:4096
v_mfma_f32_16x16x32_bf16 a[72:75], a[224:227], v[136:139], a[72:75]
v_exp_f32 v225, v113
v_mfma_f32_16x16x32_bf16 a[72:75], a[228:231], v[152:155], a[72:75]
ds_read_b64_tr_b16 a[244:245], v12 offset:8192
v_cvt_pk_bf16_f32 v216, v224, v225
v_mfma_f32_16x16x32_bf16 a[76:79], a[228:231], v[156:159], a[76:79]
v_exp_f32 v226, v114
v_mfma_f32_16x16x32_bf16 a[76:79], a[224:227], v[140:143], a[76:79]
s_waitcnt lgkmcnt(3)
ds_read_b64_tr_b16 a[246:247], v12 offset:12288
v_mfma_f32_16x16x32_bf16 a[92:95], a[232:235], v[140:143], a[92:95]
v_exp_f32 v227, v115
v_mfma_f32_16x16x32_bf16 a[92:95], a[236:239], v[156:159], a[92:95]
ds_read_b64_tr_b16 a[248:249], v13 offset:0
v_cvt_pk_bf16_f32 v217, v226, v227
v_mfma_f32_16x16x32_bf16 a[88:91], a[236:239], v[152:155], a[88:91]
ds_read_b64_tr_b16 a[250:251], v13 offset:4096
v_mfma_f32_16x16x32_bf16 a[88:91], a[232:235], v[136:139], a[88:91]
v_exp_f32 v228, v116
v_mfma_f32_16x16x32_bf16 a[84:87], a[232:235], v[132:135], a[84:87]
buffer_load_dwordx4 v18, s[40:43], s76 offen offset:2048 nt lds
v_mfma_f32_16x16x32_bf16 a[84:87], a[236:239], v[148:151], a[84:87]
v_exp_f32 v229, v117
v_mfma_f32_16x16x32_bf16 a[80:83], a[236:239], v[144:147], a[80:83]
ds_read_b64_tr_b16 a[252:253], v13 offset:8192
v_cvt_pk_bf16_f32 v218, v228, v229
v_mfma_f32_16x16x32_bf16 a[80:83], a[232:235], v[128:131], a[80:83]
s_waitcnt lgkmcnt(3)
v_exp_f32 v230, v118
v_mfma_f32_16x16x32_bf16 a[96:99], a[240:243], v[128:131], a[96:99]
ds_read_b64_tr_b16 a[254:255], v13 offset:12288
v_mfma_f32_16x16x32_bf16 a[96:99], a[244:247], v[144:147], a[96:99]
v_exp_f32 v231, v119
v_mfma_f32_16x16x32_bf16 a[100:103], a[244:247], v[148:151], a[100:103]
v_cvt_pk_bf16_f32 v219, v230, v231
v_mfma_f32_16x16x32_bf16 a[100:103], a[240:243], v[132:135], a[100:103]
v_exp_f32 v224, v120
v_mfma_f32_16x16x32_bf16 a[104:107], a[240:243], v[136:139], a[104:107]
ds_read_b128 a[224:227], v2 offset:40960
v_mfma_f32_16x16x32_bf16 a[104:107], a[244:247], v[152:155], a[104:107]
ds_read_b128 a[228:231], v3 offset:40960
v_mfma_f32_16x16x32_bf16 a[108:111], a[244:247], v[156:159], a[108:111]
v_exp_f32 v225, v121
v_mfma_f32_16x16x32_bf16 a[108:111], a[240:243], v[140:143], a[108:111]
s_waitcnt lgkmcnt(2)
ds_read_b128 a[232:235], v4 offset:40960
v_cvt_pk_bf16_f32 v220, v224, v225
v_mfma_f32_16x16x32_bf16 a[124:127], a[248:251], v[140:143], a[124:127]
v_exp_f32 v226, v122
v_mfma_f32_16x16x32_bf16 a[124:127], a[252:255], v[156:159], a[124:127]
ds_read_b128 a[236:239], v5 offset:40960
v_mfma_f32_16x16x32_bf16 a[120:123], a[252:255], v[152:155], a[120:123]
v_exp_f32 v227, v123
v_mfma_f32_16x16x32_bf16 a[120:123], a[248:251], v[136:139], a[120:123]
buffer_load_dwordx4 v19, s[40:43], s76 offen offset:3072 nt lds
v_mfma_f32_16x16x32_bf16 a[116:119], a[248:251], v[132:135], a[116:119]
s_xor_b32 s76, s67, 196608
v_exp_f32 v228, v124
v_mfma_f32_16x16x32_bf16 a[116:119], a[252:255], v[148:151], a[116:119]
s_add_u32 m0, s69, 16384
v_cvt_pk_bf16_f32 v221, v226, v227
v_mfma_f32_16x16x32_bf16 a[112:115], a[252:255], v[144:147], a[112:115]
v_exp_f32 v229, v125
v_mfma_f32_16x16x32_bf16 a[112:115], a[248:251], v[128:131], a[112:115]
v_cvt_pk_bf16_f32 v222, v228, v229
v_mfma_f32_16x16x32_bf16 a[136:139], a[144:147], v[136:139], a[136:139]
v_exp_f32 v230, v126
v_mfma_f32_16x16x32_bf16 a[136:139], a[144:147], v[152:155], a[136:139]
L_hop1_1:
s_cbranch_execz L_hop_ret1
v_mfma_f32_16x16x32_bf16 a[140:143], a[144:147], v[140:143], a[140:143]
v_exp_f32 v231, v127
v_mfma_f32_16x16x32_bf16 a[140:143], a[144:147], v[156:159], a[140:143]
s_waitcnt lgkmcnt(0)
v_cvt_pk_bf16_f32 v223, v230, v231
v_mfma_f32_16x16x32_bf16 v[96:99], a[224:227], v[32:35], v[240:243]
v_exp_f32 v224, v160
v_mfma_f32_16x16x32_bf16 v[96:99], a[228:231], v[36:39], v[96:99]
ds_read_b128 a[240:243], v2 offset:45056
v_mfma_f32_16x16x32_bf16 v[96:99], a[232:235], v[40:43], v[96:99]
v_exp_f32 v225, v161
v_mfma_f32_16x16x32_bf16 v[96:99], a[236:239], v[44:47], v[96:99]
ds_read_b128 a[244:247], v3 offset:45056
v_cvt_pk_bf16_f32 v128, v224, v225
v_mfma_f32_16x16x32_bf16 v[104:107], a[236:239], v[60:63], v[244:247]
v_exp_f32 v226, v162
v_mfma_f32_16x16x32_bf16 v[104:107], a[232:235], v[56:59], v[104:107]
buffer_load_dwordx4 v14, s[36:39], s76 offen nt lds
v_mfma_f32_16x16x32_bf16 v[104:107], a[228:231], v[52:55], v[104:107]
v_exp_f32 v227, v163
v_mfma_f32_16x16x32_bf16 v[104:107], a[224:227], v[48:51], v[104:107]
ds_read_b128 a[248:251], v4 offset:45056
v_cvt_pk_bf16_f32 v129, v226, v227
v_mfma_f32_16x16x32_bf16 v[112:115], a[224:227], v[64:67], v[248:251]
v_exp_f32 v228, v164
v_mfma_f32_16x16x32_bf16 v[112:115], a[228:231], v[68:71], v[112:115]
ds_read_b128 a[252:255], v5 offset:45056
v_mfma_f32_16x16x32_bf16 v[112:115], a[232:235], v[72:75], v[112:115]
v_exp_f32 v229, v165
v_mfma_f32_16x16x32_bf16 v[112:115], a[236:239], v[76:79], v[112:115]
v_cvt_pk_bf16_f32 v130, v228, v229
v_mfma_f32_16x16x32_bf16 v[120:123], a[236:239], v[92:95], v[252:255]
v_exp_f32 v230, v166
v_mfma_f32_16x16x32_bf16 v[120:123], a[232:235], v[88:91], v[120:123]
v_mfma_f32_16x16x32_bf16 v[120:123], a[228:231], v[84:87], v[120:123]
v_exp_f32 v231, v167
v_mfma_f32_16x16x32_bf16 v[120:123], a[224:227], v[80:83], v[120:123]
s_waitcnt vmcnt(10) lgkmcnt(0)
s_barrier
ds_read_b64_tr_b16 a[224:225], v6 offset:32768
v_mfma_f32_16x16x32_bf16 v[124:127], a[240:243], v[80:83], v[252:255]
s_xor_b32 s76, s67, 196608
v_exp_f32 v224, v168
v_mfma_f32_16x16x32_bf16 v[124:127], a[244:247], v[84:87], v[124:127]
s_add_u32 m0, s69, 16384
ds_read_b64_tr_b16 a[226:227], v6 offset:36864
v_cvt_pk_bf16_f32 v131, v230, v231
v_mfma_f32_16x16x32_bf16 v[124:127], a[248:251], v[88:91], v[124:127]
v_exp_f32 v225, v169
v_mfma_f32_16x16x32_bf16 v[124:127], a[252:255], v[92:95], v[124:127]
ds_read_b64_tr_b16 a[228:229], v6 offset:40960
v_cvt_pk_bf16_f32 v132, v224, v225
v_mfma_f32_16x16x32_bf16 v[116:119], a[252:255], v[76:79], v[248:251]
ds_read_b64_tr_b16 a[230:231], v6 offset:45056
v_mfma_f32_16x16x32_bf16 v[116:119], a[248:251], v[72:75], v[116:119]
v_exp_f32 v226, v170
v_mfma_f32_16x16x32_bf16 v[116:119], a[244:247], v[68:71], v[116:119]
ds_read_b64_tr_b16 a[232:233], v7 offset:32768
v_mfma_f32_16x16x32_bf16 v[116:119], a[240:243], v[64:67], v[116:119]
v_exp_f32 v227, v171
v_mfma_f32_16x16x32_bf16 v[108:111], a[240:243], v[48:51], v[244:247]
buffer_load_dwordx4 v15, s[36:39], s76 offen offset:1024 nt lds
v_mfma_f32_16x16x32_bf16 v[108:111], a[244:247], v[52:55], v[108:111]
v_exp_f32 v228, v172
v_mfma_f32_16x16x32_bf16 v[108:111], a[248:251], v[56:59], v[108:111]
ds_read_b64_tr_b16 a[234:235], v7 offset:36864
v_cvt_pk_bf16_f32 v133, v226, v227
v_mfma_f32_16x16x32_bf16 v[108:111], a[252:255], v[60:63], v[108:111]
v_exp_f32 v229, v173
v_mfma_f32_16x16x32_bf16 v[100:103], a[252:255], v[44:47], v[240:243]
ds_read_b64_tr_b16 a[236:237], v7 offset:40960
v_cvt_pk_bf16_f32 v134, v228, v229
v_mfma_f32_16x16x32_bf16 v[100:103], a[248:251], v[40:43], v[100:103]
v_exp_f32 v230, v174
v_mfma_f32_16x16x32_bf16 v[100:103], a[244:247], v[36:39], v[100:103]
ds_read_b64_tr_b16 a[238:239], v7 offset:45056
v_mfma_f32_16x16x32_bf16 v[100:103], a[240:243], v[32:35], v[100:103]
s_waitcnt lgkmcnt(4)
ds_read_b64_tr_b16 a[240:241], v8 offset:32768
v_mfma_f32_16x16x32_bf16 a[0:3], a[224:227], v[192:195], a[0:3]
v_exp_f32 v231, v175
v_mfma_f32_16x16x32_bf16 a[0:3], a[228:231], v[208:211], a[0:3]
ds_read_b64_tr_b16 a[242:243], v8 offset:36864
v_cvt_pk_bf16_f32 v135, v230, v231
v_mfma_f32_16x16x32_bf16 a[4:7], a[228:231], v[212:215], a[4:7]
v_exp_f32 v224, v176
v_mfma_f32_16x16x32_bf16 a[4:7], a[224:227], v[196:199], a[4:7]
ds_read_b64_tr_b16 a[244:245], v8 offset:40960
v_mfma_f32_16x16x32_bf16 a[8:11], a[224:227], v[200:203], a[8:11]
v_exp_f32 v225, v177
v_mfma_f32_16x16x32_bf16 a[8:11], a[228:231], v[216:219], a[8:11]
ds_read_b64_tr_b16 a[246:247], v8 offset:45056
v_cvt_pk_bf16_f32 v136, v224, v225
v_mfma_f32_16x16x32_bf16 a[12:15], a[228:231], v[220:223], a[12:15]
v_exp_f32 v226, v178
v_mfma_f32_16x16x32_bf16 a[12:15], a[224:227], v[204:207], a[12:15]
s_waitcnt lgkmcnt(4)
buffer_load_dwordx4 v16, s[36:39], s76 offen offset:2048 nt lds
v_mfma_f32_16x16x32_bf16 a[28:31], a[232:235], v[204:207], a[28:31]
v_exp_f32 v227, v179
v_mfma_f32_16x16x32_bf16 a[28:31], a[236:239], v[220:223], a[28:31]
ds_read_b64_tr_b16 a[248:249], v9 offset:32768
v_cvt_pk_bf16_f32 v137, v226, v227
v_mfma_f32_16x16x32_bf16 a[24:27], a[236:239], v[216:219], a[24:27]
ds_read_b64_tr_b16 a[250:251], v9 offset:36864
v_mfma_f32_16x16x32_bf16 a[24:27], a[232:235], v[200:203], a[24:27]
v_exp_f32 v228, v180
v_mfma_f32_16x16x32_bf16 a[20:23], a[232:235], v[196:199], a[20:23]
ds_read_b64_tr_b16 a[252:253], v9 offset:40960
v_mfma_f32_16x16x32_bf16 a[20:23], a[236:239], v[212:215], a[20:23]
v_exp_f32 v229, v181
v_mfma_f32_16x16x32_bf16 a[16:19], a[236:239], v[208:211], a[16:19]
ds_read_b64_tr_b16 a[254:255], v9 offset:45056
v_cvt_pk_bf16_f32 v138, v228, v229
v_mfma_f32_16x16x32_bf16 a[16:19], a[232:235], v[192:195], a[16:19]
s_waitcnt lgkmcnt(4)
v_exp_f32 v230, v182
v_mfma_f32_16x16x32_bf16 a[32:35], a[240:243], v[192:195], a[32:35]
v_mfma_f32_16x16x32_bf16 a[32:35], a[244:247], v[208:211], a[32:35]
v_exp_f32 v231, v183
v_mfma_f32_16x16x32_bf16 a[36:39], a[244:247], v[212:215], a[36:39]
v_cvt_pk_bf16_f32 v139, v230, v231
v_mfma_f32_16x16x32_bf16 a[36:39], a[240:243], v[196:199], a[36:39]
v_exp_f32 v224, v184
v_mfma_f32_16x16x32_bf16 a[40:43], a[240:243], v[200:203], a[40:43]
buffer_load_dwordx4 v17, s[36:39], s76 offen offset:3072 nt lds
v_mfma_f32_16x16x32_bf16 a[40:43], a[244:247], v[216:219], a[40:43]
s_xor_b32 s76, s67, 82432
ds_read_b128 a[224:227], v2 offset:49152
v_mfma_f32_16x16x32_bf16 a[44:47], a[244:247], v[220:223], a[44:47]
s_add_u32 m0, s69, 81920
v_exp_f32 v225, v185
v_mfma_f32_16x16x32_bf16 a[44:47], a[240:243], v[204:207], a[44:47]
s_waitcnt lgkmcnt(1)
ds_read_b128 a[228:231], v3 offset:49152
v_cvt_pk_bf16_f32 v140, v224, v225
v_mfma_f32_16x16x32_bf16 a[60:63], a[248:251], v[204:207], a[60:63]
v_exp_f32 v226, v186
v_mfma_f32_16x16x32_bf16 a[60:63], a[252:255], v[220:223], a[60:63]
ds_read_b128 a[232:235], v4 offset:49152
v_mfma_f32_16x16x32_bf16 a[56:59], a[252:255], v[216:219], a[56:59]
v_exp_f32 v227, v187
v_mfma_f32_16x16x32_bf16 a[56:59], a[248:251], v[200:203], a[56:59]
ds_read_b128 a[236:239], v5 offset:49152
v_cvt_pk_bf16_f32 v141, v226, v227
v_mfma_f32_16x16x32_bf16 a[52:55], a[248:251], v[196:199], a[52:55]
v_exp_f32 v228, v188
v_mfma_f32_16x16x32_bf16 a[52:55], a[252:255], v[212:215], a[52:55]
v_mfma_f32_16x16x32_bf16 a[48:51], a[252:255], v[208:211], a[48:51]
v_exp_f32 v229, v189
v_mfma_f32_16x16x32_bf16 a[48:51], a[248:251], v[192:195], a[48:51]
v_cvt_pk_bf16_f32 v142, v228, v229
v_mfma_f32_16x16x32_bf16 a[128:131], a[144:147], v[192:195], a[128:131]
v_exp_f32 v230, v190
v_mfma_f32_16x16x32_bf16 a[128:131], a[144:147], v[208:211], a[128:131]
v_mfma_f32_16x16x32_bf16 a[132:135], a[144:147], v[196:199], a[132:135]
v_exp_f32 v231, v191
v_mfma_f32_16x16x32_bf16 a[132:135], a[144:147], v[212:215], a[132:135]
s_waitcnt lgkmcnt(0)
buffer_load_dwordx4 v18, s[40:43], s76 offen nt lds
v_mfma_f32_16x16x32_bf16 v[160:163], a[224:227], v[32:35], v[240:243]
v_exp_f32 v224, v96
v_mfma_f32_16x16x32_bf16 v[160:163], a[228:231], v[36:39], v[160:163]
ds_read_b128 a[240:243], v2 offset:53248
v_cvt_pk_bf16_f32 v143, v230, v231
v_mfma_f32_16x16x32_bf16 v[160:163], a[232:235], v[40:43], v[160:163]
v_exp_f32 v225, v97
v_mfma_f32_16x16x32_bf16 v[160:163], a[236:239], v[44:47], v[160:163]
ds_read_b128 a[244:247], v3 offset:53248
v_cvt_pk_bf16_f32 v144, v224, v225
v_mfma_f32_16x16x32_bf16 v[168:171], a[236:239], v[60:63], v[244:247]
v_exp_f32 v226, v98
v_mfma_f32_16x16x32_bf16 v[168:171], a[232:235], v[56:59], v[168:171]
ds_read_b128 a[248:251], v4 offset:53248
v_mfma_f32_16x16x32_bf16 v[168:171], a[228:231], v[52:55], v[168:171]
v_exp_f32 v227, v99
v_mfma_f32_16x16x32_bf16 v[168:171], a[224:227], v[48:51], v[168:171]
ds_read_b128 a[252:255], v5 offset:53248
v_cvt_pk_bf16_f32 v145, v226, v227
v_mfma_f32_16x16x32_bf16 v[176:179], a[224:227], v[64:67], v[248:251]
v_exp_f32 v228, v100
v_mfma_f32_16x16x32_bf16 v[176:179], a[228:231], v[68:71], v[176:179]
v_mfma_f32_16x16x32_bf16 v[176:179], a[232:235], v[72:75], v[176:179]
v_exp_f32 v229, v101
v_mfma_f32_16x16x32_bf16 v[176:179], a[236:239], v[76:79], v[176:179]
v_cvt_pk_bf16_f32 v146, v228, v229
v_mfma_f32_16x16x32_bf16 v[184:187], a[236:239], v[92:95], v[252:255]
v_exp_f32 v230, v102
v_mfma_f32_16x16x32_bf16 v[184:187], a[232:235], v[88:91], v[184:187]
v_mfma_f32_16x16x32_bf16 v[184:187], a[228:231], v[84:87], v[184:187]
v_exp_f32 v231, v103
v_mfma_f32_16x16x32_bf16 v[184:187], a[224:227], v[80:83], v[184:187]
s_waitcnt lgkmcnt(0)
buffer_store_dwordx4 a[164:167], v238, s[52:55], s62 offen offset:0 sc1
v_mfma_f32_16x16x32_bf16 v[188:191], a[240:243], v[80:83], v[252:255]
v_exp_f32 v224, v104
v_mfma_f32_16x16x32_bf16 v[188:191], a[244:247], v[84:87], v[188:191]
ds_read_b64_tr_b16 a[224:225], v10 offset:32768
v_cvt_pk_bf16_f32 v147, v230, v231
v_mfma_f32_16x16x32_bf16 v[188:191], a[248:251], v[88:91], v[188:191]
v_exp_f32 v225, v105
v_mfma_f32_16x16x32_bf16 v[188:191], a[252:255], v[92:95], v[188:191]
ds_read_b64_tr_b16 a[226:227], v10 offset:36864
v_cvt_pk_bf16_f32 v148, v224, v225
v_mfma_f32_16x16x32_bf16 v[180:183], a[252:255], v[76:79], v[248:251]
ds_read_b64_tr_b16 a[228:229], v10 offset:40960
v_mfma_f32_16x16x32_bf16 v[180:183], a[248:251], v[72:75], v[180:183]
v_exp_f32 v226, v106
v_mfma_f32_16x16x32_bf16 v[180:183], a[244:247], v[68:71], v[180:183]
ds_read_b64_tr_b16 a[230:231], v10 offset:45056
v_mfma_f32_16x16x32_bf16 v[180:183], a[240:243], v[64:67], v[180:183]
v_exp_f32 v227, v107
v_mfma_f32_16x16x32_bf16 v[172:175], a[240:243], v[48:51], v[244:247]
ds_read_b64_tr_b16 a[232:233], v11 offset:32768
v_cvt_pk_bf16_f32 v149, v226, v227
v_mfma_f32_16x16x32_bf16 v[172:175], a[244:247], v[52:55], v[172:175]
v_exp_f32 v228, v108
v_mfma_f32_16x16x32_bf16 v[172:175], a[248:251], v[56:59], v[172:175]
ds_read_b64_tr_b16 a[234:235], v11 offset:36864
v_mfma_f32_16x16x32_bf16 v[172:175], a[252:255], v[60:63], v[172:175]
v_exp_f32 v229, v109
v_mfma_f32_16x16x32_bf16 v[164:167], a[252:255], v[44:47], v[240:243]
buffer_load_dwordx4 v19, s[40:43], s76 offen offset:1024 nt lds
v_mfma_f32_16x16x32_bf16 v[164:167], a[248:251], v[40:43], v[164:167]
v_exp_f32 v230, v110
v_mfma_f32_16x16x32_bf16 v[164:167], a[244:247], v[36:39], v[164:167]
ds_read_b64_tr_b16 a[236:237], v11 offset:40960
v_cvt_pk_bf16_f32 v150, v228, v229
v_mfma_f32_16x16x32_bf16 v[164:167], a[240:243], v[32:35], v[164:167]
s_waitcnt lgkmcnt(3)
ds_read_b64_tr_b16 a[238:239], v11 offset:45056
v_mfma_f32_16x16x32_bf16 a[64:67], a[224:227], v[192:195], a[64:67]
v_exp_f32 v231, v111
v_mfma_f32_16x16x32_bf16 a[64:67], a[228:231], v[208:211], a[64:67]
ds_read_b64_tr_b16 a[240:241], v12 offset:32768
v_cvt_pk_bf16_f32 v151, v230, v231
v_mfma_f32_16x16x32_bf16 a[68:71], a[228:231], v[212:215], a[68:71]
v_exp_f32 v224, v112
v_mfma_f32_16x16x32_bf16 a[68:71], a[224:227], v[196:199], a[68:71]
ds_read_b64_tr_b16 a[242:243], v12 offset:36864
v_mfma_f32_16x16x32_bf16 a[72:75], a[224:227], v[200:203], a[72:75]
v_exp_f32 v225, v113
v_mfma_f32_16x16x32_bf16 a[72:75], a[228:231], v[216:219], a[72:75]
ds_read_b64_tr_b16 a[244:245], v12 offset:40960
v_cvt_pk_bf16_f32 v152, v224, v225
v_mfma_f32_16x16x32_bf16 a[76:79], a[228:231], v[220:223], a[76:79]
v_exp_f32 v226, v114
v_mfma_f32_16x16x32_bf16 a[76:79], a[224:227], v[204:207], a[76:79]
s_waitcnt lgkmcnt(3)
ds_read_b64_tr_b16 a[246:247], v12 offset:45056
v_mfma_f32_16x16x32_bf16 a[92:95], a[232:235], v[204:207], a[92:95]
v_exp_f32 v227, v115
v_mfma_f32_16x16x32_bf16 a[92:95], a[236:239], v[220:223], a[92:95]
ds_read_b64_tr_b16 a[248:249], v13 offset:32768
v_cvt_pk_bf16_f32 v153, v226, v227
v_mfma_f32_16x16x32_bf16 a[88:91], a[236:239], v[216:219], a[88:91]
ds_read_b64_tr_b16 a[250:251], v13 offset:36864
v_mfma_f32_16x16x32_bf16 a[88:91], a[232:235], v[200:203], a[88:91]
v_exp_f32 v228, v116
v_mfma_f32_16x16x32_bf16 a[84:87], a[232:235], v[196:199], a[84:87]
buffer_load_dwordx4 v18, s[40:43], s76 offen offset:2048 nt lds
v_mfma_f32_16x16x32_bf16 a[84:87], a[236:239], v[212:215], a[84:87]
v_exp_f32 v229, v117
v_mfma_f32_16x16x32_bf16 a[80:83], a[236:239], v[208:211], a[80:83]
ds_read_b64_tr_b16 a[252:253], v13 offset:40960
v_cvt_pk_bf16_f32 v154, v228, v229
v_mfma_f32_16x16x32_bf16 a[80:83], a[232:235], v[192:195], a[80:83]
s_waitcnt lgkmcnt(3)
v_exp_f32 v230, v118
v_mfma_f32_16x16x32_bf16 a[96:99], a[240:243], v[192:195], a[96:99]
ds_read_b64_tr_b16 a[254:255], v13 offset:45056
v_mfma_f32_16x16x32_bf16 a[96:99], a[244:247], v[208:211], a[96:99]
v_exp_f32 v231, v119
v_mfma_f32_16x16x32_bf16 a[100:103], a[244:247], v[212:215], a[100:103]
v_cvt_pk_bf16_f32 v155, v230, v231
v_mfma_f32_16x16x32_bf16 a[100:103], a[240:243], v[196:199], a[100:103]
v_exp_f32 v224, v120
v_mfma_f32_16x16x32_bf16 a[104:107], a[240:243], v[200:203], a[104:107]
ds_read_b128 a[224:227], v2 offset:57344
v_mfma_f32_16x16x32_bf16 a[104:107], a[244:247], v[216:219], a[104:107]
ds_read_b128 a[228:231], v3 offset:57344
v_mfma_f32_16x16x32_bf16 a[108:111], a[244:247], v[220:223], a[108:111]
v_exp_f32 v225, v121
v_mfma_f32_16x16x32_bf16 a[108:111], a[240:243], v[204:207], a[108:111]
s_waitcnt lgkmcnt(2)
ds_read_b128 a[232:235], v4 offset:57344
v_cvt_pk_bf16_f32 v156, v224, v225
v_mfma_f32_16x16x32_bf16 a[124:127], a[248:251], v[204:207], a[124:127]
v_exp_f32 v226, v122
v_mfma_f32_16x16x32_bf16 a[124:127], a[252:255], v[220:223], a[124:127]
ds_read_b128 a[236:239], v5 offset:57344
v_mfma_f32_16x16x32_bf16 a[120:123], a[252:255], v[216:219], a[120:123]
v_exp_f32 v227, v123
v_mfma_f32_16x16x32_bf16 a[120:123], a[248:251], v[200:203], a[120:123]
buffer_load_dwordx4 v19, s[40:43], s76 offen offset:3072 nt lds
v_mfma_f32_16x16x32_bf16 a[116:119], a[248:251], v[196:199], a[116:119]
s_xor_b32 s76, s67, 147456
v_exp_f32 v228, v124
v_mfma_f32_16x16x32_bf16 a[116:119], a[252:255], v[212:215], a[116:119]
s_add_u32 m0, s69, 32768
v_cvt_pk_bf16_f32 v157, v226, v227
v_mfma_f32_16x16x32_bf16 a[112:115], a[252:255], v[208:211], a[112:115]
v_exp_f32 v229, v125
v_mfma_f32_16x16x32_bf16 a[112:115], a[248:251], v[192:195], a[112:115]
v_cvt_pk_bf16_f32 v158, v228, v229
v_mfma_f32_16x16x32_bf16 a[136:139], a[144:147], v[200:203], a[136:139]
v_exp_f32 v230, v126
v_mfma_f32_16x16x32_bf16 a[136:139], a[144:147], v[216:219], a[136:139]
v_mfma_f32_16x16x32_bf16 a[140:143], a[144:147], v[204:207], a[140:143]
v_exp_f32 v231, v127
v_mfma_f32_16x16x32_bf16 a[140:143], a[144:147], v[220:223], a[140:143]
s_waitcnt lgkmcnt(0)
v_cvt_pk_bf16_f32 v159, v230, v231
v_mfma_f32_16x16x32_bf16 v[96:99], a[224:227], v[32:35], v[240:243]
v_exp_f32 v224, v160
v_mfma_f32_16x16x32_bf16 v[96:99], a[228:231], v[36:39], v[96:99]
ds_read_b128 a[240:243], v2 offset:61440
v_mfma_f32_16x16x32_bf16 v[96:99], a[232:235], v[40:43], v[96:99]
v_exp_f32 v225, v161
v_mfma_f32_16x16x32_bf16 v[96:99], a[236:239], v[44:47], v[96:99]
ds_read_b128 a[244:247], v3 offset:61440
v_cvt_pk_bf16_f32 v192, v224, v225
v_mfma_f32_16x16x32_bf16 v[104:107], a[236:239], v[60:63], v[244:247]
v_exp_f32 v226, v162
v_mfma_f32_16x16x32_bf16 v[104:107], a[232:235], v[56:59], v[104:107]
buffer_load_dwordx4 v14, s[36:39], s76 offen nt lds
v_mfma_f32_16x16x32_bf16 v[104:107], a[228:231], v[52:55], v[104:107]
v_exp_f32 v227, v163
v_mfma_f32_16x16x32_bf16 v[104:107], a[224:227], v[48:51], v[104:107]
ds_read_b128 a[248:251], v4 offset:61440
v_cvt_pk_bf16_f32 v193, v226, v227
v_mfma_f32_16x16x32_bf16 v[112:115], a[224:227], v[64:67], v[248:251]
v_exp_f32 v228, v164
v_mfma_f32_16x16x32_bf16 v[112:115], a[228:231], v[68:71], v[112:115]
ds_read_b128 a[252:255], v5 offset:61440
v_mfma_f32_16x16x32_bf16 v[112:115], a[232:235], v[72:75], v[112:115]
v_exp_f32 v229, v165
v_mfma_f32_16x16x32_bf16 v[112:115], a[236:239], v[76:79], v[112:115]
v_cvt_pk_bf16_f32 v194, v228, v229
v_mfma_f32_16x16x32_bf16 v[120:123], a[236:239], v[92:95], v[252:255]
v_exp_f32 v230, v166
v_mfma_f32_16x16x32_bf16 v[120:123], a[232:235], v[88:91], v[120:123]
v_mfma_f32_16x16x32_bf16 v[120:123], a[228:231], v[84:87], v[120:123]
v_exp_f32 v231, v167
v_mfma_f32_16x16x32_bf16 v[120:123], a[224:227], v[80:83], v[120:123]
s_waitcnt vmcnt(10) lgkmcnt(0)
s_barrier
ds_read_b64_tr_b16 a[224:225], v6 offset:49152
v_mfma_f32_16x16x32_bf16 v[124:127], a[240:243], v[80:83], v[252:255]
s_xor_b32 s76, s67, 147456
v_exp_f32 v224, v168
v_mfma_f32_16x16x32_bf16 v[124:127], a[244:247], v[84:87], v[124:127]
s_add_u32 m0, s69, 32768
ds_read_b64_tr_b16 a[226:227], v6 offset:53248
v_cvt_pk_bf16_f32 v195, v230, v231
v_mfma_f32_16x16x32_bf16 v[124:127], a[248:251], v[88:91], v[124:127]
v_exp_f32 v225, v169
v_mfma_f32_16x16x32_bf16 v[124:127], a[252:255], v[92:95], v[124:127]
ds_read_b64_tr_b16 a[228:229], v6 offset:57344
v_cvt_pk_bf16_f32 v196, v224, v225
v_mfma_f32_16x16x32_bf16 v[116:119], a[252:255], v[76:79], v[248:251]
ds_read_b64_tr_b16 a[230:231], v6 offset:61440
v_mfma_f32_16x16x32_bf16 v[116:119], a[248:251], v[72:75], v[116:119]
v_exp_f32 v226, v170
v_mfma_f32_16x16x32_bf16 v[116:119], a[244:247], v[68:71], v[116:119]
ds_read_b64_tr_b16 a[232:233], v7 offset:49152
v_mfma_f32_16x16x32_bf16 v[116:119], a[240:243], v[64:67], v[116:119]
v_exp_f32 v227, v171
v_mfma_f32_16x16x32_bf16 v[108:111], a[240:243], v[48:51], v[244:247]
buffer_load_dwordx4 v15, s[36:39], s76 offen offset:1024 nt lds
v_mfma_f32_16x16x32_bf16 v[108:111], a[244:247], v[52:55], v[108:111]
v_exp_f32 v228, v172
v_mfma_f32_16x16x32_bf16 v[108:111], a[248:251], v[56:59], v[108:111]
ds_read_b64_tr_b16 a[234:235], v7 offset:53248
v_cvt_pk_bf16_f32 v197, v226, v227
v_mfma_f32_16x16x32_bf16 v[108:111], a[252:255], v[60:63], v[108:111]
v_exp_f32 v229, v173
v_mfma_f32_16x16x32_bf16 v[100:103], a[252:255], v[44:47], v[240:243]
ds_read_b64_tr_b16 a[236:237], v7 offset:57344
v_cvt_pk_bf16_f32 v198, v228, v229
v_mfma_f32_16x16x32_bf16 v[100:103], a[248:251], v[40:43], v[100:103]
v_exp_f32 v230, v174
v_mfma_f32_16x16x32_bf16 v[100:103], a[244:247], v[36:39], v[100:103]
ds_read_b64_tr_b16 a[238:239], v7 offset:61440
v_mfma_f32_16x16x32_bf16 v[100:103], a[240:243], v[32:35], v[100:103]
s_waitcnt lgkmcnt(4)
ds_read_b64_tr_b16 a[240:241], v8 offset:49152
v_mfma_f32_16x16x32_bf16 a[0:3], a[224:227], v[128:131], a[0:3]
v_exp_f32 v231, v175
v_mfma_f32_16x16x32_bf16 a[0:3], a[228:231], v[144:147], a[0:3]
ds_read_b64_tr_b16 a[242:243], v8 offset:53248
v_cvt_pk_bf16_f32 v199, v230, v231
v_mfma_f32_16x16x32_bf16 a[4:7], a[228:231], v[148:151], a[4:7]
v_exp_f32 v224, v176
v_mfma_f32_16x16x32_bf16 a[4:7], a[224:227], v[132:135], a[4:7]
ds_read_b64_tr_b16 a[244:245], v8 offset:57344
v_mfma_f32_16x16x32_bf16 a[8:11], a[224:227], v[136:139], a[8:11]
v_exp_f32 v225, v177
v_mfma_f32_16x16x32_bf16 a[8:11], a[228:231], v[152:155], a[8:11]
ds_read_b64_tr_b16 a[246:247], v8 offset:61440
v_cvt_pk_bf16_f32 v200, v224, v225
v_mfma_f32_16x16x32_bf16 a[12:15], a[228:231], v[156:159], a[12:15]
v_exp_f32 v226, v178
v_mfma_f32_16x16x32_bf16 a[12:15], a[224:227], v[140:143], a[12:15]
s_waitcnt lgkmcnt(4)
ds_read_b64_tr_b16 a[248:249], v9 offset:49152
v_mfma_f32_16x16x32_bf16 a[28:31], a[232:235], v[140:143], a[28:31]
v_exp_f32 v227, v179
v_mfma_f32_16x16x32_bf16 a[28:31], a[236:239], v[156:159], a[28:31]
buffer_load_dwordx4 v16, s[36:39], s76 offen offset:2048 nt lds
v_mfma_f32_16x16x32_bf16 a[24:27], a[236:239], v[152:155], a[24:27]
ds_read_b64_tr_b16 a[250:251], v9 offset:53248
v_cvt_pk_bf16_f32 v201, v226, v227
v_mfma_f32_16x16x32_bf16 a[24:27], a[232:235], v[136:139], a[24:27]
v_exp_f32 v228, v180
v_mfma_f32_16x16x32_bf16 a[20:23], a[232:235], v[132:135], a[20:23]
ds_read_b64_tr_b16 a[252:253], v9 offset:57344
v_mfma_f32_16x16x32_bf16 a[20:23], a[236:239], v[148:151], a[20:23]
v_exp_f32 v229, v181
v_mfma_f32_16x16x32_bf16 a[16:19], a[236:239], v[144:147], a[16:19]
ds_read_b64_tr_b16 a[254:255], v9 offset:61440
v_cvt_pk_bf16_f32 v202, v228, v229
v_mfma_f32_16x16x32_bf16 a[16:19], a[232:235], v[128:131], a[16:19]
s_waitcnt lgkmcnt(4)
v_exp_f32 v230, v182
v_mfma_f32_16x16x32_bf16 a[32:35], a[240:243], v[128:131], a[32:35]
v_mfma_f32_16x16x32_bf16 a[32:35], a[244:247], v[144:147], a[32:35]
v_exp_f32 v231, v183
v_mfma_f32_16x16x32_bf16 a[36:39], a[244:247], v[148:151], a[36:39]
v_cvt_pk_bf16_f32 v203, v230, v231
v_mfma_f32_16x16x32_bf16 a[36:39], a[240:243], v[132:135], a[36:39]
v_exp_f32 v224, v184
v_mfma_f32_16x16x32_bf16 a[40:43], a[240:243], v[136:139], a[40:43]
ds_read_b128 a[224:227], v2 offset:0
v_mfma_f32_16x16x32_bf16 a[40:43], a[244:247], v[152:155], a[40:43]
ds_read_b128 a[228:231], v3 offset:0
v_mfma_f32_16x16x32_bf16 a[44:47], a[244:247], v[156:159], a[44:47]
v_exp_f32 v225, v185
v_mfma_f32_16x16x32_bf16 a[44:47], a[240:243], v[140:143], a[44:47]
s_waitcnt lgkmcnt(2)
ds_read_b128 a[232:235], v4 offset:0
v_cvt_pk_bf16_f32 v204, v224, v225
v_mfma_f32_16x16x32_bf16 a[60:63], a[248:251], v[140:143], a[60:63]
v_exp_f32 v226, v186
v_mfma_f32_16x16x32_bf16 a[60:63], a[252:255], v[156:159], a[60:63]
buffer_load_dwordx4 v17, s[36:39], s76 offen offset:3072 nt lds
v_mfma_f32_16x16x32_bf16 a[56:59], a[252:255], v[152:155], a[56:59]
s_xor_b32 s76, s67, 131072
v_exp_f32 v227, v187
v_mfma_f32_16x16x32_bf16 a[56:59], a[248:251], v[136:139], a[56:59]
s_add_u32 m0, s69, 65536
ds_read_b128 a[236:239], v5 offset:0
v_cvt_pk_bf16_f32 v205, v226, v227
v_mfma_f32_16x16x32_bf16 a[52:55], a[248:251], v[132:135], a[52:55]
v_exp_f32 v228, v188
v_mfma_f32_16x16x32_bf16 a[52:55], a[252:255], v[148:151], a[52:55]
v_mfma_f32_16x16x32_bf16 a[48:51], a[252:255], v[144:147], a[48:51]
v_exp_f32 v229, v189
v_mfma_f32_16x16x32_bf16 a[48:51], a[248:251], v[128:131], a[48:51]
v_cvt_pk_bf16_f32 v206, v228, v229
v_mfma_f32_16x16x32_bf16 a[128:131], a[144:147], v[128:131], a[128:131]
v_exp_f32 v230, v190
v_mfma_f32_16x16x32_bf16 a[128:131], a[144:147], v[144:147], a[128:131]
v_mfma_f32_16x16x32_bf16 a[132:135], a[144:147], v[132:135], a[132:135]
v_exp_f32 v231, v191
v_mfma_f32_16x16x32_bf16 a[132:135], a[144:147], v[148:151], a[132:135]
s_waitcnt lgkmcnt(0)
v_cvt_pk_bf16_f32 v207, v230, v231
v_mfma_f32_16x16x32_bf16 v[160:163], a[224:227], v[32:35], v[240:243]
v_exp_f32 v224, v96
v_mfma_f32_16x16x32_bf16 v[160:163], a[228:231], v[36:39], v[160:163]
ds_read_b128 a[240:243], v2 offset:4096
v_mfma_f32_16x16x32_bf16 v[160:163], a[232:235], v[40:43], v[160:163]
v_exp_f32 v225, v97
v_mfma_f32_16x16x32_bf16 v[160:163], a[236:239], v[44:47], v[160:163]
ds_read_b128 a[244:247], v3 offset:4096
v_cvt_pk_bf16_f32 v208, v224, v225
v_mfma_f32_16x16x32_bf16 v[168:171], a[236:239], v[60:63], v[244:247]
v_exp_f32 v226, v98
v_mfma_f32_16x16x32_bf16 v[168:171], a[232:235], v[56:59], v[168:171]
buffer_load_dwordx4 v18, s[40:43], s76 offen nt lds
v_mfma_f32_16x16x32_bf16 v[168:171], a[228:231], v[52:55], v[168:171]
v_exp_f32 v227, v99
v_mfma_f32_16x16x32_bf16 v[168:171], a[224:227], v[48:51], v[168:171]
ds_read_b128 a[248:251], v4 offset:4096
v_cvt_pk_bf16_f32 v209, v226, v227
v_mfma_f32_16x16x32_bf16 v[176:179], a[224:227], v[64:67], v[248:251]
v_exp_f32 v228, v100
v_mfma_f32_16x16x32_bf16 v[176:179], a[228:231], v[68:71], v[176:179]
ds_read_b128 a[252:255], v5 offset:4096
v_mfma_f32_16x16x32_bf16 v[176:179], a[232:235], v[72:75], v[176:179]
v_exp_f32 v229, v101
v_mfma_f32_16x16x32_bf16 v[176:179], a[236:239], v[76:79], v[176:179]
v_cvt_pk_bf16_f32 v210, v228, v229
v_mfma_f32_16x16x32_bf16 v[184:187], a[236:239], v[92:95], v[252:255]
v_exp_f32 v230, v102
v_mfma_f32_16x16x32_bf16 v[184:187], a[232:235], v[88:91], v[184:187]
v_mfma_f32_16x16x32_bf16 v[184:187], a[228:231], v[84:87], v[184:187]
v_exp_f32 v231, v103
v_mfma_f32_16x16x32_bf16 v[184:187], a[224:227], v[80:83], v[184:187]
s_waitcnt lgkmcnt(0)
ds_read_b64_tr_b16 a[224:225], v10 offset:49152
v_cvt_pk_bf16_f32 v211, v230, v231
v_mfma_f32_16x16x32_bf16 v[188:191], a[240:243], v[80:83], v[252:255]
v_exp_f32 v224, v104
v_mfma_f32_16x16x32_bf16 v[188:191], a[244:247], v[84:87], v[188:191]
ds_read_b64_tr_b16 a[226:227], v10 offset:53248
v_mfma_f32_16x16x32_bf16 v[188:191], a[248:251], v[88:91], v[188:191]
v_exp_f32 v225, v105
v_mfma_f32_16x16x32_bf16 v[188:191], a[252:255], v[92:95], v[188:191]
ds_read_b64_tr_b16 a[228:229], v10 offset:57344
v_cvt_pk_bf16_f32 v212, v224, v225
v_mfma_f32_16x16x32_bf16 v[180:183], a[252:255], v[76:79], v[248:251]
ds_read_b64_tr_b16 a[230:231], v10 offset:61440
v_mfma_f32_16x16x32_bf16 v[180:183], a[248:251], v[72:75], v[180:183]
v_exp_f32 v226, v106
v_mfma_f32_16x16x32_bf16 v[180:183], a[244:247], v[68:71], v[180:183]
buffer_load_dwordx4 v19, s[40:43], s76 offen offset:1024 nt lds
v_mfma_f32_16x16x32_bf16 v[180:183], a[240:243], v[64:67], v[180:183]
v_exp_f32 v227, v107
v_mfma_f32_16x16x32_bf16 v[172:175], a[240:243], v[48:51], v[244:247]
ds_read_b64_tr_b16 a[232:233], v11 offset:49152
v_cvt_pk_bf16_f32 v213, v226, v227
v_mfma_f32_16x16x32_bf16 v[172:175], a[244:247], v[52:55], v[172:175]
v_exp_f32 v228, v108
v_mfma_f32_16x16x32_bf16 v[172:175], a[248:251], v[56:59], v[172:175]
ds_read_b64_tr_b16 a[234:235], v11 offset:53248
v_mfma_f32_16x16x32_bf16 v[172:175], a[252:255], v[60:63], v[172:175]
v_exp_f32 v229, v109
v_mfma_f32_16x16x32_bf16 v[164:167], a[252:255], v[44:47], v[240:243]
ds_read_b64_tr_b16 a[236:237], v11 offset:57344
v_cvt_pk_bf16_f32 v214, v228, v229
v_mfma_f32_16x16x32_bf16 v[164:167], a[248:251], v[40:43], v[164:167]
v_exp_f32 v230, v110
v_mfma_f32_16x16x32_bf16 v[164:167], a[244:247], v[36:39], v[164:167]
ds_read_b64_tr_b16 a[238:239], v11 offset:61440
v_mfma_f32_16x16x32_bf16 v[164:167], a[240:243], v[32:35], v[164:167]
s_waitcnt lgkmcnt(4)
ds_read_b64_tr_b16 a[240:241], v12 offset:49152
v_mfma_f32_16x16x32_bf16 a[64:67], a[224:227], v[128:131], a[64:67]
v_exp_f32 v231, v111
v_mfma_f32_16x16x32_bf16 a[64:67], a[228:231], v[144:147], a[64:67]
ds_read_b64_tr_b16 a[242:243], v12 offset:53248
v_cvt_pk_bf16_f32 v215, v230, v231
v_mfma_f32_16x16x32_bf16 a[68:71], a[228:231], v[148:151], a[68:71]
v_exp_f32 v224, v112
v_mfma_f32_16x16x32_bf16 a[68:71], a[224:227], v[132:135], a[68:71]
ds_read_b64_tr_b16 a[244:245], v12 offset:57344
v_mfma_f32_16x16x32_bf16 a[72:75], a[224:227], v[136:139], a[72:75]
v_exp_f32 v225, v113
v_mfma_f32_16x16x32_bf16 a[72:75], a[228:231], v[152:155], a[72:75]
ds_read_b64_tr_b16 a[246:247], v12 offset:61440
v_cvt_pk_bf16_f32 v216, v224, v225
v_mfma_f32_16x16x32_bf16 a[76:79], a[228:231], v[156:159], a[76:79]
v_exp_f32 v226, v114
v_mfma_f32_16x16x32_bf16 a[76:79], a[224:227], v[140:143], a[76:79]
s_waitcnt lgkmcnt(4)
buffer_load_dwordx4 v18, s[40:43], s76 offen offset:2048 nt lds
v_mfma_f32_16x16x32_bf16 a[92:95], a[232:235], v[140:143], a[92:95]
v_exp_f32 v227, v115
v_mfma_f32_16x16x32_bf16 a[92:95], a[236:239], v[156:159], a[92:95]
ds_read_b64_tr_b16 a[248:249], v13 offset:49152
v_cvt_pk_bf16_f32 v217, v226, v227
v_mfma_f32_16x16x32_bf16 a[88:91], a[236:239], v[152:155], a[88:91]
ds_read_b64_tr_b16 a[250:251], v13 offset:53248
v_mfma_f32_16x16x32_bf16 a[88:91], a[232:235], v[136:139], a[88:91]
v_exp_f32 v228, v116
v_mfma_f32_16x16x32_bf16 a[84:87], a[232:235], v[132:135], a[84:87]
ds_read_b64_tr_b16 a[252:253], v13 offset:57344
v_mfma_f32_16x16x32_bf16 a[84:87], a[236:239], v[148:151], a[84:87]
v_exp_f32 v229, v117
v_mfma_f32_16x16x32_bf16 a[80:83], a[236:239], v[144:147], a[80:83]
ds_read_b64_tr_b16 a[254:255], v13 offset:61440
v_cvt_pk_bf16_f32 v218, v228, v229
v_mfma_f32_16x16x32_bf16 a[80:83], a[232:235], v[128:131], a[80:83]
s_waitcnt lgkmcnt(4)
v_exp_f32 v230, v118
v_mfma_f32_16x16x32_bf16 a[96:99], a[240:243], v[128:131], a[96:99]
v_mfma_f32_16x16x32_bf16 a[96:99], a[244:247], v[144:147], a[96:99]
v_exp_f32 v231, v119
v_mfma_f32_16x16x32_bf16 a[100:103], a[244:247], v[148:151], a[100:103]
v_cvt_pk_bf16_f32 v219, v230, v231
v_mfma_f32_16x16x32_bf16 a[100:103], a[240:243], v[132:135], a[100:103]
v_exp_f32 v224, v120
v_mfma_f32_16x16x32_bf16 a[104:107], a[240:243], v[136:139], a[104:107]
L_hop1_2:
s_cbranch_execz L_hop_ret1
ds_read_b128 a[224:227], v2 offset:8192
v_mfma_f32_16x16x32_bf16 a[104:107], a[244:247], v[152:155], a[104:107]
ds_read_b128 a[228:231], v3 offset:8192
v_mfma_f32_16x16x32_bf16 a[108:111], a[244:247], v[156:159], a[108:111]
v_exp_f32 v225, v121
v_mfma_f32_16x16x32_bf16 a[108:111], a[240:243], v[140:143], a[108:111]
s_waitcnt lgkmcnt(2)
buffer_load_dwordx4 v19, s[40:43], s76 offen offset:3072 nt lds
v_mfma_f32_16x16x32_bf16 a[124:127], a[248:251], v[140:143], a[124:127]
s_xor_b32 s76, s67, 212992
v_exp_f32 v226, v122
v_mfma_f32_16x16x32_bf16 a[124:127], a[252:255], v[156:159], a[124:127]
s_add_u32 m0, s69, 49152
ds_read_b128 a[232:235], v4 offset:8192
v_cvt_pk_bf16_f32 v220, v224, v225
v_mfma_f32_16x16x32_bf16 a[120:123], a[252:255], v[152:155], a[120:123]
v_exp_f32 v227, v123
v_mfma_f32_16x16x32_bf16 a[120:123], a[248:251], v[136:139], a[120:123]
ds_read_b128 a[236:239], v5 offset:8192
v_cvt_pk_bf16_f32 v221, v226, v227
v_mfma_f32_16x16x32_bf16 a[116:119], a[248:251], v[132:135], a[116:119]
v_exp_f32 v228, v124
v_mfma_f32_16x16x32_bf16 a[116:119], a[252:255], v[148:151], a[116:119]
v_mfma_f32_16x16x32_bf16 a[112:115], a[252:255], v[144:147], a[112:115]
v_exp_f32 v229, v125
v_mfma_f32_16x16x32_bf16 a[112:115], a[248:251], v[128:131], a[112:115]
v_cvt_pk_bf16_f32 v222, v228, v229
v_mfma_f32_16x16x32_bf16 a[136:139], a[144:147], v[136:139], a[136:139]
v_exp_f32 v230, v126
v_mfma_f32_16x16x32_bf16 a[136:139], a[144:147], v[152:155], a[136:139]
v_mfma_f32_16x16x32_bf16 a[140:143], a[144:147], v[140:143], a[140:143]
v_exp_f32 v231, v127
v_mfma_f32_16x16x32_bf16 a[140:143], a[144:147], v[156:159], a[140:143]
s_waitcnt lgkmcnt(0)
v_cvt_pk_bf16_f32 v223, v230, v231
v_mfma_f32_16x16x32_bf16 v[96:99], a[224:227], v[32:35], v[240:243]
v_exp_f32 v224, v160
v_mfma_f32_16x16x32_bf16 v[96:99], a[228:231], v[36:39], v[96:99]
ds_read_b128 a[240:243], v2 offset:12288
v_mfma_f32_16x16x32_bf16 v[96:99], a[232:235], v[40:43], v[96:99]
v_exp_f32 v225, v161
v_mfma_f32_16x16x32_bf16 v[96:99], a[236:239], v[44:47], v[96:99]
buffer_load_dwordx4 v14, s[36:39], s76 offen nt lds
v_mfma_f32_16x16x32_bf16 v[104:107], a[236:239], v[60:63], v[244:247]
v_exp_f32 v226, v162
v_mfma_f32_16x16x32_bf16 v[104:107], a[232:235], v[56:59], v[104:107]
ds_read_b128 a[244:247], v3 offset:12288
v_cvt_pk_bf16_f32 v128, v224, v225
v_mfma_f32_16x16x32_bf16 v[104:107], a[228:231], v[52:55], v[104:107]
v_exp_f32 v227, v163
v_mfma_f32_16x16x32_bf16 v[104:107], a[224:227], v[48:51], v[104:107]
ds_read_b128 a[248:251], v4 offset:12288
v_cvt_pk_bf16_f32 v129, v226, v227
v_mfma_f32_16x16x32_bf16 v[112:115], a[224:227], v[64:67], v[248:251]
v_exp_f32 v228, v164
v_mfma_f32_16x16x32_bf16 v[112:115], a[228:231], v[68:71], v[112:115]
ds_read_b128 a[252:255], v5 offset:12288
v_mfma_f32_16x16x32_bf16 v[112:115], a[232:235], v[72:75], v[112:115]
v_exp_f32 v229, v165
v_mfma_f32_16x16x32_bf16 v[112:115], a[236:239], v[76:79], v[112:115]
v_cvt_pk_bf16_f32 v130, v228, v229
v_mfma_f32_16x16x32_bf16 v[120:123], a[236:239], v[92:95], v[252:255]
v_exp_f32 v230, v166
v_mfma_f32_16x16x32_bf16 v[120:123], a[232:235], v[88:91], v[120:123]
v_mfma_f32_16x16x32_bf16 v[120:123], a[228:231], v[84:87], v[120:123]
v_exp_f32 v231, v167
v_mfma_f32_16x16x32_bf16 v[120:123], a[224:227], v[80:83], v[120:123]
s_waitcnt vmcnt(9) lgkmcnt(0)
s_barrier
ds_read_b64_tr_b16 a[224:225], v6 offset:16384
v_mfma_f32_16x16x32_bf16 v[124:127], a[240:243], v[80:83], v[252:255]
s_xor_b32 s76, s67, 212992
v_exp_f32 v224, v168
v_mfma_f32_16x16x32_bf16 v[124:127], a[244:247], v[84:87], v[124:127]
s_add_u32 m0, s69, 49152
ds_read_b64_tr_b16 a[226:227], v6 offset:20480
v_cvt_pk_bf16_f32 v131, v230, v231
v_mfma_f32_16x16x32_bf16 v[124:127], a[248:251], v[88:91], v[124:127]
v_exp_f32 v225, v169
v_mfma_f32_16x16x32_bf16 v[124:127], a[252:255], v[92:95], v[124:127]
ds_read_b64_tr_b16 a[228:229], v6 offset:24576
v_cvt_pk_bf16_f32 v132, v224, v225
v_mfma_f32_16x16x32_bf16 v[116:119], a[252:255], v[76:79], v[248:251]
ds_read_b64_tr_b16 a[230:231], v6 offset:28672
v_mfma_f32_16x16x32_bf16 v[116:119], a[248:251], v[72:75], v[116:119]
v_exp_f32 v226, v170
v_mfma_f32_16x16x32_bf16 v[116:119], a[244:247], v[68:71], v[116:119]
buffer_load_dwordx4 v15, s[36:39], s76 offen offset:1024 nt lds
v_mfma_f32_16x16x32_bf16 v[116:119], a[240:243], v[64:67], v[116:119]
s_bfe_u32 s8, s2, 196611
v_exp_f32 v227, v171
v_mfma_f32_16x16x32_bf16 v[108:111], a[240:243], v[48:51], v[244:247]
s_cmp_eq_u32 s8, 0
s_cselect_b32 s71, 0, 0x1000
ds_read_b64_tr_b16 a[232:233], v7 offset:16384
v_cvt_pk_bf16_f32 v133, v226, v227
v_mfma_f32_16x16x32_bf16 v[108:111], a[244:247], v[52:55], v[108:111]
v_exp_f32 v228, v172
v_mfma_f32_16x16x32_bf16 v[108:111], a[248:251], v[56:59], v[108:111]
ds_read_b64_tr_b16 a[234:235], v7 offset:20480
v_mfma_f32_16x16x32_bf16 v[108:111], a[252:255], v[60:63], v[108:111]
v_exp_f32 v229, v173
v_mfma_f32_16x16x32_bf16 v[100:103], a[252:255], v[44:47], v[240:243]
ds_read_b64_tr_b16 a[236:237], v7 offset:24576
v_cvt_pk_bf16_f32 v134, v228, v229
v_mfma_f32_16x16x32_bf16 v[100:103], a[248:251], v[40:43], v[100:103]
v_exp_f32 v230, v174
v_mfma_f32_16x16x32_bf16 v[100:103], a[244:247], v[36:39], v[100:103]
ds_read_b64_tr_b16 a[238:239], v7 offset:28672
v_mfma_f32_16x16x32_bf16 v[100:103], a[240:243], v[32:35], v[100:103]
s_waitcnt lgkmcnt(4)
ds_read_b64_tr_b16 a[240:241], v8 offset:16384
v_mfma_f32_16x16x32_bf16 a[0:3], a[224:227], v[192:195], a[0:3]
v_exp_f32 v231, v175
v_mfma_f32_16x16x32_bf16 a[0:3], a[228:231], v[208:211], a[0:3]
buffer_atomic_add v233, v20, s[12:15], s71 offen sc1
v_mfma_f32_16x16x32_bf16 a[4:7], a[228:231], v[212:215], a[4:7]
v_exp_f32 v224, v176
v_mfma_f32_16x16x32_bf16 a[4:7], a[224:227], v[196:199], a[4:7]
ds_read_b64_tr_b16 a[242:243], v8 offset:20480
v_cvt_pk_bf16_f32 v135, v230, v231
v_mfma_f32_16x16x32_bf16 a[8:11], a[224:227], v[200:203], a[8:11]
v_exp_f32 v225, v177
v_mfma_f32_16x16x32_bf16 a[8:11], a[228:231], v[216:219], a[8:11]
ds_read_b64_tr_b16 a[244:245], v8 offset:24576
v_cvt_pk_bf16_f32 v136, v224, v225
v_mfma_f32_16x16x32_bf16 a[12:15], a[228:231], v[220:223], a[12:15]
v_exp_f32 v226, v178
v_mfma_f32_16x16x32_bf16 a[12:15], a[224:227], v[204:207], a[12:15]
s_waitcnt lgkmcnt(3)
ds_read_b64_tr_b16 a[246:247], v8 offset:28672
v_mfma_f32_16x16x32_bf16 a[28:31], a[232:235], v[204:207], a[28:31]
v_exp_f32 v227, v179
v_mfma_f32_16x16x32_bf16 a[28:31], a[236:239], v[220:223], a[28:31]
ds_read_b64_tr_b16 a[248:249], v9 offset:16384
v_cvt_pk_bf16_f32 v137, v226, v227
v_mfma_f32_16x16x32_bf16 a[24:27], a[236:239], v[216:219], a[24:27]
ds_read_b64_tr_b16 a[250:251], v9 offset:20480
v_mfma_f32_16x16x32_bf16 a[24:27], a[232:235], v[200:203], a[24:27]
v_exp_f32 v228, v180
v_mfma_f32_16x16x32_bf16 a[20:23], a[232:235], v[196:199], a[20:23]
buffer_load_dwordx4 v16, s[36:39], s76 offen offset:2048 nt lds
v_mfma_f32_16x16x32_bf16 a[20:23], a[236:239], v[212:215], a[20:23]
v_exp_f32 v229, v181
v_mfma_f32_16x16x32_bf16 a[16:19], a[236:239], v[208:211], a[16:19]
ds_read_b64_tr_b16 a[252:253], v9 offset:24576
v_cvt_pk_bf16_f32 v138, v228, v229
v_mfma_f32_16x16x32_bf16 a[16:19], a[232:235], v[192:195], a[16:19]
s_waitcnt lgkmcnt(3)
v_exp_f32 v230, v182
v_mfma_f32_16x16x32_bf16 a[32:35], a[240:243], v[192:195], a[32:35]
ds_read_b64_tr_b16 a[254:255], v9 offset:28672
v_mfma_f32_16x16x32_bf16 a[32:35], a[244:247], v[208:211], a[32:35]
v_exp_f32 v231, v183
v_mfma_f32_16x16x32_bf16 a[36:39], a[244:247], v[212:215], a[36:39]
v_cvt_pk_bf16_f32 v139, v230, v231
v_mfma_f32_16x16x32_bf16 a[36:39], a[240:243], v[196:199], a[36:39]
v_exp_f32 v224, v184
v_mfma_f32_16x16x32_bf16 a[40:43], a[240:243], v[200:203], a[40:43]
ds_read_b128 a[224:227], v2 offset:16384
v_mfma_f32_16x16x32_bf16 a[40:43], a[244:247], v[216:219], a[40:43]
ds_read_b128 a[228:231], v3 offset:16384
v_mfma_f32_16x16x32_bf16 a[44:47], a[244:247], v[220:223], a[44:47]
v_exp_f32 v225, v185
v_mfma_f32_16x16x32_bf16 a[44:47], a[240:243], v[204:207], a[44:47]
s_waitcnt lgkmcnt(2)
buffer_load_dwordx4 v17, s[36:39], s76 offen offset:3072 nt lds
v_mfma_f32_16x16x32_bf16 a[60:63], a[248:251], v[204:207], a[60:63]
s_bfe_u32 s8, s2, 196611
v_exp_f32 v226, v186
v_mfma_f32_16x16x32_bf16 a[60:63], a[252:255], v[220:223], a[60:63]
s_cmp_eq_u32 s8, 1
s_cselect_b32 s71, 0, 0x1000
ds_read_b128 a[232:235], v4 offset:16384
v_cvt_pk_bf16_f32 v140, v224, v225
v_mfma_f32_16x16x32_bf16 a[56:59], a[252:255], v[216:219], a[56:59]
v_exp_f32 v227, v187
v_mfma_f32_16x16x32_bf16 a[56:59], a[248:251], v[200:203], a[56:59]
ds_read_b128 a[236:239], v5 offset:16384
v_cvt_pk_bf16_f32 v141, v226, v227
v_mfma_f32_16x16x32_bf16 a[52:55], a[248:251], v[196:199], a[52:55]
v_exp_f32 v228, v188
v_mfma_f32_16x16x32_bf16 a[52:55], a[252:255], v[212:215], a[52:55]
v_mfma_f32_16x16x32_bf16 a[48:51], a[252:255], v[208:211], a[48:51]
v_exp_f32 v229, v189
v_mfma_f32_16x16x32_bf16 a[48:51], a[248:251], v[192:195], a[48:51]
v_cvt_pk_bf16_f32 v142, v228, v229
v_mfma_f32_16x16x32_bf16 a[128:131], a[144:147], v[192:195], a[128:131]
v_exp_f32 v230, v190
v_mfma_f32_16x16x32_bf16 a[128:131], a[144:147], v[208:211], a[128:131]
buffer_atomic_add v233, v20, s[12:15], s71 offen sc1
v_mfma_f32_16x16x32_bf16 a[132:135], a[144:147], v[196:199], a[132:135]
s_xor_b32 s76, s67, 196608
v_exp_f32 v231, v191
v_mfma_f32_16x16x32_bf16 a[132:135], a[144:147], v[212:215], a[132:135]
s_waitcnt lgkmcnt(0)
v_cvt_pk_bf16_f32 v143, v230, v231
v_mfma_f32_16x16x32_bf16 v[160:163], a[224:227], v[32:35], v[240:243]
s_add_u32 m0, s69, 98304
v_exp_f32 v224, v96
v_mfma_f32_16x16x32_bf16 v[160:163], a[228:231], v[36:39], v[160:163]
ds_read_b128 a[240:243], v2 offset:20480
v_mfma_f32_16x16x32_bf16 v[160:163], a[232:235], v[40:43], v[160:163]
v_exp_f32 v225, v97
v_mfma_f32_16x16x32_bf16 v[160:163], a[236:239], v[44:47], v[160:163]
ds_read_b128 a[244:247], v3 offset:20480
v_cvt_pk_bf16_f32 v144, v224, v225
v_mfma_f32_16x16x32_bf16 v[168:171], a[236:239], v[60:63], v[244:247]
v_exp_f32 v226, v98
v_mfma_f32_16x16x32_bf16 v[168:171], a[232:235], v[56:59], v[168:171]
ds_read_b128 a[248:251], v4 offset:20480
v_mfma_f32_16x16x32_bf16 v[168:171], a[228:231], v[52:55], v[168:171]
v_exp_f32 v227, v99
v_mfma_f32_16x16x32_bf16 v[168:171], a[224:227], v[48:51], v[168:171]
ds_read_b128 a[252:255], v5 offset:20480
v_cvt_pk_bf16_f32 v145, v226, v227
v_mfma_f32_16x16x32_bf16 v[176:179], a[224:227], v[64:67], v[248:251]
v_exp_f32 v228, v100
v_mfma_f32_16x16x32_bf16 v[176:179], a[228:231], v[68:71], v[176:179]
buffer_load_dwordx4 v18, s[40:43], s76 offen nt lds
v_mfma_f32_16x16x32_bf16 v[176:179], a[232:235], v[72:75], v[176:179]
v_exp_f32 v229, v101
v_mfma_f32_16x16x32_bf16 v[176:179], a[236:239], v[76:79], v[176:179]
v_cvt_pk_bf16_f32 v146, v228, v229
v_mfma_f32_16x16x32_bf16 v[184:187], a[236:239], v[92:95], v[252:255]
v_exp_f32 v230, v102
v_mfma_f32_16x16x32_bf16 v[184:187], a[232:235], v[88:91], v[184:187]
v_mfma_f32_16x16x32_bf16 v[184:187], a[228:231], v[84:87], v[184:187]
v_exp_f32 v231, v103
v_mfma_f32_16x16x32_bf16 v[184:187], a[224:227], v[80:83], v[184:187]
s_waitcnt lgkmcnt(0)
ds_read_b64_tr_b16 a[224:225], v10 offset:16384
v_cvt_pk_bf16_f32 v147, v230, v231
v_mfma_f32_16x16x32_bf16 v[188:191], a[240:243], v[80:83], v[252:255]
v_exp_f32 v224, v104
v_mfma_f32_16x16x32_bf16 v[188:191], a[244:247], v[84:87], v[188:191]
ds_read_b64_tr_b16 a[226:227], v10 offset:20480
v_mfma_f32_16x16x32_bf16 v[188:191], a[248:251], v[88:91], v[188:191]
v_exp_f32 v225, v105
v_mfma_f32_16x16x32_bf16 v[188:191], a[252:255], v[92:95], v[188:191]
buffer_load_dwordx4 v19, s[40:43], s76 offen offset:1024 nt lds
v_mfma_f32_16x16x32_bf16 v[180:183], a[252:255], v[76:79], v[248:251]
s_bfe_u32 s8, s2, 196611
ds_read_b64_tr_b16 a[228:229], v10 offset:24576
v_cvt_pk_bf16_f32 v148, v224, v225
v_mfma_f32_16x16x32_bf16 v[180:183], a[248:251], v[72:75], v[180:183]
s_cmp_eq_u32 s8, 2
s_cselect_b32 s71, 0, 0x1000
v_exp_f32 v226, v106
v_mfma_f32_16x16x32_bf16 v[180:183], a[244:247], v[68:71], v[180:183]
ds_read_b64_tr_b16 a[230:231], v10 offset:28672
v_mfma_f32_16x16x32_bf16 v[180:183], a[240:243], v[64:67], v[180:183]
v_exp_f32 v227, v107
v_mfma_f32_16x16x32_bf16 v[172:175], a[240:243], v[48:51], v[244:247]
ds_read_b64_tr_b16 a[232:233], v11 offset:16384
v_cvt_pk_bf16_f32 v149, v226, v227
v_mfma_f32_16x16x32_bf16 v[172:175], a[244:247], v[52:55], v[172:175]
v_exp_f32 v228, v108
v_mfma_f32_16x16x32_bf16 v[172:175], a[248:251], v[56:59], v[172:175]
ds_read_b64_tr_b16 a[234:235], v11 offset:20480
v_mfma_f32_16x16x32_bf16 v[172:175], a[252:255], v[60:63], v[172:175]
v_exp_f32 v229, v109
v_mfma_f32_16x16x32_bf16 v[164:167], a[252:255], v[44:47], v[240:243]
ds_read_b64_tr_b16 a[236:237], v11 offset:24576
v_cvt_pk_bf16_f32 v150, v228, v229
v_mfma_f32_16x16x32_bf16 v[164:167], a[248:251], v[40:43], v[164:167]
v_exp_f32 v230, v110
v_mfma_f32_16x16x32_bf16 v[164:167], a[244:247], v[36:39], v[164:167]
buffer_atomic_add v233, v20, s[12:15], s71 offen sc1
v_mfma_f32_16x16x32_bf16 v[164:167], a[240:243], v[32:35], v[164:167]
s_waitcnt lgkmcnt(3)
ds_read_b64_tr_b16 a[238:239], v11 offset:28672
v_mfma_f32_16x16x32_bf16 a[64:67], a[224:227], v[192:195], a[64:67]
v_exp_f32 v231, v111
v_mfma_f32_16x16x32_bf16 a[64:67], a[228:231], v[208:211], a[64:67]
ds_read_b64_tr_b16 a[240:241], v12 offset:16384
v_cvt_pk_bf16_f32 v151, v230, v231
v_mfma_f32_16x16x32_bf16 a[68:71], a[228:231], v[212:215], a[68:71]
v_exp_f32 v224, v112
v_mfma_f32_16x16x32_bf16 a[68:71], a[224:227], v[196:199], a[68:71]
ds_read_b64_tr_b16 a[242:243], v12 offset:20480
v_mfma_f32_16x16x32_bf16 a[72:75], a[224:227], v[200:203], a[72:75]
v_exp_f32 v225, v113
v_mfma_f32_16x16x32_bf16 a[72:75], a[228:231], v[216:219], a[72:75]
ds_read_b64_tr_b16 a[244:245], v12 offset:24576
v_cvt_pk_bf16_f32 v152, v224, v225
v_mfma_f32_16x16x32_bf16 a[76:79], a[228:231], v[220:223], a[76:79]
v_exp_f32 v226, v114
v_mfma_f32_16x16x32_bf16 a[76:79], a[224:227], v[204:207], a[76:79]
s_waitcnt lgkmcnt(3)
ds_read_b64_tr_b16 a[246:247], v12 offset:28672
v_mfma_f32_16x16x32_bf16 a[92:95], a[232:235], v[204:207], a[92:95]
v_exp_f32 v227, v115
v_mfma_f32_16x16x32_bf16 a[92:95], a[236:239], v[220:223], a[92:95]
buffer_load_dwordx4 v18, s[40:43], s76 offen offset:2048 nt lds
v_mfma_f32_16x16x32_bf16 a[88:91], a[236:239], v[216:219], a[88:91]
ds_read_b64_tr_b16 a[248:249], v13 offset:16384
v_cvt_pk_bf16_f32 v153, v226, v227
v_mfma_f32_16x16x32_bf16 a[88:91], a[232:235], v[200:203], a[88:91]
v_exp_f32 v228, v116
v_mfma_f32_16x16x32_bf16 a[84:87], a[232:235], v[196:199], a[84:87]
ds_read_b64_tr_b16 a[250:251], v13 offset:20480
v_mfma_f32_16x16x32_bf16 a[84:87], a[236:239], v[212:215], a[84:87]
v_exp_f32 v229, v117
v_mfma_f32_16x16x32_bf16 a[80:83], a[236:239], v[208:211], a[80:83]
ds_read_b64_tr_b16 a[252:253], v13 offset:24576
v_cvt_pk_bf16_f32 v154, v228, v229
v_mfma_f32_16x16x32_bf16 a[80:83], a[232:235], v[192:195], a[80:83]
s_waitcnt lgkmcnt(3)
v_exp_f32 v230, v118
v_mfma_f32_16x16x32_bf16 a[96:99], a[240:243], v[192:195], a[96:99]
ds_read_b64_tr_b16 a[254:255], v13 offset:28672
v_mfma_f32_16x16x32_bf16 a[96:99], a[244:247], v[208:211], a[96:99]
v_exp_f32 v231, v119
v_mfma_f32_16x16x32_bf16 a[100:103], a[244:247], v[212:215], a[100:103]
v_cvt_pk_bf16_f32 v155, v230, v231
v_mfma_f32_16x16x32_bf16 a[100:103], a[240:243], v[196:199], a[100:103]
v_exp_f32 v224, v120
v_mfma_f32_16x16x32_bf16 a[104:107], a[240:243], v[200:203], a[104:107]
buffer_load_dwordx4 v19, s[40:43], s76 offen offset:3072 nt lds
v_mfma_f32_16x16x32_bf16 a[104:107], a[244:247], v[216:219], a[104:107]
s_bfe_u32 s8, s2, 196611
ds_read_b128 a[224:227], v2 offset:24576
v_mfma_f32_16x16x32_bf16 a[108:111], a[244:247], v[220:223], a[108:111]
s_cmp_eq_u32 s8, 3
s_cselect_b32 s71, 0, 0x1000
v_exp_f32 v225, v121
v_mfma_f32_16x16x32_bf16 a[108:111], a[240:243], v[204:207], a[108:111]
s_waitcnt lgkmcnt(1)
ds_read_b128 a[228:231], v3 offset:24576
v_cvt_pk_bf16_f32 v156, v224, v225
v_mfma_f32_16x16x32_bf16 a[124:127], a[248:251], v[204:207], a[124:127]
v_exp_f32 v226, v122
v_mfma_f32_16x16x32_bf16 a[124:127], a[252:255], v[220:223], a[124:127]
ds_read_b128 a[232:235], v4 offset:24576
v_mfma_f32_16x16x32_bf16 a[120:123], a[252:255], v[216:219], a[120:123]
v_exp_f32 v227, v123
v_mfma_f32_16x16x32_bf16 a[120:123], a[248:251], v[200:203], a[120:123]
ds_read_b128 a[236:239], v5 offset:24576
v_cvt_pk_bf16_f32 v157, v226, v227
v_mfma_f32_16x16x32_bf16 a[116:119], a[248:251], v[196:199], a[116:119]
v_exp_f32 v228, v124
v_mfma_f32_16x16x32_bf16 a[116:119], a[252:255], v[212:215], a[116:119]
v_mfma_f32_16x16x32_bf16 a[112:115], a[252:255], v[208:211], a[112:115]
v_exp_f32 v229, v125
v_mfma_f32_16x16x32_bf16 a[112:115], a[248:251], v[192:195], a[112:115]
buffer_atomic_add v233, v20, s[12:15], s71 offen sc1
v_mfma_f32_16x16x32_bf16 a[136:139], a[144:147], v[200:203], a[136:139]
s_xor_b32 s76, s67, 131584
v_exp_f32 v230, v126
v_mfma_f32_16x16x32_bf16 a[136:139], a[144:147], v[216:219], a[136:139]
s_add_u32 m0, s69, 0
v_cvt_pk_bf16_f32 v158, v228, v229
v_mfma_f32_16x16x32_bf16 a[140:143], a[144:147], v[204:207], a[140:143]
v_exp_f32 v231, v127
v_mfma_f32_16x16x32_bf16 a[140:143], a[144:147], v[220:223], a[140:143]
s_waitcnt lgkmcnt(0)
v_cvt_pk_bf16_f32 v159, v230, v231
v_mfma_f32_16x16x32_bf16 v[96:99], a[224:227], v[32:35], v[240:243]
v_exp_f32 v224, v160
v_mfma_f32_16x16x32_bf16 v[96:99], a[228:231], v[36:39], v[96:99]
ds_read_b128 a[240:243], v2 offset:28672
v_mfma_f32_16x16x32_bf16 v[96:99], a[232:235], v[40:43], v[96:99]
v_exp_f32 v225, v161
v_mfma_f32_16x16x32_bf16 v[96:99], a[236:239], v[44:47], v[96:99]
ds_read_b128 a[244:247], v3 offset:28672
v_cvt_pk_bf16_f32 v192, v224, v225
v_mfma_f32_16x16x32_bf16 v[104:107], a[236:239], v[60:63], v[244:247]
v_exp_f32 v226, v162
v_mfma_f32_16x16x32_bf16 v[104:107], a[232:235], v[56:59], v[104:107]
ds_read_b128 a[248:251], v4 offset:28672
v_mfma_f32_16x16x32_bf16 v[104:107], a[228:231], v[52:55], v[104:107]
v_exp_f32 v227, v163
v_mfma_f32_16x16x32_bf16 v[104:107], a[224:227], v[48:51], v[104:107]
buffer_load_dwordx4 v14, s[36:39], s76 offen nt lds
v_mfma_f32_16x16x32_bf16 v[112:115], a[224:227], v[64:67], v[248:251]
v_exp_f32 v228, v164
v_mfma_f32_16x16x32_bf16 v[112:115], a[228:231], v[68:71], v[112:115]
ds_read_b128 a[252:255], v5 offset:28672
v_cvt_pk_bf16_f32 v193, v226, v227
v_mfma_f32_16x16x32_bf16 v[112:115], a[232:235], v[72:75], v[112:115]
v_exp_f32 v229, v165
v_mfma_f32_16x16x32_bf16 v[112:115], a[236:239], v[76:79], v[112:115]
v_cvt_pk_bf16_f32 v194, v228, v229
v_mfma_f32_16x16x32_bf16 v[120:123], a[236:239], v[92:95], v[252:255]
v_exp_f32 v230, v166
v_mfma_f32_16x16x32_bf16 v[120:123], a[232:235], v[88:91], v[120:123]
v_mfma_f32_16x16x32_bf16 v[120:123], a[228:231], v[84:87], v[120:123]
v_exp_f32 v231, v167
v_mfma_f32_16x16x32_bf16 v[120:123], a[224:227], v[80:83], v[120:123]
s_waitcnt vmcnt(13) lgkmcnt(0)
s_barrier
ds_read_b64_tr_b16 a[224:225], v6 offset:0
v_mfma_f32_16x16x32_bf16 v[124:127], a[240:243], v[80:83], v[252:255]
s_xor_b32 s76, s67, 131584
v_exp_f32 v224, v168
v_mfma_f32_16x16x32_bf16 v[124:127], a[244:247], v[84:87], v[124:127]
s_add_u32 m0, s69, 0
ds_read_b64_tr_b16 a[226:227], v6 offset:4096
v_cvt_pk_bf16_f32 v195, v230, v231
v_mfma_f32_16x16x32_bf16 v[124:127], a[248:251], v[88:91], v[124:127]
v_exp_f32 v225, v169
v_mfma_f32_16x16x32_bf16 v[124:127], a[252:255], v[92:95], v[124:127]
ds_read_b64_tr_b16 a[228:229], v6 offset:8192
v_cvt_pk_bf16_f32 v196, v224, v225
v_mfma_f32_16x16x32_bf16 v[116:119], a[252:255], v[76:79], v[248:251]
ds_read_b64_tr_b16 a[230:231], v6 offset:12288
v_mfma_f32_16x16x32_bf16 v[116:119], a[248:251], v[72:75], v[116:119]
v_exp_f32 v226, v170
v_mfma_f32_16x16x32_bf16 v[116:119], a[244:247], v[68:71], v[116:119]
buffer_load_dwordx4 v15, s[36:39], s76 offen offset:1024 nt lds
v_mfma_f32_16x16x32_bf16 v[116:119], a[240:243], v[64:67], v[116:119]
s_bfe_u32 s8, s2, 196611
v_exp_f32 v227, v171
v_mfma_f32_16x16x32_bf16 v[108:111], a[240:243], v[48:51], v[244:247]
s_cmp_eq_u32 s8, 4
s_cselect_b32 s71, 0, 0x1000
ds_read_b64_tr_b16 a[232:233], v7 offset:0
v_cvt_pk_bf16_f32 v197, v226, v227
v_mfma_f32_16x16x32_bf16 v[108:111], a[244:247], v[52:55], v[108:111]
v_exp_f32 v228, v172
v_mfma_f32_16x16x32_bf16 v[108:111], a[248:251], v[56:59], v[108:111]
ds_read_b64_tr_b16 a[234:235], v7 offset:4096
v_mfma_f32_16x16x32_bf16 v[108:111], a[252:255], v[60:63], v[108:111]
v_exp_f32 v229, v173
v_mfma_f32_16x16x32_bf16 v[100:103], a[252:255], v[44:47], v[240:243]
ds_read_b64_tr_b16 a[236:237], v7 offset:8192
v_cvt_pk_bf16_f32 v198, v228, v229
v_mfma_f32_16x16x32_bf16 v[100:103], a[248:251], v[40:43], v[100:103]
v_exp_f32 v230, v174
v_mfma_f32_16x16x32_bf16 v[100:103], a[244:247], v[36:39], v[100:103]
ds_read_b64_tr_b16 a[238:239], v7 offset:12288
v_mfma_f32_16x16x32_bf16 v[100:103], a[240:243], v[32:35], v[100:103]
s_waitcnt lgkmcnt(4)
ds_read_b64_tr_b16 a[240:241], v8 offset:0
v_mfma_f32_16x16x32_bf16 a[0:3], a[224:227], v[128:131], a[0:3]
v_exp_f32 v231, v175
v_mfma_f32_16x16x32_bf16 a[0:3], a[228:231], v[144:147], a[0:3]
buffer_atomic_add v233, v20, s[12:15], s71 offen sc1
v_mfma_f32_16x16x32_bf16 a[4:7], a[228:231], v[148:151], a[4:7]
v_exp_f32 v224, v176
v_mfma_f32_16x16x32_bf16 a[4:7], a[224:227], v[132:135], a[4:7]
ds_read_b64_tr_b16 a[242:243], v8 offset:4096
v_cvt_pk_bf16_f32 v199, v230, v231
v_mfma_f32_16x16x32_bf16 a[8:11], a[224:227], v[136:139], a[8:11]
v_exp_f32 v225, v177
v_mfma_f32_16x16x32_bf16 a[8:11], a[228:231], v[152:155], a[8:11]
ds_read_b64_tr_b16 a[244:245], v8 offset:8192
v_cvt_pk_bf16_f32 v200, v224, v225
v_mfma_f32_16x16x32_bf16 a[12:15], a[228:231], v[156:159], a[12:15]
v_exp_f32 v226, v178
v_mfma_f32_16x16x32_bf16 a[12:15], a[224:227], v[140:143], a[12:15]
s_waitcnt lgkmcnt(3)
ds_read_b64_tr_b16 a[246:247], v8 offset:12288
v_mfma_f32_16x16x32_bf16 a[28:31], a[232:235], v[140:143], a[28:31]
v_exp_f32 v227, v179
v_mfma_f32_16x16x32_bf16 a[28:31], a[236:239], v[156:159], a[28:31]
ds_read_b64_tr_b16 a[248:249], v9 offset:0
v_cvt_pk_bf16_f32 v201, v226, v227
v_mfma_f32_16x16x32_bf16 a[24:27], a[236:239], v[152:155], a[24:27]
ds_read_b64_tr_b16 a[250:251], v9 offset:4096
v_mfma_f32_16x16x32_bf16 a[24:27], a[232:235], v[136:139], a[24:27]
v_exp_f32 v228, v180
v_mfma_f32_16x16x32_bf16 a[20:23], a[232:235], v[132:135], a[20:23]
buffer_load_dwordx4 v16, s[36:39], s76 offen offset:2048 nt lds
v_mfma_f32_16x16x32_bf16 a[20:23], a[236:239], v[148:151], a[20:23]
v_exp_f32 v229, v181
v_mfma_f32_16x16x32_bf16 a[16:19], a[236:239], v[144:147], a[16:19]
ds_read_b64_tr_b16 a[252:253], v9 offset:8192
v_cvt_pk_bf16_f32 v202, v228, v229
v_mfma_f32_16x16x32_bf16 a[16:19], a[232:235], v[128:131], a[16:19]
s_waitcnt lgkmcnt(3)
v_exp_f32 v230, v182
v_mfma_f32_16x16x32_bf16 a[32:35], a[240:243], v[128:131], a[32:35]
ds_read_b64_tr_b16 a[254:255], v9 offset:12288
v_mfma_f32_16x16x32_bf16 a[32:35], a[244:247], v[144:147], a[32:35]
v_exp_f32 v231, v183
v_mfma_f32_16x16x32_bf16 a[36:39], a[244:247], v[148:151], a[36:39]
v_cvt_pk_bf16_f32 v203, v230, v231
v_mfma_f32_16x16x32_bf16 a[36:39], a[240:243], v[132:135], a[36:39]
v_exp_f32 v224, v184
v_mfma_f32_16x16x32_bf16 a[40:43], a[240:243], v[136:139], a[40:43]
ds_read_b128 a[224:227], v2 offset:32768
v_mfma_f32_16x16x32_bf16 a[40:43], a[244:247], v[152:155], a[40:43]
ds_read_b128 a[228:231], v3 offset:32768
v_mfma_f32_16x16x32_bf16 a[44:47], a[244:247], v[156:159], a[44:47]
v_exp_f32 v225, v185
v_mfma_f32_16x16x32_bf16 a[44:47], a[240:243], v[140:143], a[44:47]
s_waitcnt lgkmcnt(2)
buffer_load_dwordx4 v17, s[36:39], s76 offen offset:3072 nt lds
v_mfma_f32_16x16x32_bf16 a[60:63], a[248:251], v[140:143], a[60:63]
s_bfe_u32 s8, s2, 196611
v_exp_f32 v226, v186
v_mfma_f32_16x16x32_bf16 a[60:63], a[252:255], v[156:159], a[60:63]
s_cmp_eq_u32 s8, 5
s_cselect_b32 s71, 0, 0x1000
ds_read_b128 a[232:235], v4 offset:32768
v_cvt_pk_bf16_f32 v204, v224, v225
v_mfma_f32_16x16x32_bf16 a[56:59], a[252:255], v[152:155], a[56:59]
v_exp_f32 v227, v187
v_mfma_f32_16x16x32_bf16 a[56:59], a[248:251], v[136:139], a[56:59]
ds_read_b128 a[236:239], v5 offset:32768
v_cvt_pk_bf16_f32 v205, v226, v227
v_mfma_f32_16x16x32_bf16 a[52:55], a[248:251], v[132:135], a[52:55]
v_exp_f32 v228, v188
v_mfma_f32_16x16x32_bf16 a[52:55], a[252:255], v[148:151], a[52:55]
v_mfma_f32_16x16x32_bf16 a[48:51], a[252:255], v[144:147], a[48:51]
v_exp_f32 v229, v189
v_mfma_f32_16x16x32_bf16 a[48:51], a[248:251], v[128:131], a[48:51]
v_cvt_pk_bf16_f32 v206, v228, v229
v_mfma_f32_16x16x32_bf16 a[128:131], a[144:147], v[128:131], a[128:131]
v_exp_f32 v230, v190
v_mfma_f32_16x16x32_bf16 a[128:131], a[144:147], v[144:147], a[128:131]
buffer_atomic_add v233, v20, s[12:15], s71 offen sc1
v_mfma_f32_16x16x32_bf16 a[132:135], a[144:147], v[132:135], a[132:135]
s_xor_b32 s76, s67, 147456
v_exp_f32 v231, v191
v_mfma_f32_16x16x32_bf16 a[132:135], a[144:147], v[148:151], a[132:135]
s_waitcnt lgkmcnt(0)
v_cvt_pk_bf16_f32 v207, v230, v231
v_mfma_f32_16x16x32_bf16 v[160:163], a[224:227], v[32:35], v[240:243]
s_add_u32 m0, s69, 114688
v_exp_f32 v224, v96
v_mfma_f32_16x16x32_bf16 v[160:163], a[228:231], v[36:39], v[160:163]
ds_read_b128 a[240:243], v2 offset:36864
v_mfma_f32_16x16x32_bf16 v[160:163], a[232:235], v[40:43], v[160:163]
v_exp_f32 v225, v97
v_mfma_f32_16x16x32_bf16 v[160:163], a[236:239], v[44:47], v[160:163]
ds_read_b128 a[244:247], v3 offset:36864
v_cvt_pk_bf16_f32 v208, v224, v225
v_mfma_f32_16x16x32_bf16 v[168:171], a[236:239], v[60:63], v[244:247]
v_exp_f32 v226, v98
v_mfma_f32_16x16x32_bf16 v[168:171], a[232:235], v[56:59], v[168:171]
ds_read_b128 a[248:251], v4 offset:36864
v_mfma_f32_16x16x32_bf16 v[168:171], a[228:231], v[52:55], v[168:171]
v_exp_f32 v227, v99
v_mfma_f32_16x16x32_bf16 v[168:171], a[224:227], v[48:51], v[168:171]
ds_read_b128 a[252:255], v5 offset:36864
v_cvt_pk_bf16_f32 v209, v226, v227
v_mfma_f32_16x16x32_bf16 v[176:179], a[224:227], v[64:67], v[248:251]
v_exp_f32 v228, v100
v_mfma_f32_16x16x32_bf16 v[176:179], a[228:231], v[68:71], v[176:179]
buffer_load_dwordx4 v18, s[40:43], s76 offen nt lds
v_mfma_f32_16x16x32_bf16 v[176:179], a[232:235], v[72:75], v[176:179]
v_exp_f32 v229, v101
v_mfma_f32_16x16x32_bf16 v[176:179], a[236:239], v[76:79], v[176:179]
v_cvt_pk_bf16_f32 v210, v228, v229
v_mfma_f32_16x16x32_bf16 v[184:187], a[236:239], v[92:95], v[252:255]
v_exp_f32 v230, v102
v_mfma_f32_16x16x32_bf16 v[184:187], a[232:235], v[88:91], v[184:187]
v_mfma_f32_16x16x32_bf16 v[184:187], a[228:231], v[84:87], v[184:187]
v_exp_f32 v231, v103
v_mfma_f32_16x16x32_bf16 v[184:187], a[224:227], v[80:83], v[184:187]
s_waitcnt lgkmcnt(0)
ds_read_b64_tr_b16 a[224:225], v10 offset:0
v_cvt_pk_bf16_f32 v211, v230, v231
v_mfma_f32_16x16x32_bf16 v[188:191], a[240:243], v[80:83], v[252:255]
v_exp_f32 v224, v104
v_mfma_f32_16x16x32_bf16 v[188:191], a[244:247], v[84:87], v[188:191]
ds_read_b64_tr_b16 a[226:227], v10 offset:4096
v_mfma_f32_16x16x32_bf16 v[188:191], a[248:251], v[88:91], v[188:191]
v_exp_f32 v225, v105
v_mfma_f32_16x16x32_bf16 v[188:191], a[252:255], v[92:95], v[188:191]
buffer_load_dwordx4 v19, s[40:43], s76 offen offset:1024 nt lds
v_mfma_f32_16x16x32_bf16 v[180:183], a[252:255], v[76:79], v[248:251]
s_bfe_u32 s8, s2, 196611
ds_read_b64_tr_b16 a[228:229], v10 offset:8192
v_cvt_pk_bf16_f32 v212, v224, v225
v_mfma_f32_16x16x32_bf16 v[180:183], a[248:251], v[72:75], v[180:183]
s_cmp_eq_u32 s8, 6
s_cselect_b32 s71, 0, 0x1000
v_exp_f32 v226, v106
v_mfma_f32_16x16x32_bf16 v[180:183], a[244:247], v[68:71], v[180:183]
ds_read_b64_tr_b16 a[230:231], v10 offset:12288
v_mfma_f32_16x16x32_bf16 v[180:183], a[240:243], v[64:67], v[180:183]
v_exp_f32 v227, v107
v_mfma_f32_16x16x32_bf16 v[172:175], a[240:243], v[48:51], v[244:247]
ds_read_b64_tr_b16 a[232:233], v11 offset:0
v_cvt_pk_bf16_f32 v213, v226, v227
v_mfma_f32_16x16x32_bf16 v[172:175], a[244:247], v[52:55], v[172:175]
v_exp_f32 v228, v108
v_mfma_f32_16x16x32_bf16 v[172:175], a[248:251], v[56:59], v[172:175]
ds_read_b64_tr_b16 a[234:235], v11 offset:4096
v_mfma_f32_16x16x32_bf16 v[172:175], a[252:255], v[60:63], v[172:175]
v_exp_f32 v229, v109
v_mfma_f32_16x16x32_bf16 v[164:167], a[252:255], v[44:47], v[240:243]
L_hop1_3:
s_cbranch_execz L_hop_ret1
ds_read_b64_tr_b16 a[236:237], v11 offset:8192
v_cvt_pk_bf16_f32 v214, v228, v229
v_mfma_f32_16x16x32_bf16 v[164:167], a[248:251], v[40:43], v[164:167]
v_exp_f32 v230, v110
v_mfma_f32_16x16x32_bf16 v[164:167], a[244:247], v[36:39], v[164:167]
buffer_atomic_add v233, v20, s[12:15], s71 offen sc1
v_mfma_f32_16x16x32_bf16 v[164:167], a[240:243], v[32:35], v[164:167]
s_waitcnt lgkmcnt(3)
ds_read_b64_tr_b16 a[238:239], v11 offset:12288
v_mfma_f32_16x16x32_bf16 a[64:67], a[224:227], v[128:131], a[64:67]
v_exp_f32 v231, v111
v_mfma_f32_16x16x32_bf16 a[64:67], a[228:231], v[144:147], a[64:67]
ds_read_b64_tr_b16 a[240:241], v12 offset:0
v_cvt_pk_bf16_f32 v215, v230, v231
v_mfma_f32_16x16x32_bf16 a[68:71], a[228:231], v[148:151], a[68:71]
v_exp_f32 v224, v112
v_mfma_f32_16x16x32_bf16 a[68:71], a[224:227], v[132:135], a[68:71]
ds_read_b64_tr_b16 a[242:243], v12 offset:4096
v_mfma_f32_16x16x32_bf16 a[72:75], a[224:227], v[136:139], a[72:75]
v_exp_f32 v225, v113
v_mfma_f32_16x16x32_bf16 a[72:75], a[228:231], v[152:155], a[72:75]
ds_read_b64_tr_b16 a[244:245], v12 offset:8192
v_cvt_pk_bf16_f32 v216, v224, v225
v_mfma_f32_16x16x32_bf16 a[76:79], a[228:231], v[156:159], a[76:79]
v_exp_f32 v226, v114
v_mfma_f32_16x16x32_bf16 a[76:79], a[224:227], v[140:143], a[76:79]
s_waitcnt lgkmcnt(3)
ds_read_b64_tr_b16 a[246:247], v12 offset:12288
v_mfma_f32_16x16x32_bf16 a[92:95], a[232:235], v[140:143], a[92:95]
v_exp_f32 v227, v115
v_mfma_f32_16x16x32_bf16 a[92:95], a[236:239], v[156:159], a[92:95]
buffer_load_dwordx4 v18, s[40:43], s76 offen offset:2048 nt lds
v_mfma_f32_16x16x32_bf16 a[88:91], a[236:239], v[152:155], a[88:91]
ds_read_b64_tr_b16 a[248:249], v13 offset:0
v_cvt_pk_bf16_f32 v217, v226, v227
v_mfma_f32_16x16x32_bf16 a[88:91], a[232:235], v[136:139], a[88:91]
v_exp_f32 v228, v116
v_mfma_f32_16x16x32_bf16 a[84:87], a[232:235], v[132:135], a[84:87]
ds_read_b64_tr_b16 a[250:251], v13 offset:4096
v_mfma_f32_16x16x32_bf16 a[84:87], a[236:239], v[148:151], a[84:87]
v_exp_f32 v229, v117
v_mfma_f32_16x16x32_bf16 a[80:83], a[236:239], v[144:147], a[80:83]
ds_read_b64_tr_b16 a[252:253], v13 offset:8192
v_cvt_pk_bf16_f32 v218, v228, v229
v_mfma_f32_16x16x32_bf16 a[80:83], a[232:235], v[128:131], a[80:83]
s_waitcnt lgkmcnt(3)
v_exp_f32 v230, v118
v_mfma_f32_16x16x32_bf16 a[96:99], a[240:243], v[128:131], a[96:99]
ds_read_b64_tr_b16 a[254:255], v13 offset:12288
v_mfma_f32_16x16x32_bf16 a[96:99], a[244:247], v[144:147], a[96:99]
v_exp_f32 v231, v119
v_mfma_f32_16x16x32_bf16 a[100:103], a[244:247], v[148:151], a[100:103]
v_cvt_pk_bf16_f32 v219, v230, v231
v_mfma_f32_16x16x32_bf16 a[100:103], a[240:243], v[132:135], a[100:103]
v_exp_f32 v224, v120
v_mfma_f32_16x16x32_bf16 a[104:107], a[240:243], v[136:139], a[104:107]
buffer_load_dwordx4 v19, s[40:43], s76 offen offset:3072 nt lds
v_mfma_f32_16x16x32_bf16 a[104:107], a[244:247], v[152:155], a[104:107]
s_bfe_u32 s8, s2, 196611
ds_read_b128 a[224:227], v2 offset:40960
v_mfma_f32_16x16x32_bf16 a[108:111], a[244:247], v[156:159], a[108:111]
s_cmp_eq_u32 s8, 7
s_cselect_b32 s71, 0, 0x1000
v_exp_f32 v225, v121
v_mfma_f32_16x16x32_bf16 a[108:111], a[240:243], v[140:143], a[108:111]
s_waitcnt lgkmcnt(1)
ds_read_b128 a[228:231], v3 offset:40960
v_cvt_pk_bf16_f32 v220, v224, v225
v_mfma_f32_16x16x32_bf16 a[124:127], a[248:251], v[140:143], a[124:127]
v_exp_f32 v226, v122
v_mfma_f32_16x16x32_bf16 a[124:127], a[252:255], v[156:159], a[124:127]
ds_read_b128 a[232:235], v4 offset:40960
v_mfma_f32_16x16x32_bf16 a[120:123], a[252:255], v[152:155], a[120:123]
v_exp_f32 v227, v123
v_mfma_f32_16x16x32_bf16 a[120:123], a[248:251], v[136:139], a[120:123]
ds_read_b128 a[236:239], v5 offset:40960
v_cvt_pk_bf16_f32 v221, v226, v227
v_mfma_f32_16x16x32_bf16 a[116:119], a[248:251], v[132:135], a[116:119]
v_exp_f32 v228, v124
v_mfma_f32_16x16x32_bf16 a[116:119], a[252:255], v[148:151], a[116:119]
v_mfma_f32_16x16x32_bf16 a[112:115], a[252:255], v[144:147], a[112:115]
v_exp_f32 v229, v125
v_mfma_f32_16x16x32_bf16 a[112:115], a[248:251], v[128:131], a[112:115]
buffer_atomic_add v233, v20, s[12:15], s71 offen sc1
v_mfma_f32_16x16x32_bf16 a[136:139], a[144:147], v[136:139], a[136:139]
s_xor_b32 s76, s67, 197120
v_exp_f32 v230, v126
v_mfma_f32_16x16x32_bf16 a[136:139], a[144:147], v[152:155], a[136:139]
s_add_u32 m0, s69, 16384
v_cvt_pk_bf16_f32 v222, v228, v229
v_mfma_f32_16x16x32_bf16 a[140:143], a[144:147], v[140:143], a[140:143]
v_exp_f32 v231, v127
v_mfma_f32_16x16x32_bf16 a[140:143], a[144:147], v[156:159], a[140:143]
s_waitcnt lgkmcnt(0)
v_cvt_pk_bf16_f32 v223, v230, v231
v_mfma_f32_16x16x32_bf16 v[96:99], a[224:227], v[32:35], v[240:243]
v_exp_f32 v224, v160
v_mfma_f32_16x16x32_bf16 v[96:99], a[228:231], v[36:39], v[96:99]
ds_read_b128 a[240:243], v2 offset:45056
v_mfma_f32_16x16x32_bf16 v[96:99], a[232:235], v[40:43], v[96:99]
v_exp_f32 v225, v161
v_mfma_f32_16x16x32_bf16 v[96:99], a[236:239], v[44:47], v[96:99]
ds_read_b128 a[244:247], v3 offset:45056
v_cvt_pk_bf16_f32 v128, v224, v225
v_mfma_f32_16x16x32_bf16 v[104:107], a[236:239], v[60:63], v[244:247]
v_exp_f32 v226, v162
v_mfma_f32_16x16x32_bf16 v[104:107], a[232:235], v[56:59], v[104:107]
ds_read_b128 a[248:251], v4 offset:45056
v_mfma_f32_16x16x32_bf16 v[104:107], a[228:231], v[52:55], v[104:107]
v_exp_f32 v227, v163
v_mfma_f32_16x16x32_bf16 v[104:107], a[224:227], v[48:51], v[104:107]
buffer_load_dwordx4 v14, s[36:39], s76 offen nt lds
v_mfma_f32_16x16x32_bf16 v[112:115], a[224:227], v[64:67], v[248:251]
v_exp_f32 v228, v164
v_mfma_f32_16x16x32_bf16 v[112:115], a[228:231], v[68:71], v[112:115]
ds_read_b128 a[252:255], v5 offset:45056
v_cvt_pk_bf16_f32 v129, v226, v227
v_mfma_f32_16x16x32_bf16 v[112:115], a[232:235], v[72:75], v[112:115]
v_exp_f32 v229, v165
v_mfma_f32_16x16x32_bf16 v[112:115], a[236:239], v[76:79], v[112:115]
v_cvt_pk_bf16_f32 v130, v228, v229
v_mfma_f32_16x16x32_bf16 v[120:123], a[236:239], v[92:95], v[252:255]
v_exp_f32 v230, v166
v_mfma_f32_16x16x32_bf16 v[120:123], a[232:235], v[88:91], v[120:123]
v_mfma_f32_16x16x32_bf16 v[120:123], a[228:231], v[84:87], v[120:123]
v_exp_f32 v231, v167
v_mfma_f32_16x16x32_bf16 v[120:123], a[224:227], v[80:83], v[120:123]
s_waitcnt vmcnt(14) lgkmcnt(0)
s_barrier
ds_read_b64_tr_b16 a[224:225], v6 offset:32768
v_mfma_f32_16x16x32_bf16 v[124:127], a[240:243], v[80:83], v[252:255]
s_xor_b32 s76, s67, 197120
v_exp_f32 v224, v168
v_mfma_f32_16x16x32_bf16 v[124:127], a[244:247], v[84:87], v[124:127]
s_add_u32 m0, s69, 16384
ds_read_b64_tr_b16 a[226:227], v6 offset:36864
v_cvt_pk_bf16_f32 v131, v230, v231
v_mfma_f32_16x16x32_bf16 v[124:127], a[248:251], v[88:91], v[124:127]
v_exp_f32 v225, v169
v_mfma_f32_16x16x32_bf16 v[124:127], a[252:255], v[92:95], v[124:127]
ds_read_b64_tr_b16 a[228:229], v6 offset:40960
v_cvt_pk_bf16_f32 v132, v224, v225
v_mfma_f32_16x16x32_bf16 v[116:119], a[252:255], v[76:79], v[248:251]
ds_read_b64_tr_b16 a[230:231], v6 offset:45056
v_mfma_f32_16x16x32_bf16 v[116:119], a[248:251], v[72:75], v[116:119]
v_exp_f32 v226, v170
v_mfma_f32_16x16x32_bf16 v[116:119], a[244:247], v[68:71], v[116:119]
ds_read_b64_tr_b16 a[232:233], v7 offset:32768
v_mfma_f32_16x16x32_bf16 v[116:119], a[240:243], v[64:67], v[116:119]
v_exp_f32 v227, v171
v_mfma_f32_16x16x32_bf16 v[108:111], a[240:243], v[48:51], v[244:247]
buffer_load_dwordx4 v15, s[36:39], s76 offen offset:1024 nt lds
v_mfma_f32_16x16x32_bf16 v[108:111], a[244:247], v[52:55], v[108:111]
v_exp_f32 v228, v172
v_mfma_f32_16x16x32_bf16 v[108:111], a[248:251], v[56:59], v[108:111]
ds_read_b64_tr_b16 a[234:235], v7 offset:36864
v_cvt_pk_bf16_f32 v133, v226, v227
v_mfma_f32_16x16x32_bf16 v[108:111], a[252:255], v[60:63], v[108:111]
v_exp_f32 v229, v173
v_mfma_f32_16x16x32_bf16 v[100:103], a[252:255], v[44:47], v[240:243]
ds_read_b64_tr_b16 a[236:237], v7 offset:40960
v_cvt_pk_bf16_f32 v134, v228, v229
v_mfma_f32_16x16x32_bf16 v[100:103], a[248:251], v[40:43], v[100:103]
v_exp_f32 v230, v174
v_mfma_f32_16x16x32_bf16 v[100:103], a[244:247], v[36:39], v[100:103]
ds_read_b64_tr_b16 a[238:239], v7 offset:45056
v_mfma_f32_16x16x32_bf16 v[100:103], a[240:243], v[32:35], v[100:103]
s_waitcnt lgkmcnt(4)
ds_read_b64_tr_b16 a[240:241], v8 offset:32768
v_mfma_f32_16x16x32_bf16 a[0:3], a[224:227], v[192:195], a[0:3]
v_exp_f32 v231, v175
v_mfma_f32_16x16x32_bf16 a[0:3], a[228:231], v[208:211], a[0:3]
ds_read_b64_tr_b16 a[242:243], v8 offset:36864
v_cvt_pk_bf16_f32 v135, v230, v231
v_mfma_f32_16x16x32_bf16 a[4:7], a[228:231], v[212:215], a[4:7]
v_exp_f32 v224, v176
v_mfma_f32_16x16x32_bf16 a[4:7], a[224:227], v[196:199], a[4:7]
ds_read_b64_tr_b16 a[244:245], v8 offset:40960
v_mfma_f32_16x16x32_bf16 a[8:11], a[224:227], v[200:203], a[8:11]
v_exp_f32 v225, v177
v_mfma_f32_16x16x32_bf16 a[8:11], a[228:231], v[216:219], a[8:11]
ds_read_b64_tr_b16 a[246:247], v8 offset:45056
v_cvt_pk_bf16_f32 v136, v224, v225
v_mfma_f32_16x16x32_bf16 a[12:15], a[228:231], v[220:223], a[12:15]
v_exp_f32 v226, v178
v_mfma_f32_16x16x32_bf16 a[12:15], a[224:227], v[204:207], a[12:15]
s_waitcnt lgkmcnt(4)
ds_read_b64_tr_b16 a[248:249], v9 offset:32768
v_mfma_f32_16x16x32_bf16 a[28:31], a[232:235], v[204:207], a[28:31]
v_exp_f32 v227, v179
v_mfma_f32_16x16x32_bf16 a[28:31], a[236:239], v[220:223], a[28:31]
buffer_load_dwordx4 v16, s[36:39], s76 offen offset:2048 nt lds
v_mfma_f32_16x16x32_bf16 a[24:27], a[236:239], v[216:219], a[24:27]
ds_read_b64_tr_b16 a[250:251], v9 offset:36864
v_cvt_pk_bf16_f32 v137, v226, v227
v_mfma_f32_16x16x32_bf16 a[24:27], a[232:235], v[200:203], a[24:27]
v_exp_f32 v228, v180
v_mfma_f32_16x16x32_bf16 a[20:23], a[232:235], v[196:199], a[20:23]
ds_read_b64_tr_b16 a[252:253], v9 offset:40960
v_mfma_f32_16x16x32_bf16 a[20:23], a[236:239], v[212:215], a[20:23]
v_exp_f32 v229, v181
v_mfma_f32_16x16x32_bf16 a[16:19], a[236:239], v[208:211], a[16:19]
ds_read_b64_tr_b16 a[254:255], v9 offset:45056
v_cvt_pk_bf16_f32 v138, v228, v229
v_mfma_f32_16x16x32_bf16 a[16:19], a[232:235], v[192:195], a[16:19]
s_waitcnt lgkmcnt(4)
v_exp_f32 v230, v182
v_mfma_f32_16x16x32_bf16 a[32:35], a[240:243], v[192:195], a[32:35]
v_mfma_f32_16x16x32_bf16 a[32:35], a[244:247], v[208:211], a[32:35]
v_exp_f32 v231, v183
v_mfma_f32_16x16x32_bf16 a[36:39], a[244:247], v[212:215], a[36:39]
v_cvt_pk_bf16_f32 v139, v230, v231
v_mfma_f32_16x16x32_bf16 a[36:39], a[240:243], v[196:199], a[36:39]
v_exp_f32 v224, v184
v_mfma_f32_16x16x32_bf16 a[40:43], a[240:243], v[200:203], a[40:43]
ds_read_b128 a[224:227], v2 offset:49152
v_mfma_f32_16x16x32_bf16 a[40:43], a[244:247], v[216:219], a[40:43]
ds_read_b128 a[228:231], v3 offset:49152
v_mfma_f32_16x16x32_bf16 a[44:47], a[244:247], v[220:223], a[44:47]
v_exp_f32 v225, v185
v_mfma_f32_16x16x32_bf16 a[44:47], a[240:243], v[204:207], a[44:47]
s_waitcnt lgkmcnt(2)
ds_read_b128 a[232:235], v4 offset:49152
v_cvt_pk_bf16_f32 v140, v224, v225
v_mfma_f32_16x16x32_bf16 a[60:63], a[248:251], v[204:207], a[60:63]
v_exp_f32 v226, v186
v_mfma_f32_16x16x32_bf16 a[60:63], a[252:255], v[220:223], a[60:63]
buffer_load_dwordx4 v17, s[36:39], s76 offen offset:3072 nt lds
v_mfma_f32_16x16x32_bf16 a[56:59], a[252:255], v[216:219], a[56:59]
s_xor_b32 s76, s67, 212992
v_exp_f32 v227, v187
v_mfma_f32_16x16x32_bf16 a[56:59], a[248:251], v[200:203], a[56:59]
s_add_u32 m0, s69, 81920
ds_read_b128 a[236:239], v5 offset:49152
v_cvt_pk_bf16_f32 v141, v226, v227
v_mfma_f32_16x16x32_bf16 a[52:55], a[248:251], v[196:199], a[52:55]
v_exp_f32 v228, v188
v_mfma_f32_16x16x32_bf16 a[52:55], a[252:255], v[212:215], a[52:55]
v_mfma_f32_16x16x32_bf16 a[48:51], a[252:255], v[208:211], a[48:51]
v_exp_f32 v229, v189
v_mfma_f32_16x16x32_bf16 a[48:51], a[248:251], v[192:195], a[48:51]
v_cvt_pk_bf16_f32 v142, v228, v229
v_mfma_f32_16x16x32_bf16 a[128:131], a[144:147], v[192:195], a[128:131]
v_exp_f32 v230, v190
v_mfma_f32_16x16x32_bf16 a[128:131], a[144:147], v[208:211], a[128:131]
v_mfma_f32_16x16x32_bf16 a[132:135], a[144:147], v[196:199], a[132:135]
v_exp_f32 v231, v191
v_mfma_f32_16x16x32_bf16 a[132:135], a[144:147], v[212:215], a[132:135]
s_waitcnt lgkmcnt(0)
v_cvt_pk_bf16_f32 v143, v230, v231
v_mfma_f32_16x16x32_bf16 v[160:163], a[224:227], v[32:35], v[240:243]
v_exp_f32 v224, v96
v_mfma_f32_16x16x32_bf16 v[160:163], a[228:231], v[36:39], v[160:163]
ds_read_b128 a[240:243], v2 offset:53248
v_mfma_f32_16x16x32_bf16 v[160:163], a[232:235], v[40:43], v[160:163]
v_exp_f32 v225, v97
v_mfma_f32_16x16x32_bf16 v[160:163], a[236:239], v[44:47], v[160:163]
ds_read_b128 a[244:247], v3 offset:53248
v_cvt_pk_bf16_f32 v144, v224, v225
v_mfma_f32_16x16x32_bf16 v[168:171], a[236:239], v[60:63], v[244:247]
v_exp_f32 v226, v98
v_mfma_f32_16x16x32_bf16 v[168:171], a[232:235], v[56:59], v[168:171]
buffer_load_dwordx4 v18, s[40:43], s76 offen nt lds
v_mfma_f32_16x16x32_bf16 v[168:171], a[228:231], v[52:55], v[168:171]
v_exp_f32 v227, v99
v_mfma_f32_16x16x32_bf16 v[168:171], a[224:227], v[48:51], v[168:171]
ds_read_b128 a[248:251], v4 offset:53248
v_cvt_pk_bf16_f32 v145, v226, v227
v_mfma_f32_16x16x32_bf16 v[176:179], a[224:227], v[64:67], v[248:251]
v_exp_f32 v228, v100
v_mfma_f32_16x16x32_bf16 v[176:179], a[228:231], v[68:71], v[176:179]
ds_read_b128 a[252:255], v5 offset:53248
v_mfma_f32_16x16x32_bf16 v[176:179], a[232:235], v[72:75], v[176:179]
v_exp_f32 v229, v101
v_mfma_f32_16x16x32_bf16 v[176:179], a[236:239], v[76:79], v[176:179]
v_cvt_pk_bf16_f32 v146, v228, v229
v_mfma_f32_16x16x32_bf16 v[184:187], a[236:239], v[92:95], v[252:255]
v_exp_f32 v230, v102
v_mfma_f32_16x16x32_bf16 v[184:187], a[232:235], v[88:91], v[184:187]
v_mfma_f32_16x16x32_bf16 v[184:187], a[228:231], v[84:87], v[184:187]
v_exp_f32 v231, v103
v_mfma_f32_16x16x32_bf16 v[184:187], a[224:227], v[80:83], v[184:187]
s_waitcnt lgkmcnt(0)
ds_read_b64_tr_b16 a[224:225], v10 offset:32768
v_cvt_pk_bf16_f32 v147, v230, v231
v_mfma_f32_16x16x32_bf16 v[188:191], a[240:243], v[80:83], v[252:255]
v_exp_f32 v224, v104
v_mfma_f32_16x16x32_bf16 v[188:191], a[244:247], v[84:87], v[188:191]
ds_read_b64_tr_b16 a[226:227], v10 offset:36864
v_mfma_f32_16x16x32_bf16 v[188:191], a[248:251], v[88:91], v[188:191]
v_exp_f32 v225, v105
v_mfma_f32_16x16x32_bf16 v[188:191], a[252:255], v[92:95], v[188:191]
ds_read_b64_tr_b16 a[228:229], v10 offset:40960
v_cvt_pk_bf16_f32 v148, v224, v225
v_mfma_f32_16x16x32_bf16 v[180:183], a[252:255], v[76:79], v[248:251]
ds_read_b64_tr_b16 a[230:231], v10 offset:45056
v_mfma_f32_16x16x32_bf16 v[180:183], a[248:251], v[72:75], v[180:183]
v_exp_f32 v226, v106
v_mfma_f32_16x16x32_bf16 v[180:183], a[244:247], v[68:71], v[180:183]
buffer_load_dwordx4 v19, s[40:43], s76 offen offset:1024 nt lds
v_mfma_f32_16x16x32_bf16 v[180:183], a[240:243], v[64:67], v[180:183]
v_exp_f32 v227, v107
v_mfma_f32_16x16x32_bf16 v[172:175], a[240:243], v[48:51], v[244:247]
ds_read_b64_tr_b16 a[232:233], v11 offset:32768
v_cvt_pk_bf16_f32 v149, v226, v227
v_mfma_f32_16x16x32_bf16 v[172:175], a[244:247], v[52:55], v[172:175]
v_exp_f32 v228, v108
v_mfma_f32_16x16x32_bf16 v[172:175], a[248:251], v[56:59], v[172:175]
ds_read_b64_tr_b16 a[234:235], v11 offset:36864
v_mfma_f32_16x16x32_bf16 v[172:175], a[252:255], v[60:63], v[172:175]
v_exp_f32 v229, v109
v_mfma_f32_16x16x32_bf16 v[164:167], a[252:255], v[44:47], v[240:243]
ds_read_b64_tr_b16 a[236:237], v11 offset:40960
v_cvt_pk_bf16_f32 v150, v228, v229
v_mfma_f32_16x16x32_bf16 v[164:167], a[248:251], v[40:43], v[164:167]
v_exp_f32 v230, v110
v_mfma_f32_16x16x32_bf16 v[164:167], a[244:247], v[36:39], v[164:167]
ds_read_b64_tr_b16 a[238:239], v11 offset:45056
v_mfma_f32_16x16x32_bf16 v[164:167], a[240:243], v[32:35], v[164:167]
s_waitcnt lgkmcnt(4)
ds_read_b64_tr_b16 a[240:241], v12 offset:32768
v_mfma_f32_16x16x32_bf16 a[64:67], a[224:227], v[192:195], a[64:67]
v_exp_f32 v231, v111
v_mfma_f32_16x16x32_bf16 a[64:67], a[228:231], v[208:211], a[64:67]
ds_read_b64_tr_b16 a[242:243], v12 offset:36864
v_cvt_pk_bf16_f32 v151, v230, v231
v_mfma_f32_16x16x32_bf16 a[68:71], a[228:231], v[212:215], a[68:71]
v_exp_f32 v224, v112
v_mfma_f32_16x16x32_bf16 a[68:71], a[224:227], v[196:199], a[68:71]
ds_read_b64_tr_b16 a[244:245], v12 offset:40960
v_mfma_f32_16x16x32_bf16 a[72:75], a[224:227], v[200:203], a[72:75]
v_exp_f32 v225, v113
v_mfma_f32_16x16x32_bf16 a[72:75], a[228:231], v[216:219], a[72:75]
ds_read_b64_tr_b16 a[246:247], v12 offset:45056
v_cvt_pk_bf16_f32 v152, v224, v225
v_mfma_f32_16x16x32_bf16 a[76:79], a[228:231], v[220:223], a[76:79]
v_exp_f32 v226, v114
v_mfma_f32_16x16x32_bf16 a[76:79], a[224:227], v[204:207], a[76:79]
s_waitcnt lgkmcnt(4)
buffer_load_dwordx4 v18, s[40:43], s76 offen offset:2048 nt lds
v_mfma_f32_16x16x32_bf16 a[92:95], a[232:235], v[204:207], a[92:95]
v_exp_f32 v227, v115
v_mfma_f32_16x16x32_bf16 a[92:95], a[236:239], v[220:223], a[92:95]
ds_read_b64_tr_b16 a[248:249], v13 offset:32768
v_cvt_pk_bf16_f32 v153, v226, v227
v_mfma_f32_16x16x32_bf16 a[88:91], a[236:239], v[216:219], a[88:91]
ds_read_b64_tr_b16 a[250:251], v13 offset:36864
v_mfma_f32_16x16x32_bf16 a[88:91], a[232:235], v[200:203], a[88:91]
v_exp_f32 v228, v116
v_mfma_f32_16x16x32_bf16 a[84:87], a[232:235], v[196:199], a[84:87]
ds_read_b64_tr_b16 a[252:253], v13 offset:40960
v_mfma_f32_16x16x32_bf16 a[84:87], a[236:239], v[212:215], a[84:87]
v_exp_f32 v229, v117
v_mfma_f32_16x16x32_bf16 a[80:83], a[236:239], v[208:211], a[80:83]
ds_read_b64_tr_b16 a[254:255], v13 offset:45056
v_cvt_pk_bf16_f32 v154, v228, v229
v_mfma_f32_16x16x32_bf16 a[80:83], a[232:235], v[192:195], a[80:83]
s_waitcnt lgkmcnt(4)
v_exp_f32 v230, v118
v_mfma_f32_16x16x32_bf16 a[96:99], a[240:243], v[192:195], a[96:99]
v_mfma_f32_16x16x32_bf16 a[96:99], a[244:247], v[208:211], a[96:99]
v_exp_f32 v231, v119
v_mfma_f32_16x16x32_bf16 a[100:103], a[244:247], v[212:215], a[100:103]
v_cvt_pk_bf16_f32 v155, v230, v231
v_mfma_f32_16x16x32_bf16 a[100:103], a[240:243], v[196:199], a[100:103]
v_exp_f32 v224, v120
v_mfma_f32_16x16x32_bf16 a[104:107], a[240:243], v[200:203], a[104:107]
ds_read_b128 a[224:227], v2 offset:57344
v_mfma_f32_16x16x32_bf16 a[104:107], a[244:247], v[216:219], a[104:107]
ds_read_b128 a[228:231], v3 offset:57344
v_mfma_f32_16x16x32_bf16 a[108:111], a[244:247], v[220:223], a[108:111]
v_exp_f32 v225, v121
v_mfma_f32_16x16x32_bf16 a[108:111], a[240:243], v[204:207], a[108:111]
s_waitcnt lgkmcnt(2)
buffer_load_dwordx4 v19, s[40:43], s76 offen offset:3072 nt lds
v_mfma_f32_16x16x32_bf16 a[124:127], a[248:251], v[204:207], a[124:127]
s_xor_b32 s76, s67, 147968
v_exp_f32 v226, v122
v_mfma_f32_16x16x32_bf16 a[124:127], a[252:255], v[220:223], a[124:127]
s_add_u32 m0, s69, 32768
ds_read_b128 a[232:235], v4 offset:57344
v_cvt_pk_bf16_f32 v156, v224, v225
v_mfma_f32_16x16x32_bf16 a[120:123], a[252:255], v[216:219], a[120:123]
v_exp_f32 v227, v123
v_mfma_f32_16x16x32_bf16 a[120:123], a[248:251], v[200:203], a[120:123]
ds_read_b128 a[236:239], v5 offset:57344
v_cvt_pk_bf16_f32 v157, v226, v227
v_mfma_f32_16x16x32_bf16 a[116:119], a[248:251], v[196:199], a[116:119]
v_exp_f32 v228, v124
v_mfma_f32_16x16x32_bf16 a[116:119], a[252:255], v[212:215], a[116:119]
v_mfma_f32_16x16x32_bf16 a[112:115], a[252:255], v[208:211], a[112:115]
v_exp_f32 v229, v125
v_mfma_f32_16x16x32_bf16 a[112:115], a[248:251], v[192:195], a[112:115]
v_cvt_pk_bf16_f32 v158, v228, v229
v_mfma_f32_16x16x32_bf16 a[136:139], a[144:147], v[200:203], a[136:139]
v_exp_f32 v230, v126
v_mfma_f32_16x16x32_bf16 a[136:139], a[144:147], v[216:219], a[136:139]
v_mfma_f32_16x16x32_bf16 a[140:143], a[144:147], v[204:207], a[140:143]
v_exp_f32 v231, v127
v_mfma_f32_16x16x32_bf16 a[140:143], a[144:147], v[220:223], a[140:143]
s_waitcnt lgkmcnt(0)
v_cvt_pk_bf16_f32 v159, v230, v231
v_mfma_f32_16x16x32_bf16 v[96:99], a[224:227], v[32:35], v[240:243]
v_exp_f32 v224, v160
v_mfma_f32_16x16x32_bf16 v[96:99], a[228:231], v[36:39], v[96:99]
ds_read_b128 a[240:243], v2 offset:61440
v_mfma_f32_16x16x32_bf16 v[96:99], a[232:235], v[40:43], v[96:99]
v_exp_f32 v225, v161
v_mfma_f32_16x16x32_bf16 v[96:99], a[236:239], v[44:47], v[96:99]
buffer_load_dwordx4 v14, s[36:39], s76 offen nt lds
v_mfma_f32_16x16x32_bf16 v[104:107], a[236:239], v[60:63], v[244:247]
v_exp_f32 v226, v162
v_mfma_f32_16x16x32_bf16 v[104:107], a[232:235], v[56:59], v[104:107]
ds_read_b128 a[244:247], v3 offset:61440
v_cvt_pk_bf16_f32 v192, v224, v225
v_mfma_f32_16x16x32_bf16 v[104:107], a[228:231], v[52:55], v[104:107]
v_exp_f32 v227, v163
v_mfma_f32_16x16x32_bf16 v[104:107], a[224:227], v[48:51], v[104:107]
ds_read_b128 a[248:251], v4 offset:61440
v_cvt_pk_bf16_f32 v193, v226, v227
v_mfma_f32_16x16x32_bf16 v[112:115], a[224:227], v[64:67], v[248:251]
v_exp_f32 v228, v164
v_mfma_f32_16x16x32_bf16 v[112:115], a[228:231], v[68:71], v[112:115]
ds_read_b128 a[252:255], v5 offset:61440
v_mfma_f32_16x16x32_bf16 v[112:115], a[232:235], v[72:75], v[112:115]
v_exp_f32 v229, v165
v_mfma_f32_16x16x32_bf16 v[112:115], a[236:239], v[76:79], v[112:115]
v_cvt_pk_bf16_f32 v194, v228, v229
v_mfma_f32_16x16x32_bf16 v[120:123], a[236:239], v[92:95], v[252:255]
v_exp_f32 v230, v166
v_mfma_f32_16x16x32_bf16 v[120:123], a[232:235], v[88:91], v[120:123]
v_mfma_f32_16x16x32_bf16 v[120:123], a[228:231], v[84:87], v[120:123]
v_exp_f32 v231, v167
v_mfma_f32_16x16x32_bf16 v[120:123], a[224:227], v[80:83], v[120:123]
s_waitcnt vmcnt(10) lgkmcnt(0)
s_barrier
ds_read_b64_tr_b16 a[224:225], v6 offset:49152
v_mfma_f32_16x16x32_bf16 v[124:127], a[240:243], v[80:83], v[252:255]
s_xor_b32 s76, s67, 147968
v_exp_f32 v224, v168
v_mfma_f32_16x16x32_bf16 v[124:127], a[244:247], v[84:87], v[124:127]
s_add_u32 m0, s69, 32768
ds_read_b64_tr_b16 a[226:227], v6 offset:53248
v_cvt_pk_bf16_f32 v195, v230, v231
v_mfma_f32_16x16x32_bf16 v[124:127], a[248:251], v[88:91], v[124:127]
v_exp_f32 v225, v169
v_mfma_f32_16x16x32_bf16 v[124:127], a[252:255], v[92:95], v[124:127]
ds_read_b64_tr_b16 a[228:229], v6 offset:57344
v_cvt_pk_bf16_f32 v196, v224, v225
v_mfma_f32_16x16x32_bf16 v[116:119], a[252:255], v[76:79], v[248:251]
ds_read_b64_tr_b16 a[230:231], v6 offset:61440
v_mfma_f32_16x16x32_bf16 v[116:119], a[248:251], v[72:75], v[116:119]
v_exp_f32 v226, v170
v_mfma_f32_16x16x32_bf16 v[116:119], a[244:247], v[68:71], v[116:119]
ds_read_b64_tr_b16 a[232:233], v7 offset:49152
v_mfma_f32_16x16x32_bf16 v[116:119], a[240:243], v[64:67], v[116:119]
v_exp_f32 v227, v171
v_mfma_f32_16x16x32_bf16 v[108:111], a[240:243], v[48:51], v[244:247]
buffer_load_dwordx4 v15, s[36:39], s76 offen offset:1024 nt lds
v_mfma_f32_16x16x32_bf16 v[108:111], a[244:247], v[52:55], v[108:111]
v_exp_f32 v228, v172
v_mfma_f32_16x16x32_bf16 v[108:111], a[248:251], v[56:59], v[108:111]
ds_read_b64_tr_b16 a[234:235], v7 offset:53248
v_cvt_pk_bf16_f32 v197, v226, v227
v_mfma_f32_16x16x32_bf16 v[108:111], a[252:255], v[60:63], v[108:111]
v_exp_f32 v229, v173
v_mfma_f32_16x16x32_bf16 v[100:103], a[252:255], v[44:47], v[240:243]
ds_read_b64_tr_b16 a[236:237], v7 offset:57344
v_cvt_pk_bf16_f32 v198, v228, v229
v_mfma_f32_16x16x32_bf16 v[100:103], a[248:251], v[40:43], v[100:103]
v_exp_f32 v230, v174
v_mfma_f32_16x16x32_bf16 v[100:103], a[244:247], v[36:39], v[100:103]
ds_read_b64_tr_b16 a[238:239], v7 offset:61440
v_mfma_f32_16x16x32_bf16 v[100:103], a[240:243], v[32:35], v[100:103]
s_waitcnt lgkmcnt(4)
ds_read_b64_tr_b16 a[240:241], v8 offset:49152
v_mfma_f32_16x16x32_bf16 a[0:3], a[224:227], v[128:131], a[0:3]
v_exp_f32 v231, v175
v_mfma_f32_16x16x32_bf16 a[0:3], a[228:231], v[144:147], a[0:3]
ds_read_b64_tr_b16 a[242:243], v8 offset:53248
v_cvt_pk_bf16_f32 v199, v230, v231
v_mfma_f32_16x16x32_bf16 a[4:7], a[228:231], v[148:151], a[4:7]
v_exp_f32 v224, v176
v_mfma_f32_16x16x32_bf16 a[4:7], a[224:227], v[132:135], a[4:7]
ds_read_b64_tr_b16 a[244:245], v8 offset:57344
v_mfma_f32_16x16x32_bf16 a[8:11], a[224:227], v[136:139], a[8:11]
v_exp_f32 v225, v177
v_mfma_f32_16x16x32_bf16 a[8:11], a[228:231], v[152:155], a[8:11]
ds_read_b64_tr_b16 a[246:247], v8 offset:61440
v_cvt_pk_bf16_f32 v200, v224, v225
v_mfma_f32_16x16x32_bf16 a[12:15], a[228:231], v[156:159], a[12:15]
v_exp_f32 v226, v178
v_mfma_f32_16x16x32_bf16 a[12:15], a[224:227], v[140:143], a[12:15]
s_waitcnt lgkmcnt(4)
buffer_load_dwordx4 v16, s[36:39], s76 offen offset:2048 nt lds
v_mfma_f32_16x16x32_bf16 a[28:31], a[232:235], v[140:143], a[28:31]
v_exp_f32 v227, v179
v_mfma_f32_16x16x32_bf16 a[28:31], a[236:239], v[156:159], a[28:31]
ds_read_b64_tr_b16 a[248:249], v9 offset:49152
v_cvt_pk_bf16_f32 v201, v226, v227
v_mfma_f32_16x16x32_bf16 a[24:27], a[236:239], v[152:155], a[24:27]
ds_read_b64_tr_b16 a[250:251], v9 offset:53248
v_mfma_f32_16x16x32_bf16 a[24:27], a[232:235], v[136:139], a[24:27]
v_exp_f32 v228, v180
v_mfma_f32_16x16x32_bf16 a[20:23], a[232:235], v[132:135], a[20:23]
ds_read_b64_tr_b16 a[252:253], v9 offset:57344
v_mfma_f32_16x16x32_bf16 a[20:23], a[236:239], v[148:151], a[20:23]
v_exp_f32 v229, v181
v_mfma_f32_16x16x32_bf16 a[16:19], a[236:239], v[144:147], a[16:19]
ds_read_b64_tr_b16 a[254:255], v9 offset:61440
v_cvt_pk_bf16_f32 v202, v228, v229
v_mfma_f32_16x16x32_bf16 a[16:19], a[232:235], v[128:131], a[16:19]
s_waitcnt lgkmcnt(4)
v_exp_f32 v230, v182
v_mfma_f32_16x16x32_bf16 a[32:35], a[240:243], v[128:131], a[32:35]
v_mfma_f32_16x16x32_bf16 a[32:35], a[244:247], v[144:147], a[32:35]
v_exp_f32 v231, v183
v_mfma_f32_16x16x32_bf16 a[36:39], a[244:247], v[148:151], a[36:39]
v_cvt_pk_bf16_f32 v203, v230, v231
v_mfma_f32_16x16x32_bf16 a[36:39], a[240:243], v[132:135], a[36:39]
v_exp_f32 v224, v184
v_mfma_f32_16x16x32_bf16 a[40:43], a[240:243], v[136:139], a[40:43]
buffer_load_dwordx4 v17, s[36:39], s76 offen offset:3072 nt lds
v_mfma_f32_16x16x32_bf16 a[40:43], a[244:247], v[152:155], a[40:43]
s_xor_b32 s76, s67, 131584
ds_read_b128 a[224:227], v2 offset:0
v_mfma_f32_16x16x32_bf16 a[44:47], a[244:247], v[156:159], a[44:47]
s_add_u32 m0, s69, 65536
v_exp_f32 v225, v185
v_mfma_f32_16x16x32_bf16 a[44:47], a[240:243], v[140:143], a[44:47]
s_waitcnt lgkmcnt(1)
ds_read_b128 a[228:231], v3 offset:0
v_cvt_pk_bf16_f32 v204, v224, v225
v_mfma_f32_16x16x32_bf16 a[60:63], a[248:251], v[140:143], a[60:63]
v_exp_f32 v226, v186
v_mfma_f32_16x16x32_bf16 a[60:63], a[252:255], v[156:159], a[60:63]
ds_read_b128 a[232:235], v4 offset:0
v_mfma_f32_16x16x32_bf16 a[56:59], a[252:255], v[152:155], a[56:59]
v_exp_f32 v227, v187
v_mfma_f32_16x16x32_bf16 a[56:59], a[248:251], v[136:139], a[56:59]
ds_read_b128 a[236:239], v5 offset:0
v_cvt_pk_bf16_f32 v205, v226, v227
v_mfma_f32_16x16x32_bf16 a[52:55], a[248:251], v[132:135], a[52:55]
v_exp_f32 v228, v188
v_mfma_f32_16x16x32_bf16 a[52:55], a[252:255], v[148:151], a[52:55]
v_mfma_f32_16x16x32_bf16 a[48:51], a[252:255], v[144:147], a[48:51]
v_exp_f32 v229, v189
v_mfma_f32_16x16x32_bf16 a[48:51], a[248:251], v[128:131], a[48:51]
v_cvt_pk_bf16_f32 v206, v228, v229
v_mfma_f32_16x16x32_bf16 a[128:131], a[144:147], v[128:131], a[128:131]
v_exp_f32 v230, v190
v_mfma_f32_16x16x32_bf16 a[128:131], a[144:147], v[144:147], a[128:131]
v_mfma_f32_16x16x32_bf16 a[132:135], a[144:147], v[132:135], a[132:135]
v_exp_f32 v231, v191
v_mfma_f32_16x16x32_bf16 a[132:135], a[144:147], v[148:151], a[132:135]
s_waitcnt lgkmcnt(0)
buffer_load_dwordx4 v18, s[40:43], s76 offen nt lds
v_mfma_f32_16x16x32_bf16 v[160:163], a[224:227], v[32:35], v[240:243]
v_exp_f32 v224, v96
v_mfma_f32_16x16x32_bf16 v[160:163], a[228:231], v[36:39], v[160:163]
ds_read_b128 a[240:243], v2 offset:4096
v_cvt_pk_bf16_f32 v207, v230, v231
v_mfma_f32_16x16x32_bf16 v[160:163], a[232:235], v[40:43], v[160:163]
v_exp_f32 v225, v97
v_mfma_f32_16x16x32_bf16 v[160:163], a[236:239], v[44:47], v[160:163]
ds_read_b128 a[244:247], v3 offset:4096
v_cvt_pk_bf16_f32 v208, v224, v225
v_mfma_f32_16x16x32_bf16 v[168:171], a[236:239], v[60:63], v[244:247]
v_exp_f32 v226, v98
v_mfma_f32_16x16x32_bf16 v[168:171], a[232:235], v[56:59], v[168:171]
ds_read_b128 a[248:251], v4 offset:4096
v_mfma_f32_16x16x32_bf16 v[168:171], a[228:231], v[52:55], v[168:171]
v_exp_f32 v227, v99
v_mfma_f32_16x16x32_bf16 v[168:171], a[224:227], v[48:51], v[168:171]
ds_read_b128 a[252:255], v5 offset:4096
v_cvt_pk_bf16_f32 v209, v226, v227
v_mfma_f32_16x16x32_bf16 v[176:179], a[224:227], v[64:67], v[248:251]
v_exp_f32 v228, v100
v_mfma_f32_16x16x32_bf16 v[176:179], a[228:231], v[68:71], v[176:179]
v_mfma_f32_16x16x32_bf16 v[176:179], a[232:235], v[72:75], v[176:179]
v_exp_f32 v229, v101
v_mfma_f32_16x16x32_bf16 v[176:179], a[236:239], v[76:79], v[176:179]
v_cvt_pk_bf16_f32 v210, v228, v229
v_mfma_f32_16x16x32_bf16 v[184:187], a[236:239], v[92:95], v[252:255]
v_exp_f32 v230, v102
L_hop2_0:
s_cbranch_execz L_hop_ret2
v_mfma_f32_16x16x32_bf16 v[184:187], a[232:235], v[88:91], v[184:187]
v_mfma_f32_16x16x32_bf16 v[184:187], a[228:231], v[84:87], v[184:187]
v_exp_f32 v231, v103
v_mfma_f32_16x16x32_bf16 v[184:187], a[224:227], v[80:83], v[184:187]
s_waitcnt lgkmcnt(0)
buffer_load_dwordx4 v19, s[40:43], s76 offen offset:1024 nt lds
v_mfma_f32_16x16x32_bf16 v[188:191], a[240:243], v[80:83], v[252:255]
v_exp_f32 v224, v104
v_mfma_f32_16x16x32_bf16 v[188:191], a[244:247], v[84:87], v[188:191]
ds_read_b64_tr_b16 a[224:225], v10 offset:49152
v_cvt_pk_bf16_f32 v211, v230, v231
v_mfma_f32_16x16x32_bf16 v[188:191], a[248:251], v[88:91], v[188:191]
v_exp_f32 v225, v105
v_mfma_f32_16x16x32_bf16 v[188:191], a[252:255], v[92:95], v[188:191]
ds_read_b64_tr_b16 a[226:227], v10 offset:53248
v_cvt_pk_bf16_f32 v212, v224, v225
v_mfma_f32_16x16x32_bf16 v[180:183], a[252:255], v[76:79], v[248:251]
ds_read_b64_tr_b16 a[228:229], v10 offset:57344
v_mfma_f32_16x16x32_bf16 v[180:183], a[248:251], v[72:75], v[180:183]
v_exp_f32 v226, v106
v_mfma_f32_16x16x32_bf16 v[180:183], a[244:247], v[68:71], v[180:183]
ds_read_b64_tr_b16 a[230:231], v10 offset:61440
v_mfma_f32_16x16x32_bf16 v[180:183], a[240:243], v[64:67], v[180:183]
v_exp_f32 v227, v107
v_mfma_f32_16x16x32_bf16 v[172:175], a[240:243], v[48:51], v[244:247]
ds_read_b64_tr_b16 a[232:233], v11 offset:49152
v_cvt_pk_bf16_f32 v213, v226, v227
v_mfma_f32_16x16x32_bf16 v[172:175], a[244:247], v[52:55], v[172:175]
v_exp_f32 v228, v108
v_mfma_f32_16x16x32_bf16 v[172:175], a[248:251], v[56:59], v[172:175]
ds_read_b64_tr_b16 a[234:235], v11 offset:53248
v_mfma_f32_16x16x32_bf16 v[172:175], a[252:255], v[60:63], v[172:175]
v_exp_f32 v229, v109
v_mfma_f32_16x16x32_bf16 v[164:167], a[252:255], v[44:47], v[240:243]
buffer_load_dwordx4 v18, s[40:43], s76 offen offset:2048 nt lds
v_mfma_f32_16x16x32_bf16 v[164:167], a[248:251], v[40:43], v[164:167]
v_exp_f32 v230, v110
v_mfma_f32_16x16x32_bf16 v[164:167], a[244:247], v[36:39], v[164:167]
ds_read_b64_tr_b16 a[236:237], v11 offset:57344
v_cvt_pk_bf16_f32 v214, v228, v229
v_mfma_f32_16x16x32_bf16 v[164:167], a[240:243], v[32:35], v[164:167]
s_waitcnt lgkmcnt(3)
ds_read_b64_tr_b16 a[238:239], v11 offset:61440
v_mfma_f32_16x16x32_bf16 a[64:67], a[224:227], v[128:131], a[64:67]
v_exp_f32 v231, v111
v_mfma_f32_16x16x32_bf16 a[64:67], a[228:231], v[144:147], a[64:67]
ds_read_b64_tr_b16 a[240:241], v12 offset:49152
v_cvt_pk_bf16_f32 v215, v230, v231
v_mfma_f32_16x16x32_bf16 a[68:71], a[228:231], v[148:151], a[68:71]
v_exp_f32 v224, v112
v_mfma_f32_16x16x32_bf16 a[68:71], a[224:227], v[132:135], a[68:71]
ds_read_b64_tr_b16 a[242:243], v12 offset:53248
v_mfma_f32_16x16x32_bf16 a[72:75], a[224:227], v[136:139], a[72:75]
v_exp_f32 v225, v113
v_mfma_f32_16x16x32_bf16 a[72:75], a[228:231], v[152:155], a[72:75]
ds_read_b64_tr_b16 a[244:245], v12 offset:57344
v_cvt_pk_bf16_f32 v216, v224, v225
v_mfma_f32_16x16x32_bf16 a[76:79], a[228:231], v[156:159], a[76:79]
v_exp_f32 v226, v114
v_mfma_f32_16x16x32_bf16 a[76:79], a[224:227], v[140:143], a[76:79]
s_waitcnt lgkmcnt(3)
ds_read_b64_tr_b16 a[246:247], v12 offset:61440
v_mfma_f32_16x16x32_bf16 a[92:95], a[232:235], v[140:143], a[92:95]
v_exp_f32 v227, v115
v_mfma_f32_16x16x32_bf16 a[92:95], a[236:239], v[156:159], a[92:95]
ds_read_b64_tr_b16 a[248:249], v13 offset:49152
v_cvt_pk_bf16_f32 v217, v226, v227
v_mfma_f32_16x16x32_bf16 a[88:91], a[236:239], v[152:155], a[88:91]
ds_read_b64_tr_b16 a[250:251], v13 offset:53248
v_mfma_f32_16x16x32_bf16 a[88:91], a[232:235], v[136:139], a[88:91]
v_exp_f32 v228, v116
v_mfma_f32_16x16x32_bf16 a[84:87], a[232:235], v[132:135], a[84:87]
buffer_load_dwordx4 v19, s[40:43], s76 offen offset:3072 nt lds
v_mfma_f32_16x16x32_bf16 a[84:87], a[236:239], v[148:151], a[84:87]
v_exp_f32 v229, v117
v_mfma_f32_16x16x32_bf16 a[80:83], a[236:239], v[144:147], a[80:83]
ds_read_b64_tr_b16 a[252:253], v13 offset:57344
v_cvt_pk_bf16_f32 v218, v228, v229
v_mfma_f32_16x16x32_bf16 a[80:83], a[232:235], v[128:131], a[80:83]
s_waitcnt lgkmcnt(3)
v_exp_f32 v230, v118
v_mfma_f32_16x16x32_bf16 a[96:99], a[240:243], v[128:131], a[96:99]
ds_read_b64_tr_b16 a[254:255], v13 offset:61440
v_mfma_f32_16x16x32_bf16 a[96:99], a[244:247], v[144:147], a[96:99]
v_exp_f32 v231, v119
v_mfma_f32_16x16x32_bf16 a[100:103], a[244:247], v[148:151], a[100:103]
v_cvt_pk_bf16_f32 v219, v230, v231
v_mfma_f32_16x16x32_bf16 a[100:103], a[240:243], v[132:135], a[100:103]
v_exp_f32 v224, v120
v_mfma_f32_16x16x32_bf16 a[104:107], a[240:243], v[136:139], a[104:107]
ds_read_b128 a[224:227], v2 offset:8192
v_mfma_f32_16x16x32_bf16 a[104:107], a[244:247], v[152:155], a[104:107]
ds_read_b128 a[228:231], v3 offset:8192
v_mfma_f32_16x16x32_bf16 a[108:111], a[244:247], v[156:159], a[108:111]
v_exp_f32 v225, v121
v_mfma_f32_16x16x32_bf16 a[108:111], a[240:243], v[140:143], a[108:111]
s_waitcnt lgkmcnt(2)
ds_read_b128 a[232:235], v4 offset:8192
v_cvt_pk_bf16_f32 v220, v224, v225
v_mfma_f32_16x16x32_bf16 a[124:127], a[248:251], v[140:143], a[124:127]
v_exp_f32 v226, v122
v_mfma_f32_16x16x32_bf16 a[124:127], a[252:255], v[156:159], a[124:127]
ds_read_b128 a[236:239], v5 offset:8192
v_mfma_f32_16x16x32_bf16 a[120:123], a[252:255], v[152:155], a[120:123]
v_exp_f32 v227, v123
v_mfma_f32_16x16x32_bf16 a[120:123], a[248:251], v[136:139], a[120:123]
buffer_load_dword v239, v234, s[12:15], 0 offen sc1
v_mfma_f32_16x16x32_bf16 a[116:119], a[248:251], v[132:135], a[116:119]
s_xor_b32 s76, s67, 213504
v_exp_f32 v228, v124
v_mfma_f32_16x16x32_bf16 a[116:119], a[252:255], v[148:151], a[116:119]
s_add_u32 m0, s69, 49152
v_cvt_pk_bf16_f32 v221, v226, v227
v_mfma_f32_16x16x32_bf16 a[112:115], a[252:255], v[144:147], a[112:115]
v_exp_f32 v229, v125
v_mfma_f32_16x16x32_bf16 a[112:115], a[248:251], v[128:131], a[112:115]
v_cvt_pk_bf16_f32 v222, v228, v229
v_mfma_f32_16x16x32_bf16 a[136:139], a[144:147], v[136:139], a[136:139]
v_exp_f32 v230, v126
v_mfma_f32_16x16x32_bf16 a[136:139], a[144:147], v[152:155], a[136:139]
v_mfma_f32_16x16x32_bf16 a[140:143], a[144:147], v[140:143], a[140:143]
v_exp_f32 v231, v127
v_mfma_f32_16x16x32_bf16 a[140:143], a[144:147], v[156:159], a[140:143]
s_waitcnt lgkmcnt(0)
v_cvt_pk_bf16_f32 v223, v230, v231
v_mfma_f32_16x16x32_bf16 v[96:99], a[224:227], v[32:35], v[240:243]
v_exp_f32 v224, v160
v_mfma_f32_16x16x32_bf16 v[96:99], a[228:231], v[36:39], v[96:99]
ds_read_b128 a[240:243], v2 offset:12288
v_mfma_f32_16x16x32_bf16 v[96:99], a[232:235], v[40:43], v[96:99]
v_exp_f32 v225, v161
v_mfma_f32_16x16x32_bf16 v[96:99], a[236:239], v[44:47], v[96:99]
ds_read_b128 a[244:247], v3 offset:12288
v_cvt_pk_bf16_f32 v128, v224, v225
v_mfma_f32_16x16x32_bf16 v[104:107], a[236:239], v[60:63], v[244:247]
v_exp_f32 v226, v162
v_mfma_f32_16x16x32_bf16 v[104:107], a[232:235], v[56:59], v[104:107]
buffer_load_dwordx4 v14, s[36:39], s76 offen nt lds
v_mfma_f32_16x16x32_bf16 v[104:107], a[228:231], v[52:55], v[104:107]
v_exp_f32 v227, v163
v_mfma_f32_16x16x32_bf16 v[104:107], a[224:227], v[48:51], v[104:107]
ds_read_b128 a[248:251], v4 offset:12288
v_cvt_pk_bf16_f32 v129, v226, v227
v_mfma_f32_16x16x32_bf16 v[112:115], a[224:227], v[64:67], v[248:251]
v_exp_f32 v228, v164
v_mfma_f32_16x16x32_bf16 v[112:115], a[228:231], v[68:71], v[112:115]
ds_read_b128 a[252:255], v5 offset:12288
v_mfma_f32_16x16x32_bf16 v[112:115], a[232:235], v[72:75], v[112:115]
v_exp_f32 v229, v165
v_mfma_f32_16x16x32_bf16 v[112:115], a[236:239], v[76:79], v[112:115]
v_cvt_pk_bf16_f32 v130, v228, v229
v_mfma_f32_16x16x32_bf16 v[120:123], a[236:239], v[92:95], v[252:255]
v_exp_f32 v230, v166
v_mfma_f32_16x16x32_bf16 v[120:123], a[232:235], v[88:91], v[120:123]
v_mfma_f32_16x16x32_bf16 v[120:123], a[228:231], v[84:87], v[120:123]
v_exp_f32 v231, v167
v_mfma_f32_16x16x32_bf16 v[120:123], a[224:227], v[80:83], v[120:123]
s_waitcnt vmcnt(10) lgkmcnt(0)
s_barrier
ds_read_b64_tr_b16 a[224:225], v6 offset:16384
v_mfma_f32_16x16x32_bf16 v[124:127], a[240:243], v[80:83], v[252:255]
s_xor_b32 s76, s67, 213504
v_exp_f32 v224, v168
v_mfma_f32_16x16x32_bf16 v[124:127], a[244:247], v[84:87], v[124:127]
s_add_u32 m0, s69, 49152
ds_read_b64_tr_b16 a[226:227], v6 offset:20480
v_cvt_pk_bf16_f32 v131, v230, v231
v_mfma_f32_16x16x32_bf16 v[124:127], a[248:251], v[88:91], v[124:127]
v_exp_f32 v225, v169
v_mfma_f32_16x16x32_bf16 v[124:127], a[252:255], v[92:95], v[124:127]
ds_read_b64_tr_b16 a[228:229], v6 offset:24576
v_cvt_pk_bf16_f32 v132, v224, v225
v_mfma_f32_16x16x32_bf16 v[116:119], a[252:255], v[76:79], v[248:251]
ds_read_b64_tr_b16 a[230:231], v6 offset:28672
v_mfma_f32_16x16x32_bf16 v[116:119], a[248:251], v[72:75], v[116:119]
v_exp_f32 v226, v170
v_mfma_f32_16x16x32_bf16 v[116:119], a[244:247], v[68:71], v[116:119]
ds_read_b64_tr_b16 a[232:233], v7 offset:16384
v_mfma_f32_16x16x32_bf16 v[116:119], a[240:243], v[64:67], v[116:119]
v_exp_f32 v227, v171
v_mfma_f32_16x16x32_bf16 v[108:111], a[240:243], v[48:51], v[244:247]
buffer_load_dwordx4 v15, s[36:39], s76 offen offset:1024 nt lds
v_mfma_f32_16x16x32_bf16 v[108:111], a[244:247], v[52:55], v[108:111]
v_exp_f32 v228, v172
v_mfma_f32_16x16x32_bf16 v[108:111], a[248:251], v[56:59], v[108:111]
ds_read_b64_tr_b16 a[234:235], v7 offset:20480
v_cvt_pk_bf16_f32 v133, v226, v227
v_mfma_f32_16x16x32_bf16 v[108:111], a[252:255], v[60:63], v[108:111]
v_exp_f32 v229, v173
v_mfma_f32_16x16x32_bf16 v[100:103], a[252:255], v[44:47], v[240:243]
ds_read_b64_tr_b16 a[236:237], v7 offset:24576
v_cvt_pk_bf16_f32 v134, v228, v229
v_mfma_f32_16x16x32_bf16 v[100:103], a[248:251], v[40:43], v[100:103]
v_exp_f32 v230, v174
v_mfma_f32_16x16x32_bf16 v[100:103], a[244:247], v[36:39], v[100:103]
ds_read_b64_tr_b16 a[238:239], v7 offset:28672
v_mfma_f32_16x16x32_bf16 v[100:103], a[240:243], v[32:35], v[100:103]
s_waitcnt lgkmcnt(4)
ds_read_b64_tr_b16 a[240:241], v8 offset:16384
v_mfma_f32_16x16x32_bf16 a[0:3], a[224:227], v[192:195], a[0:3]
v_exp_f32 v231, v175
v_mfma_f32_16x16x32_bf16 a[0:3], a[228:231], v[208:211], a[0:3]
ds_read_b64_tr_b16 a[242:243], v8 offset:20480
v_cvt_pk_bf16_f32 v135, v230, v231
v_mfma_f32_16x16x32_bf16 a[4:7], a[228:231], v[212:215], a[4:7]
v_exp_f32 v224, v176
v_mfma_f32_16x16x32_bf16 a[4:7], a[224:227], v[196:199], a[4:7]
ds_read_b64_tr_b16 a[244:245], v8 offset:24576
v_mfma_f32_16x16x32_bf16 a[8:11], a[224:227], v[200:203], a[8:11]
v_exp_f32 v225, v177
v_mfma_f32_16x16x32_bf16 a[8:11], a[228:231], v[216:219], a[8:11]
ds_read_b64_tr_b16 a[246:247], v8 offset:28672
v_cvt_pk_bf16_f32 v136, v224, v225
v_mfma_f32_16x16x32_bf16 a[12:15], a[228:231], v[220:223], a[12:15]
v_exp_f32 v226, v178
v_mfma_f32_16x16x32_bf16 a[12:15], a[224:227], v[204:207], a[12:15]
s_waitcnt lgkmcnt(4)
ds_read_b64_tr_b16 a[248:249], v9 offset:16384
v_mfma_f32_16x16x32_bf16 a[28:31], a[232:235], v[204:207], a[28:31]
v_exp_f32 v227, v179
v_mfma_f32_16x16x32_bf16 a[28:31], a[236:239], v[220:223], a[28:31]
buffer_load_dwordx4 v16, s[36:39], s76 offen offset:2048 nt lds
v_mfma_f32_16x16x32_bf16 a[24:27], a[236:239], v[216:219], a[24:27]
ds_read_b64_tr_b16 a[250:251], v9 offset:20480
v_cvt_pk_bf16_f32 v137, v226, v227
v_mfma_f32_16x16x32_bf16 a[24:27], a[232:235], v[200:203], a[24:27]
v_exp_f32 v228, v180
v_mfma_f32_16x16x32_bf16 a[20:23], a[232:235], v[196:199], a[20:23]
ds_read_b64_tr_b16 a[252:253], v9 offset:24576
v_mfma_f32_16x16x32_bf16 a[20:23], a[236:239], v[212:215], a[20:23]
v_exp_f32 v229, v181
v_mfma_f32_16x16x32_bf16 a[16:19], a[236:239], v[208:211], a[16:19]
ds_read_b64_tr_b16 a[254:255], v9 offset:28672
v_cvt_pk_bf16_f32 v138, v228, v229
v_mfma_f32_16x16x32_bf16 a[16:19], a[232:235], v[192:195], a[16:19]
s_waitcnt lgkmcnt(4)
v_exp_f32 v230, v182
v_mfma_f32_16x16x32_bf16 a[32:35], a[240:243], v[192:195], a[32:35]
v_mfma_f32_16x16x32_bf16 a[32:35], a[244:247], v[208:211], a[32:35]
v_exp_f32 v231, v183
v_mfma_f32_16x16x32_bf16 a[36:39], a[244:247], v[212:215], a[36:39]
v_cvt_pk_bf16_f32 v139, v230, v231
v_mfma_f32_16x16x32_bf16 a[36:39], a[240:243], v[196:199], a[36:39]
v_exp_f32 v224, v184
v_mfma_f32_16x16x32_bf16 a[40:43], a[240:243], v[200:203], a[40:43]
ds_read_b128 a[224:227], v2 offset:16384
v_mfma_f32_16x16x32_bf16 a[40:43], a[244:247], v[216:219], a[40:43]
ds_read_b128 a[228:231], v3 offset:16384
v_mfma_f32_16x16x32_bf16 a[44:47], a[244:247], v[220:223], a[44:47]
v_exp_f32 v225, v185
v_mfma_f32_16x16x32_bf16 a[44:47], a[240:243], v[204:207], a[44:47]
s_waitcnt lgkmcnt(2)
ds_read_b128 a[232:235], v4 offset:16384
v_cvt_pk_bf16_f32 v140, v224, v225
v_mfma_f32_16x16x32_bf16 a[60:63], a[248:251], v[204:207], a[60:63]
v_exp_f32 v226, v186
v_mfma_f32_16x16x32_bf16 a[60:63], a[252:255], v[220:223], a[60:63]
buffer_load_dwordx4 v17, s[36:39], s76 offen offset:3072 nt lds
v_mfma_f32_16x16x32_bf16 a[56:59], a[252:255], v[216:219], a[56:59]
s_xor_b32 s76, s67, 197120
v_exp_f32 v227, v187
v_mfma_f32_16x16x32_bf16 a[56:59], a[248:251], v[200:203], a[56:59]
s_add_u32 m0, s69, 98304
ds_read_b128 a[236:239], v5 offset:16384
v_cvt_pk_bf16_f32 v141, v226, v227
v_mfma_f32_16x16x32_bf16 a[52:55], a[248:251], v[196:199], a[52:55]
v_exp_f32 v228, v188
v_mfma_f32_16x16x32_bf16 a[52:55], a[252:255], v[212:215], a[52:55]
v_mfma_f32_16x16x32_bf16 a[48:51], a[252:255], v[208:211], a[48:51]
v_exp_f32 v229, v189
v_mfma_f32_16x16x32_bf16 a[48:51], a[248:251], v[192:195], a[48:51]
v_cvt_pk_bf16_f32 v142, v228, v229
v_mfma_f32_16x16x32_bf16 a[128:131], a[144:147], v[192:195], a[128:131]
v_exp_f32 v230, v190
v_mfma_f32_16x16x32_bf16 a[128:131], a[144:147], v[208:211], a[128:131]
v_mfma_f32_16x16x32_bf16 a[132:135], a[144:147], v[196:199], a[132:135]
v_exp_f32 v231, v191
v_mfma_f32_16x16x32_bf16 a[132:135], a[144:147], v[212:215], a[132:135]
s_waitcnt lgkmcnt(0)
v_cvt_pk_bf16_f32 v143, v230, v231
v_mfma_f32_16x16x32_bf16 v[160:163], a[224:227], v[32:35], v[240:243]
v_exp_f32 v224, v96
v_mfma_f32_16x16x32_bf16 v[160:163], a[228:231], v[36:39], v[160:163]
ds_read_b128 a[240:243], v2 offset:20480
v_mfma_f32_16x16x32_bf16 v[160:163], a[232:235], v[40:43], v[160:163]
v_exp_f32 v225, v97
v_mfma_f32_16x16x32_bf16 v[160:163], a[236:239], v[44:47], v[160:163]
ds_read_b128 a[244:247], v3 offset:20480
v_cvt_pk_bf16_f32 v144, v224, v225
v_mfma_f32_16x16x32_bf16 v[168:171], a[236:239], v[60:63], v[244:247]
v_exp_f32 v226, v98
v_mfma_f32_16x16x32_bf16 v[168:171], a[232:235], v[56:59], v[168:171]
buffer_load_dwordx4 v18, s[40:43], s76 offen nt lds
v_mfma_f32_16x16x32_bf16 v[168:171], a[228:231], v[52:55], v[168:171]
v_exp_f32 v227, v99
v_mfma_f32_16x16x32_bf16 v[168:171], a[224:227], v[48:51], v[168:171]
ds_read_b128 a[248:251], v4 offset:20480
v_cvt_pk_bf16_f32 v145, v226, v227
v_mfma_f32_16x16x32_bf16 v[176:179], a[224:227], v[64:67], v[248:251]
v_exp_f32 v228, v100
v_mfma_f32_16x16x32_bf16 v[176:179], a[228:231], v[68:71], v[176:179]
ds_read_b128 a[252:255], v5 offset:20480
v_mfma_f32_16x16x32_bf16 v[176:179], a[232:235], v[72:75], v[176:179]
v_exp_f32 v229, v101
v_mfma_f32_16x16x32_bf16 v[176:179], a[236:239], v[76:79], v[176:179]
v_cvt_pk_bf16_f32 v146, v228, v229
v_mfma_f32_16x16x32_bf16 v[184:187], a[236:239], v[92:95], v[252:255]
v_exp_f32 v230, v102
v_mfma_f32_16x16x32_bf16 v[184:187], a[232:235], v[88:91], v[184:187]
v_mfma_f32_16x16x32_bf16 v[184:187], a[228:231], v[84:87], v[184:187]
v_exp_f32 v231, v103
v_mfma_f32_16x16x32_bf16 v[184:187], a[224:227], v[80:83], v[184:187]
s_waitcnt lgkmcnt(0)
ds_read_b64_tr_b16 a[224:225], v10 offset:16384
v_cvt_pk_bf16_f32 v147, v230, v231
v_mfma_f32_16x16x32_bf16 v[188:191], a[240:243], v[80:83], v[252:255]
v_exp_f32 v224, v104
v_mfma_f32_16x16x32_bf16 v[188:191], a[244:247], v[84:87], v[188:191]
ds_read_b64_tr_b16 a[226:227], v10 offset:20480
v_mfma_f32_16x16x32_bf16 v[188:191], a[248:251], v[88:91], v[188:191]
v_exp_f32 v225, v105
v_mfma_f32_16x16x32_bf16 v[188:191], a[252:255], v[92:95], v[188:191]
ds_read_b64_tr_b16 a[228:229], v10 offset:24576
v_cvt_pk_bf16_f32 v148, v224, v225
v_mfma_f32_16x16x32_bf16 v[180:183], a[252:255], v[76:79], v[248:251]
ds_read_b64_tr_b16 a[230:231], v10 offset:28672
v_mfma_f32_16x16x32_bf16 v[180:183], a[248:251], v[72:75], v[180:183]
v_exp_f32 v226, v106
v_mfma_f32_16x16x32_bf16 v[180:183], a[244:247], v[68:71], v[180:183]
buffer_load_dwordx4 v19, s[40:43], s76 offen offset:1024 nt lds
v_mfma_f32_16x16x32_bf16 v[180:183], a[240:243], v[64:67], v[180:183]
v_exp_f32 v227, v107
v_mfma_f32_16x16x32_bf16 v[172:175], a[240:243], v[48:51], v[244:247]
ds_read_b64_tr_b16 a[232:233], v11 offset:16384
v_cvt_pk_bf16_f32 v149, v226, v227
v_mfma_f32_16x16x32_bf16 v[172:175], a[244:247], v[52:55], v[172:175]
v_exp_f32 v228, v108
v_mfma_f32_16x16x32_bf16 v[172:175], a[248:251], v[56:59], v[172:175]
ds_read_b64_tr_b16 a[234:235], v11 offset:20480
v_mfma_f32_16x16x32_bf16 v[172:175], a[252:255], v[60:63], v[172:175]
v_exp_f32 v229, v109
v_mfma_f32_16x16x32_bf16 v[164:167], a[252:255], v[44:47], v[240:243]
ds_read_b64_tr_b16 a[236:237], v11 offset:24576
v_cvt_pk_bf16_f32 v150, v228, v229
v_mfma_f32_16x16x32_bf16 v[164:167], a[248:251], v[40:43], v[164:167]
v_exp_f32 v230, v110
v_mfma_f32_16x16x32_bf16 v[164:167], a[244:247], v[36:39], v[164:167]
ds_read_b64_tr_b16 a[238:239], v11 offset:28672
v_mfma_f32_16x16x32_bf16 v[164:167], a[240:243], v[32:35], v[164:167]
s_waitcnt lgkmcnt(4)
ds_read_b64_tr_b16 a[240:241], v12 offset:16384
v_mfma_f32_16x16x32_bf16 a[64:67], a[224:227], v[192:195], a[64:67]
v_exp_f32 v231, v111
v_mfma_f32_16x16x32_bf16 a[64:67], a[228:231], v[208:211], a[64:67]
ds_read_b64_tr_b16 a[242:243], v12 offset:20480
v_cvt_pk_bf16_f32 v151, v230, v231
v_mfma_f32_16x16x32_bf16 a[68:71], a[228:231], v[212:215], a[68:71]
v_exp_f32 v224, v112
v_mfma_f32_16x16x32_bf16 a[68:71], a[224:227], v[196:199], a[68:71]
ds_read_b64_tr_b16 a[244:245], v12 offset:24576
v_mfma_f32_16x16x32_bf16 a[72:75], a[224:227], v[200:203], a[72:75]
v_exp_f32 v225, v113
v_mfma_f32_16x16x32_bf16 a[72:75], a[228:231], v[216:219], a[72:75]
ds_read_b64_tr_b16 a[246:247], v12 offset:28672
v_cvt_pk_bf16_f32 v152, v224, v225
v_mfma_f32_16x16x32_bf16 a[76:79], a[228:231], v[220:223], a[76:79]
v_exp_f32 v226, v114
v_mfma_f32_16x16x32_bf16 a[76:79], a[224:227], v[204:207], a[76:79]
s_waitcnt lgkmcnt(4)
buffer_load_dwordx4 v18, s[40:43], s76 offen offset:2048 nt lds
v_mfma_f32_16x16x32_bf16 a[92:95], a[232:235], v[204:207], a[92:95]
v_exp_f32 v227, v115
v_mfma_f32_16x16x32_bf16 a[92:95], a[236:239], v[220:223], a[92:95]
ds_read_b64_tr_b16 a[248:249], v13 offset:16384
v_cvt_pk_bf16_f32 v153, v226, v227
v_mfma_f32_16x16x32_bf16 a[88:91], a[236:239], v[216:219], a[88:91]
ds_read_b64_tr_b16 a[250:251], v13 offset:20480
v_mfma_f32_16x16x32_bf16 a[88:91], a[232:235], v[200:203], a[88:91]
v_exp_f32 v228, v116
v_mfma_f32_16x16x32_bf16 a[84:87], a[232:235], v[196:199], a[84:87]
ds_read_b64_tr_b16 a[252:253], v13 offset:24576
v_mfma_f32_16x16x32_bf16 a[84:87], a[236:239], v[212:215], a[84:87]
v_exp_f32 v229, v117
v_mfma_f32_16x16x32_bf16 a[80:83], a[236:239], v[208:211], a[80:83]
ds_read_b64_tr_b16 a[254:255], v13 offset:28672
v_cvt_pk_bf16_f32 v154, v228, v229
v_mfma_f32_16x16x32_bf16 a[80:83], a[232:235], v[192:195], a[80:83]
s_waitcnt lgkmcnt(4)
v_exp_f32 v230, v118
v_mfma_f32_16x16x32_bf16 a[96:99], a[240:243], v[192:195], a[96:99]
v_mfma_f32_16x16x32_bf16 a[96:99], a[244:247], v[208:211], a[96:99]
v_exp_f32 v231, v119
v_mfma_f32_16x16x32_bf16 a[100:103], a[244:247], v[212:215], a[100:103]
v_cvt_pk_bf16_f32 v155, v230, v231
v_mfma_f32_16x16x32_bf16 a[100:103], a[240:243], v[196:199], a[100:103]
v_exp_f32 v224, v120
v_mfma_f32_16x16x32_bf16 a[104:107], a[240:243], v[200:203], a[104:107]
ds_read_b128 a[224:227], v2 offset:24576
v_mfma_f32_16x16x32_bf16 a[104:107], a[244:247], v[216:219], a[104:107]
ds_read_b128 a[228:231], v3 offset:24576
v_mfma_f32_16x16x32_bf16 a[108:111], a[244:247], v[220:223], a[108:111]
v_exp_f32 v225, v121
v_mfma_f32_16x16x32_bf16 a[108:111], a[240:243], v[204:207], a[108:111]
s_waitcnt lgkmcnt(2)
buffer_load_dwordx4 v19, s[40:43], s76 offen offset:3072 nt lds
v_mfma_f32_16x16x32_bf16 a[124:127], a[248:251], v[204:207], a[124:127]
s_xor_b32 s76, s67, 147968
v_exp_f32 v226, v122
v_mfma_f32_16x16x32_bf16 a[124:127], a[252:255], v[220:223], a[124:127]
s_add_u32 m0, s69, 114688
ds_read_b128 a[232:235], v4 offset:24576
v_cvt_pk_bf16_f32 v156, v224, v225
v_mfma_f32_16x16x32_bf16 a[120:123], a[252:255], v[216:219], a[120:123]
v_exp_f32 v227, v123
v_mfma_f32_16x16x32_bf16 a[120:123], a[248:251], v[200:203], a[120:123]
ds_read_b128 a[236:239], v5 offset:24576
v_cvt_pk_bf16_f32 v157, v226, v227
v_mfma_f32_16x16x32_bf16 a[116:119], a[248:251], v[196:199], a[116:119]
v_exp_f32 v228, v124
v_mfma_f32_16x16x32_bf16 a[116:119], a[252:255], v[212:215], a[116:119]
v_mfma_f32_16x16x32_bf16 a[112:115], a[252:255], v[208:211], a[112:115]
v_exp_f32 v229, v125
v_mfma_f32_16x16x32_bf16 a[112:115], a[248:251], v[192:195], a[112:115]
v_cvt_pk_bf16_f32 v158, v228, v229
v_mfma_f32_16x16x32_bf16 a[136:139], a[144:147], v[200:203], a[136:139]
v_exp_f32 v230, v126
v_mfma_f32_16x16x32_bf16 a[136:139], a[144:147], v[216:219], a[136:139]
v_mfma_f32_16x16x32_bf16 a[140:143], a[144:147], v[204:207], a[140:143]
v_exp_f32 v231, v127
v_mfma_f32_16x16x32_bf16 a[140:143], a[144:147], v[220:223], a[140:143]
s_waitcnt lgkmcnt(0)
v_cvt_pk_bf16_f32 v159, v230, v231
v_mfma_f32_16x16x32_bf16 v[96:99], a[224:227], v[32:35], v[240:243]
v_exp_f32 v224, v160
v_mfma_f32_16x16x32_bf16 v[96:99], a[228:231], v[36:39], v[96:99]
ds_read_b128 a[240:243], v2 offset:28672
v_mfma_f32_16x16x32_bf16 v[96:99], a[232:235], v[40:43], v[96:99]
v_exp_f32 v225, v161
v_mfma_f32_16x16x32_bf16 v[96:99], a[236:239], v[44:47], v[96:99]
buffer_load_dwordx4 v18, s[40:43], s76 offen nt lds
v_mfma_f32_16x16x32_bf16 v[104:107], a[236:239], v[60:63], v[244:247]
v_exp_f32 v226, v162
v_mfma_f32_16x16x32_bf16 v[104:107], a[232:235], v[56:59], v[104:107]
ds_read_b128 a[244:247], v3 offset:28672
v_cvt_pk_bf16_f32 v192, v224, v225
v_mfma_f32_16x16x32_bf16 v[104:107], a[228:231], v[52:55], v[104:107]
v_exp_f32 v227, v163
v_mfma_f32_16x16x32_bf16 v[104:107], a[224:227], v[48:51], v[104:107]
ds_read_b128 a[248:251], v4 offset:28672
v_cvt_pk_bf16_f32 v193, v226, v227
v_mfma_f32_16x16x32_bf16 v[112:115], a[224:227], v[64:67], v[248:251]
v_exp_f32 v228, v164
v_mfma_f32_16x16x32_bf16 v[112:115], a[228:231], v[68:71], v[112:115]
ds_read_b128 a[252:255], v5 offset:28672
v_mfma_f32_16x16x32_bf16 v[112:115], a[232:235], v[72:75], v[112:115]
v_exp_f32 v229, v165
v_mfma_f32_16x16x32_bf16 v[112:115], a[236:239], v[76:79], v[112:115]
v_cvt_pk_bf16_f32 v194, v228, v229
v_mfma_f32_16x16x32_bf16 v[120:123], a[236:239], v[92:95], v[252:255]
v_exp_f32 v230, v166
v_mfma_f32_16x16x32_bf16 v[120:123], a[232:235], v[88:91], v[120:123]
v_mfma_f32_16x16x32_bf16 v[120:123], a[228:231], v[84:87], v[120:123]
v_exp_f32 v231, v167
v_mfma_f32_16x16x32_bf16 v[120:123], a[224:227], v[80:83], v[120:123]
s_waitcnt vmcnt(9) lgkmcnt(0)
s_barrier
v_readfirstlane_b32 s8, v239
v_readlane_b32 s9, v239, 1
ds_read_b64_tr_b16 a[224:225], v6 offset:0
v_mfma_f32_16x16x32_bf16 v[124:127], a[240:243], v[80:83], v[252:255]
s_add_u32 s8, s8, s9
v_exp_f32 v224, v168
v_mfma_f32_16x16x32_bf16 v[124:127], a[244:247], v[84:87], v[124:127]
s_cmp_ge_u32 s8, 256
ds_read_b64_tr_b16 a[226:227], v6 offset:4096
v_cvt_pk_bf16_f32 v195, v230, v231
v_mfma_f32_16x16x32_bf16 v[124:127], a[248:251], v[88:91], v[124:127]
s_cbranch_scc0 L_ci_spin
L_ci_ret:
v_exp_f32 v225, v169
v_mfma_f32_16x16x32_bf16 v[124:127], a[252:255], v[92:95], v[124:127]
s_xor_b32 s76, s67, 147968
ds_read_b64_tr_b16 a[228:229], v6 offset:8192
v_cvt_pk_bf16_f32 v196, v224, v225
v_mfma_f32_16x16x32_bf16 v[116:119], a[252:255], v[76:79], v[248:251]
s_add_u32 m0, s69, 114688
ds_read_b64_tr_b16 a[230:231], v6 offset:12288
v_mfma_f32_16x16x32_bf16 v[116:119], a[248:251], v[72:75], v[116:119]
v_exp_f32 v226, v170
v_mfma_f32_16x16x32_bf16 v[116:119], a[244:247], v[68:71], v[116:119]
buffer_load_dwordx4 v19, s[40:43], s76 offen offset:1024 nt lds
v_mfma_f32_16x16x32_bf16 v[116:119], a[240:243], v[64:67], v[116:119]
v_exp_f32 v227, v171
v_mfma_f32_16x16x32_bf16 v[108:111], a[240:243], v[48:51], v[244:247]
ds_read_b64_tr_b16 a[232:233], v7 offset:0
v_cvt_pk_bf16_f32 v197, v226, v227
v_mfma_f32_16x16x32_bf16 v[108:111], a[244:247], v[52:55], v[108:111]
v_exp_f32 v228, v172
v_mfma_f32_16x16x32_bf16 v[108:111], a[248:251], v[56:59], v[108:111]
ds_read_b64_tr_b16 a[234:235], v7 offset:4096
v_mfma_f32_16x16x32_bf16 v[108:111], a[252:255], v[60:63], v[108:111]
v_exp_f32 v229, v173
v_mfma_f32_16x16x32_bf16 v[100:103], a[252:255], v[44:47], v[240:243]
ds_read_b64_tr_b16 a[236:237], v7 offset:8192
v_cvt_pk_bf16_f32 v198, v228, v229
v_mfma_f32_16x16x32_bf16 v[100:103], a[248:251], v[40:43], v[100:103]
v_exp_f32 v230, v174
v_mfma_f32_16x16x32_bf16 v[100:103], a[244:247], v[36:39], v[100:103]
ds_read_b64_tr_b16 a[238:239], v7 offset:12288
v_mfma_f32_16x16x32_bf16 v[100:103], a[240:243], v[32:35], v[100:103]
s_waitcnt lgkmcnt(4)
ds_read_b64_tr_b16 a[240:241], v8 offset:0
v_mfma_f32_16x16x32_bf16 a[0:3], a[224:227], v[128:131], a[0:3]
v_exp_f32 v231, v175
v_mfma_f32_16x16x32_bf16 a[0:3], a[228:231], v[144:147], a[0:3]
ds_read_b64_tr_b16 a[242:243], v8 offset:4096
v_cvt_pk_bf16_f32 v199, v230, v231
v_mfma_f32_16x16x32_bf16 a[4:7], a[228:231], v[148:151], a[4:7]
v_exp_f32 v224, v176
v_mfma_f32_16x16x32_bf16 a[4:7], a[224:227], v[132:135], a[4:7]
buffer_load_dwordx4 v18, s[40:43], s76 offen offset:2048 nt lds
v_mfma_f32_16x16x32_bf16 a[8:11], a[224:227], v[136:139], a[8:11]
v_exp_f32 v225, v177
v_mfma_f32_16x16x32_bf16 a[8:11], a[228:231], v[152:155], a[8:11]
ds_read_b64_tr_b16 a[244:245], v8 offset:8192
v_cvt_pk_bf16_f32 v200, v224, v225
v_mfma_f32_16x16x32_bf16 a[12:15], a[228:231], v[156:159], a[12:15]
v_exp_f32 v226, v178
v_mfma_f32_16x16x32_bf16 a[12:15], a[224:227], v[140:143], a[12:15]
s_waitcnt lgkmcnt(3)
ds_read_b64_tr_b16 a[246:247], v8 offset:12288
v_mfma_f32_16x16x32_bf16 a[28:31], a[232:235], v[140:143], a[28:31]
v_exp_f32 v227, v179
v_mfma_f32_16x16x32_bf16 a[28:31], a[236:239], v[156:159], a[28:31]
ds_read_b64_tr_b16 a[248:249], v9 offset:0
v_cvt_pk_bf16_f32 v201, v226, v227
v_mfma_f32_16x16x32_bf16 a[24:27], a[236:239], v[152:155], a[24:27]
ds_read_b64_tr_b16 a[250:251], v9 offset:4096
v_mfma_f32_16x16x32_bf16 a[24:27], a[232:235], v[136:139], a[24:27]
v_exp_f32 v228, v180
v_mfma_f32_16x16x32_bf16 a[20:23], a[232:235], v[132:135], a[20:23]
ds_read_b64_tr_b16 a[252:253], v9 offset:8192
v_mfma_f32_16x16x32_bf16 a[20:23], a[236:239], v[148:151], a[20:23]
v_exp_f32 v229, v181
v_mfma_f32_16x16x32_bf16 a[16:19], a[236:239], v[144:147], a[16:19]
buffer_load_dwordx4 v19, s[40:43], s76 offen offset:3072 nt lds
v_mfma_f32_16x16x32_bf16 a[16:19], a[232:235], v[128:131], a[16:19]
s_waitcnt lgkmcnt(3)
v_exp_f32 v230, v182
v_mfma_f32_16x16x32_bf16 a[32:35], a[240:243], v[128:131], a[32:35]
s_xor_b32 s76, s67, 213504
ds_read_b64_tr_b16 a[254:255], v9 offset:12288
v_cvt_pk_bf16_f32 v202, v228, v229
v_mfma_f32_16x16x32_bf16 a[32:35], a[244:247], v[144:147], a[32:35]
s_add_u32 m0, s69, 81920
v_exp_f32 v231, v183
v_mfma_f32_16x16x32_bf16 a[36:39], a[244:247], v[148:151], a[36:39]
v_cvt_pk_bf16_f32 v203, v230, v231
v_mfma_f32_16x16x32_bf16 a[36:39], a[240:243], v[132:135], a[36:39]
v_exp_f32 v224, v184
v_mfma_f32_16x16x32_bf16 a[40:43], a[240:243], v[136:139], a[40:43]
ds_read_b128 a[224:227], v2 offset:32768
v_mfma_f32_16x16x32_bf16 a[40:43], a[244:247], v[152:155], a[40:43]
ds_read_b128 a[228:231], v3 offset:32768
v_mfma_f32_16x16x32_bf16 a[44:47], a[244:247], v[156:159], a[44:47]
v_exp_f32 v225, v185
v_mfma_f32_16x16x32_bf16 a[44:47], a[240:243], v[140:143], a[44:47]
s_waitcnt lgkmcnt(2)
ds_read_b128 a[232:235], v4 offset:32768
v_cvt_pk_bf16_f32 v204, v224, v225
v_mfma_f32_16x16x32_bf16 a[60:63], a[248:251], v[140:143], a[60:63]
v_exp_f32 v226, v186
v_mfma_f32_16x16x32_bf16 a[60:63], a[252:255], v[156:159], a[60:63]
ds_read_b128 a[236:239], v5 offset:32768
v_mfma_f32_16x16x32_bf16 a[56:59], a[252:255], v[152:155], a[56:59]
v_exp_f32 v227, v187
v_mfma_f32_16x16x32_bf16 a[56:59], a[248:251], v[136:139], a[56:59]
buffer_load_dwordx4 v18, s[40:43], s76 offen nt lds
v_mfma_f32_16x16x32_bf16 a[52:55], a[248:251], v[132:135], a[52:55]
v_exp_f32 v228, v188
v_mfma_f32_16x16x32_bf16 a[52:55], a[252:255], v[148:151], a[52:55]
v_cvt_pk_bf16_f32 v205, v226, v227
v_mfma_f32_16x16x32_bf16 a[48:51], a[252:255], v[144:147], a[48:51]
v_exp_f32 v229, v189
v_mfma_f32_16x16x32_bf16 a[48:51], a[248:251], v[128:131], a[48:51]
v_cvt_pk_bf16_f32 v206, v228, v229
L_hop2_1:
s_cbranch_execz L_hop_ret2
v_mfma_f32_16x16x32_bf16 a[128:131], a[144:147], v[128:131], a[128:131]
v_exp_f32 v230, v190
v_mfma_f32_16x16x32_bf16 a[128:131], a[144:147], v[144:147], a[128:131]
v_mfma_f32_16x16x32_bf16 a[132:135], a[144:147], v[132:135], a[132:135]
v_exp_f32 v231, v191
v_mfma_f32_16x16x32_bf16 a[132:135], a[144:147], v[148:151], a[132:135]
s_waitcnt lgkmcnt(0)
v_cvt_pk_bf16_f32 v207, v230, v231
v_mfma_f32_16x16x32_bf16 v[160:163], a[224:227], v[32:35], v[240:243]
v_exp_f32 v224, v96
v_mfma_f32_16x16x32_bf16 v[160:163], a[228:231], v[36:39], v[160:163]
ds_read_b128 a[240:243], v2 offset:36864
v_mfma_f32_16x16x32_bf16 v[160:163], a[232:235], v[40:43], v[160:163]
v_exp_f32 v225, v97
v_mfma_f32_16x16x32_bf16 v[160:163], a[236:239], v[44:47], v[160:163]
buffer_load_dwordx4 v19, s[40:43], s76 offen offset:1024 nt lds
v_mfma_f32_16x16x32_bf16 v[168:171], a[236:239], v[60:63], v[244:247]
v_exp_f32 v226, v98
v_mfma_f32_16x16x32_bf16 v[168:171], a[232:235], v[56:59], v[168:171]
ds_read_b128 a[244:247], v3 offset:36864
v_cvt_pk_bf16_f32 v208, v224, v225
v_mfma_f32_16x16x32_bf16 v[168:171], a[228:231], v[52:55], v[168:171]
v_exp_f32 v227, v99
v_mfma_f32_16x16x32_bf16 v[168:171], a[224:227], v[48:51], v[168:171]
ds_read_b128 a[248:251], v4 offset:36864
v_cvt_pk_bf16_f32 v209, v226, v227
v_mfma_f32_16x16x32_bf16 v[176:179], a[224:227], v[64:67], v[248:251]
v_exp_f32 v228, v100
v_mfma_f32_16x16x32_bf16 v[176:179], a[228:231], v[68:71], v[176:179]
ds_read_b128 a[252:255], v5 offset:36864
v_mfma_f32_16x16x32_bf16 v[176:179], a[232:235], v[72:75], v[176:179]
v_exp_f32 v229, v101
v_mfma_f32_16x16x32_bf16 v[176:179], a[236:239], v[76:79], v[176:179]
v_cvt_pk_bf16_f32 v210, v228, v229
v_mfma_f32_16x16x32_bf16 v[184:187], a[236:239], v[92:95], v[252:255]
v_exp_f32 v230, v102
v_mfma_f32_16x16x32_bf16 v[184:187], a[232:235], v[88:91], v[184:187]
v_mfma_f32_16x16x32_bf16 v[184:187], a[228:231], v[84:87], v[184:187]
v_exp_f32 v231, v103
v_mfma_f32_16x16x32_bf16 v[184:187], a[224:227], v[80:83], v[184:187]
s_waitcnt lgkmcnt(0)
buffer_load_dwordx4 v18, s[40:43], s76 offen offset:2048 nt lds
v_mfma_f32_16x16x32_bf16 v[188:191], a[240:243], v[80:83], v[252:255]
v_exp_f32 v224, v104
v_mfma_f32_16x16x32_bf16 v[188:191], a[244:247], v[84:87], v[188:191]
ds_read_b64_tr_b16 a[224:225], v10 offset:0
v_cvt_pk_bf16_f32 v211, v230, v231
v_mfma_f32_16x16x32_bf16 v[188:191], a[248:251], v[88:91], v[188:191]
v_exp_f32 v225, v105
v_mfma_f32_16x16x32_bf16 v[188:191], a[252:255], v[92:95], v[188:191]
ds_read_b64_tr_b16 a[226:227], v10 offset:4096
v_cvt_pk_bf16_f32 v212, v224, v225
v_mfma_f32_16x16x32_bf16 v[180:183], a[252:255], v[76:79], v[248:251]
ds_read_b64_tr_b16 a[228:229], v10 offset:8192
v_mfma_f32_16x16x32_bf16 v[180:183], a[248:251], v[72:75], v[180:183]
v_exp_f32 v226, v106
v_mfma_f32_16x16x32_bf16 v[180:183], a[244:247], v[68:71], v[180:183]
ds_read_b64_tr_b16 a[230:231], v10 offset:12288
v_mfma_f32_16x16x32_bf16 v[180:183], a[240:243], v[64:67], v[180:183]
v_exp_f32 v227, v107
v_mfma_f32_16x16x32_bf16 v[172:175], a[240:243], v[48:51], v[244:247]
ds_read_b64_tr_b16 a[232:233], v11 offset:0
v_cvt_pk_bf16_f32 v213, v226, v227
v_mfma_f32_16x16x32_bf16 v[172:175], a[244:247], v[52:55], v[172:175]
v_exp_f32 v228, v108
v_mfma_f32_16x16x32_bf16 v[172:175], a[248:251], v[56:59], v[172:175]
buffer_load_dwordx4 v19, s[40:43], s76 offen offset:3072 nt lds
v_mfma_f32_16x16x32_bf16 v[172:175], a[252:255], v[60:63], v[172:175]
s_add_u32 s44, s16, 143360
v_exp_f32 v229, v109
v_mfma_f32_16x16x32_bf16 v[164:167], a[252:255], v[44:47], v[240:243]
s_add_u32 m0, s69, 131072
ds_read_b64_tr_b16 a[234:235], v11 offset:4096
v_cvt_pk_bf16_f32 v214, v228, v229
v_mfma_f32_16x16x32_bf16 v[164:167], a[248:251], v[40:43], v[164:167]
v_exp_f32 v230, v110
v_mfma_f32_16x16x32_bf16 v[164:167], a[244:247], v[36:39], v[164:167]
ds_read_b64_tr_b16 a[236:237], v11 offset:8192
v_mfma_f32_16x16x32_bf16 v[164:167], a[240:243], v[32:35], v[164:167]
s_waitcnt lgkmcnt(3)
ds_read_b64_tr_b16 a[238:239], v11 offset:12288
v_mfma_f32_16x16x32_bf16 a[64:67], a[224:227], v[128:131], a[64:67]
v_exp_f32 v231, v111
v_mfma_f32_16x16x32_bf16 a[64:67], a[228:231], v[144:147], a[64:67]
ds_read_b64_tr_b16 a[240:241], v12 offset:0
v_cvt_pk_bf16_f32 v215, v230, v231
v_mfma_f32_16x16x32_bf16 a[68:71], a[228:231], v[148:151], a[68:71]
v_exp_f32 v224, v112
v_mfma_f32_16x16x32_bf16 a[68:71], a[224:227], v[132:135], a[68:71]
ds_read_b64_tr_b16 a[242:243], v12 offset:4096
v_mfma_f32_16x16x32_bf16 a[72:75], a[224:227], v[136:139], a[72:75]
v_exp_f32 v225, v113
v_mfma_f32_16x16x32_bf16 a[72:75], a[228:231], v[152:155], a[72:75]
ds_read_b64_tr_b16 a[244:245], v12 offset:8192
v_cvt_pk_bf16_f32 v216, v224, v225
v_mfma_f32_16x16x32_bf16 a[76:79], a[228:231], v[156:159], a[76:79]
v_exp_f32 v226, v114
v_mfma_f32_16x16x32_bf16 a[76:79], a[224:227], v[140:143], a[76:79]
s_waitcnt lgkmcnt(3)
buffer_load_dwordx4 v238, s[52:55], s44 offen sc1 lds
v_mfma_f32_16x16x32_bf16 a[92:95], a[232:235], v[140:143], a[92:95]
v_exp_f32 v227, v115
v_mfma_f32_16x16x32_bf16 a[92:95], a[236:239], v[156:159], a[92:95]
ds_read_b64_tr_b16 a[246:247], v12 offset:12288
v_cvt_pk_bf16_f32 v217, v226, v227
v_mfma_f32_16x16x32_bf16 a[88:91], a[236:239], v[152:155], a[88:91]
ds_read_b64_tr_b16 a[248:249], v13 offset:0
v_mfma_f32_16x16x32_bf16 a[88:91], a[232:235], v[136:139], a[88:91]
v_exp_f32 v228, v116
v_mfma_f32_16x16x32_bf16 a[84:87], a[232:235], v[132:135], a[84:87]
ds_read_b64_tr_b16 a[250:251], v13 offset:4096
v_mfma_f32_16x16x32_bf16 a[84:87], a[236:239], v[148:151], a[84:87]
v_exp_f32 v229, v117
v_mfma_f32_16x16x32_bf16 a[80:83], a[236:239], v[144:147], a[80:83]
ds_read_b64_tr_b16 a[252:253], v13 offset:8192
v_cvt_pk_bf16_f32 v218, v228, v229
v_mfma_f32_16x16x32_bf16 a[80:83], a[232:235], v[128:131], a[80:83]
s_waitcnt lgkmcnt(3)
v_exp_f32 v230, v118
v_mfma_f32_16x16x32_bf16 a[96:99], a[240:243], v[128:131], a[96:99]
ds_read_b64_tr_b16 a[254:255], v13 offset:12288
v_mfma_f32_16x16x32_bf16 a[96:99], a[244:247], v[144:147], a[96:99]
v_exp_f32 v231, v119
v_mfma_f32_16x16x32_bf16 a[100:103], a[244:247], v[148:151], a[100:103]
buffer_load_dwordx4 v238, s[52:55], s44 offen offset:1024 sc1 lds
v_mfma_f32_16x16x32_bf16 a[100:103], a[240:243], v[132:135], a[100:103]
v_exp_f32 v224, v120
v_mfma_f32_16x16x32_bf16 a[104:107], a[240:243], v[136:139], a[104:107]
ds_read_b128 a[224:227], v2 offset:40960
v_cvt_pk_bf16_f32 v219, v230, v231
v_mfma_f32_16x16x32_bf16 a[104:107], a[244:247], v[152:155], a[104:107]
ds_read_b128 a[228:231], v3 offset:40960
v_mfma_f32_16x16x32_bf16 a[108:111], a[244:247], v[156:159], a[108:111]
v_exp_f32 v225, v121
v_mfma_f32_16x16x32_bf16 a[108:111], a[240:243], v[140:143], a[108:111]
s_waitcnt lgkmcnt(2)
buffer_load_dwordx4 v238, s[52:55], s44 offen offset:2048 sc1 lds
v_mfma_f32_16x16x32_bf16 a[124:127], a[248:251], v[140:143], a[124:127]
v_exp_f32 v226, v122
v_mfma_f32_16x16x32_bf16 a[124:127], a[252:255], v[156:159], a[124:127]
ds_read_b128 a[232:235], v4 offset:40960
v_cvt_pk_bf16_f32 v220, v224, v225
v_mfma_f32_16x16x32_bf16 a[120:123], a[252:255], v[152:155], a[120:123]
v_exp_f32 v227, v123
v_mfma_f32_16x16x32_bf16 a[120:123], a[248:251], v[136:139], a[120:123]
ds_read_b128 a[236:239], v5 offset:40960
v_cvt_pk_bf16_f32 v221, v226, v227
v_mfma_f32_16x16x32_bf16 a[116:119], a[248:251], v[132:135], a[116:119]
v_exp_f32 v228, v124
v_mfma_f32_16x16x32_bf16 a[116:119], a[252:255], v[148:151], a[116:119]
buffer_load_dwordx4 v238, s[52:55], s44 offen offset:3072 sc1 lds
v_mfma_f32_16x16x32_bf16 a[112:115], a[252:255], v[144:147], a[112:115]
s_add_u32 s45, s44, 4096
v_exp_f32 v229, v125
v_mfma_f32_16x16x32_bf16 a[112:115], a[248:251], v[128:131], a[112:115]
s_add_u32 m0, s69, 147456
v_cvt_pk_bf16_f32 v222, v228, v229
v_mfma_f32_16x16x32_bf16 a[136:139], a[144:147], v[136:139], a[136:139]
v_exp_f32 v230, v126
v_mfma_f32_16x16x32_bf16 a[136:139], a[144:147], v[152:155], a[136:139]
v_mfma_f32_16x16x32_bf16 a[140:143], a[144:147], v[140:143], a[140:143]
v_exp_f32 v231, v127
v_mfma_f32_16x16x32_bf16 a[140:143], a[144:147], v[156:159], a[140:143]
s_waitcnt lgkmcnt(0)
buffer_load_dwordx4 v238, s[52:55], s45 offen sc1 lds
v_mfma_f32_16x16x32_bf16 v[96:99], a[224:227], v[32:35], v[240:243]
s_add_u32 s44, s17, 20480
v_exp_f32 v224, v160
v_mfma_f32_16x16x32_bf16 v[96:99], a[228:231], v[36:39], v[96:99]
s_add_u32 m0, s69, 0
ds_read_b128 a[240:243], v2 offset:45056
v_cvt_pk_bf16_f32 v223, v230, v231
v_mfma_f32_16x16x32_bf16 v[96:99], a[232:235], v[40:43], v[96:99]
v_exp_f32 v225, v161
v_mfma_f32_16x16x32_bf16 v[96:99], a[236:239], v[44:47], v[96:99]
ds_read_b128 a[244:247], v3 offset:45056
v_cvt_pk_bf16_f32 v128, v224, v225
v_mfma_f32_16x16x32_bf16 v[104:107], a[236:239], v[60:63], v[244:247]
v_exp_f32 v226, v162
v_mfma_f32_16x16x32_bf16 v[104:107], a[232:235], v[56:59], v[104:107]
buffer_load_dwordx4 v238, s[52:55], s44 offen sc1 lds
v_mfma_f32_16x16x32_bf16 v[104:107], a[228:231], v[52:55], v[104:107]
v_exp_f32 v227, v163
v_mfma_f32_16x16x32_bf16 v[104:107], a[224:227], v[48:51], v[104:107]
ds_read_b128 a[248:251], v4 offset:45056
v_cvt_pk_bf16_f32 v129, v226, v227
v_mfma_f32_16x16x32_bf16 v[112:115], a[224:227], v[64:67], v[248:251]
v_exp_f32 v228, v164
v_mfma_f32_16x16x32_bf16 v[112:115], a[228:231], v[68:71], v[112:115]
ds_read_b128 a[252:255], v5 offset:45056
v_mfma_f32_16x16x32_bf16 v[112:115], a[232:235], v[72:75], v[112:115]
v_exp_f32 v229, v165
v_mfma_f32_16x16x32_bf16 v[112:115], a[236:239], v[76:79], v[112:115]
buffer_load_dwordx4 v238, s[52:55], s44 offen offset:1024 sc1 lds
v_mfma_f32_16x16x32_bf16 v[120:123], a[236:239], v[92:95], v[252:255]
v_exp_f32 v230, v166
v_mfma_f32_16x16x32_bf16 v[120:123], a[232:235], v[88:91], v[120:123]
v_cvt_pk_bf16_f32 v130, v228, v229
v_mfma_f32_16x16x32_bf16 v[120:123], a[228:231], v[84:87], v[120:123]
v_exp_f32 v231, v167
v_mfma_f32_16x16x32_bf16 v[120:123], a[224:227], v[80:83], v[120:123]
s_waitcnt vmcnt(15) lgkmcnt(0)
s_barrier
ds_read_b64_tr_b16 a[224:225], v6 offset:32768
v_mfma_f32_16x16x32_bf16 v[124:127], a[240:243], v[80:83], v[252:255]
v_exp_f32 v224, v168
v_mfma_f32_16x16x32_bf16 v[124:127], a[244:247], v[84:87], v[124:127]
ds_read_b64_tr_b16 a[226:227], v6 offset:36864
v_cvt_pk_bf16_f32 v131, v230, v231
v_mfma_f32_16x16x32_bf16 v[124:127], a[248:251], v[88:91], v[124:127]
v_exp_f32 v225, v169
v_mfma_f32_16x16x32_bf16 v[124:127], a[252:255], v[92:95], v[124:127]
buffer_load_dwordx4 v238, s[52:55], s44 offen offset:2048 sc1 lds
v_mfma_f32_16x16x32_bf16 v[116:119], a[252:255], v[76:79], v[248:251]
ds_read_b64_tr_b16 a[228:229], v6 offset:40960
v_cvt_pk_bf16_f32 v132, v224, v225
v_mfma_f32_16x16x32_bf16 v[116:119], a[248:251], v[72:75], v[116:119]
v_exp_f32 v226, v170
v_mfma_f32_16x16x32_bf16 v[116:119], a[244:247], v[68:71], v[116:119]
buffer_load_dwordx4 v238, s[52:55], s44 offen offset:3072 sc1 lds
v_mfma_f32_16x16x32_bf16 v[116:119], a[240:243], v[64:67], v[116:119]
s_add_u32 s45, s44, 4096
v_exp_f32 v227, v171
v_mfma_f32_16x16x32_bf16 v[108:111], a[240:243], v[48:51], v[244:247]
s_add_u32 m0, s69, 148480
ds_read_b64_tr_b16 a[230:231], v6 offset:45056
v_cvt_pk_bf16_f32 v133, v226, v227
v_mfma_f32_16x16x32_bf16 v[108:111], a[244:247], v[52:55], v[108:111]
v_exp_f32 v228, v172
v_mfma_f32_16x16x32_bf16 v[108:111], a[248:251], v[56:59], v[108:111]
ds_read_b64_tr_b16 a[232:233], v7 offset:32768
v_mfma_f32_16x16x32_bf16 v[108:111], a[252:255], v[60:63], v[108:111]
v_exp_f32 v229, v173
v_mfma_f32_16x16x32_bf16 v[100:103], a[252:255], v[44:47], v[240:243]
buffer_load_dwordx4 v238, s[52:55], s45 offen sc1 lds
v_mfma_f32_16x16x32_bf16 v[100:103], a[248:251], v[40:43], v[100:103]
s_add_u32 s44, s17, 61440
v_exp_f32 v230, v174
v_mfma_f32_16x16x32_bf16 v[100:103], a[244:247], v[36:39], v[100:103]
s_add_u32 m0, s69, 16384
ds_read_b64_tr_b16 a[234:235], v7 offset:36864
v_cvt_pk_bf16_f32 v134, v228, v229
v_mfma_f32_16x16x32_bf16 v[100:103], a[240:243], v[32:35], v[100:103]
s_waitcnt lgkmcnt(2)
ds_read_b64_tr_b16 a[236:237], v7 offset:40960
v_mfma_f32_16x16x32_bf16 a[0:3], a[224:227], v[192:195], a[0:3]
v_exp_f32 v231, v175
v_mfma_f32_16x16x32_bf16 a[0:3], a[228:231], v[208:211], a[0:3]
ds_read_b64_tr_b16 a[238:239], v7 offset:45056
v_cvt_pk_bf16_f32 v135, v230, v231
v_mfma_f32_16x16x32_bf16 a[4:7], a[228:231], v[212:215], a[4:7]
buffer_load_dwordx4 v238, s[52:55], s44 offen sc1 lds
v_exp_f32 v224, v176
v_mfma_f32_16x16x32_bf16 a[4:7], a[224:227], v[196:199], a[4:7]
ds_read_b64_tr_b16 a[240:241], v8 offset:32768
v_mfma_f32_16x16x32_bf16 a[8:11], a[224:227], v[200:203], a[8:11]
v_exp_f32 v225, v177
v_mfma_f32_16x16x32_bf16 a[8:11], a[228:231], v[216:219], a[8:11]
ds_read_b64_tr_b16 a[242:243], v8 offset:36864
v_cvt_pk_bf16_f32 v136, v224, v225
v_mfma_f32_16x16x32_bf16 a[12:15], a[228:231], v[220:223], a[12:15]
buffer_load_dwordx4 v238, s[52:55], s44 offen offset:1024 sc1 lds
v_exp_f32 v226, v178
v_mfma_f32_16x16x32_bf16 a[12:15], a[224:227], v[204:207], a[12:15]
s_waitcnt lgkmcnt(2)
ds_read_b64_tr_b16 a[244:245], v8 offset:40960
v_mfma_f32_16x16x32_bf16 a[28:31], a[232:235], v[204:207], a[28:31]
v_exp_f32 v227, v179
v_mfma_f32_16x16x32_bf16 a[28:31], a[236:239], v[220:223], a[28:31]
ds_read_b64_tr_b16 a[246:247], v8 offset:45056
v_cvt_pk_bf16_f32 v137, v226, v227
v_mfma_f32_16x16x32_bf16 a[24:27], a[236:239], v[216:219], a[24:27]
ds_read_b64_tr_b16 a[248:249], v9 offset:32768
v_mfma_f32_16x16x32_bf16 a[24:27], a[232:235], v[200:203], a[24:27]
buffer_load_dwordx4 v238, s[52:55], s44 offen offset:2048 sc1 lds
v_exp_f32 v228, v180
v_mfma_f32_16x16x32_bf16 a[20:23], a[232:235], v[196:199], a[20:23]
ds_read_b64_tr_b16 a[250:251], v9 offset:36864
v_mfma_f32_16x16x32_bf16 a[20:23], a[236:239], v[212:215], a[20:23]
v_exp_f32 v229, v181
v_mfma_f32_16x16x32_bf16 a[16:19], a[236:239], v[208:211], a[16:19]
ds_read_b64_tr_b16 a[252:253], v9 offset:40960
v_cvt_pk_bf16_f32 v138, v228, v229
v_mfma_f32_16x16x32_bf16 a[16:19], a[232:235], v[192:195], a[16:19]
s_waitcnt lgkmcnt(3)
buffer_load_dwordx4 v238, s[52:55], s44 offen offset:3072 sc1 lds
v_exp_f32 v230, v182
v_mfma_f32_16x16x32_bf16 a[32:35], a[240:243], v[192:195], a[32:35]
s_add_u32 s45, s44, 4096
ds_read_b64_tr_b16 a[254:255], v9 offset:45056
v_mfma_f32_16x16x32_bf16 a[32:35], a[244:247], v[208:211], a[32:35]
s_add_u32 m0, s69, 149504
v_exp_f32 v231, v183
v_mfma_f32_16x16x32_bf16 a[36:39], a[244:247], v[212:215], a[36:39]
buffer_load_dwordx4 v238, s[52:55], s45 offen sc1 lds
v_mfma_f32_16x16x32_bf16 a[36:39], a[240:243], v[196:199], a[36:39]
s_add_u32 s44, s17, 102400
v_exp_f32 v224, v184
v_mfma_f32_16x16x32_bf16 a[40:43], a[240:243], v[200:203], a[40:43]
s_add_u32 m0, s69, 65536
ds_read_b128 a[224:227], v2 offset:49152
v_cvt_pk_bf16_f32 v139, v230, v231
v_mfma_f32_16x16x32_bf16 a[40:43], a[244:247], v[216:219], a[40:43]
ds_read_b128 a[228:231], v3 offset:49152
v_mfma_f32_16x16x32_bf16 a[44:47], a[244:247], v[220:223], a[44:47]
v_exp_f32 v225, v185
v_mfma_f32_16x16x32_bf16 a[44:47], a[240:243], v[204:207], a[44:47]
s_waitcnt lgkmcnt(2)
buffer_load_dwordx4 v238, s[52:55], s44 offen sc1 lds
v_mfma_f32_16x16x32_bf16 a[60:63], a[248:251], v[204:207], a[60:63]
v_exp_f32 v226, v186
v_mfma_f32_16x16x32_bf16 a[60:63], a[252:255], v[220:223], a[60:63]
ds_read_b128 a[232:235], v4 offset:49152
v_cvt_pk_bf16_f32 v140, v224, v225
v_mfma_f32_16x16x32_bf16 a[56:59], a[252:255], v[216:219], a[56:59]
v_exp_f32 v227, v187
v_mfma_f32_16x16x32_bf16 a[56:59], a[248:251], v[200:203], a[56:59]
buffer_load_dwordx4 v238, s[52:55], s44 offen offset:1024 sc1 lds
v_mfma_f32_16x16x32_bf16 a[52:55], a[248:251], v[196:199], a[52:55]
v_exp_f32 v228, v188
v_mfma_f32_16x16x32_bf16 a[52:55], a[252:255], v[212:215], a[52:55]
ds_read_b128 a[236:239], v5 offset:49152
v_cvt_pk_bf16_f32 v141, v226, v227
v_mfma_f32_16x16x32_bf16 a[48:51], a[252:255], v[208:211], a[48:51]
v_exp_f32 v229, v189
v_mfma_f32_16x16x32_bf16 a[48:51], a[248:251], v[192:195], a[48:51]
buffer_load_dwordx4 v238, s[52:55], s44 offen offset:2048 sc1 lds
v_mfma_f32_16x16x32_bf16 a[128:131], a[144:147], v[192:195], a[128:131]
v_exp_f32 v230, v190
v_mfma_f32_16x16x32_bf16 a[128:131], a[144:147], v[208:211], a[128:131]
v_cvt_pk_bf16_f32 v142, v228, v229
v_mfma_f32_16x16x32_bf16 a[132:135], a[144:147], v[196:199], a[132:135]
v_exp_f32 v231, v191
v_mfma_f32_16x16x32_bf16 a[132:135], a[144:147], v[212:215], a[132:135]
s_waitcnt lgkmcnt(0)
v_cvt_pk_bf16_f32 v143, v230, v231
v_mfma_f32_16x16x32_bf16 v[160:163], a[224:227], v[32:35], v[240:243]
v_exp_f32 v224, v96
v_mfma_f32_16x16x32_bf16 v[160:163], a[228:231], v[36:39], v[160:163]
buffer_load_dwordx4 v238, s[52:55], s44 offen offset:3072 sc1 lds
v_mfma_f32_16x16x32_bf16 v[160:163], a[232:235], v[40:43], v[160:163]
s_add_u32 s45, s44, 4096
v_exp_f32 v225, v97
v_mfma_f32_16x16x32_bf16 v[160:163], a[236:239], v[44:47], v[160:163]
s_add_u32 m0, s69, 150528
ds_read_b128 a[240:243], v2 offset:53248
v_cvt_pk_bf16_f32 v144, v224, v225
v_mfma_f32_16x16x32_bf16 v[168:171], a[236:239], v[60:63], v[244:247]
v_exp_f32 v226, v98
v_mfma_f32_16x16x32_bf16 v[168:171], a[232:235], v[56:59], v[168:171]
ds_read_b128 a[244:247], v3 offset:53248
v_mfma_f32_16x16x32_bf16 v[168:171], a[228:231], v[52:55], v[168:171]
buffer_load_dwordx4 v238, s[52:55], s45 offen sc1 lds
v_exp_f32 v227, v99
v_mfma_f32_16x16x32_bf16 v[168:171], a[224:227], v[48:51], v[168:171]
s_add_u32 s44, s17, 143360
ds_read_b128 a[248:251], v4 offset:53248
v_cvt_pk_bf16_f32 v145, v226, v227
v_mfma_f32_16x16x32_bf16 v[176:179], a[224:227], v[64:67], v[248:251]
s_add_u32 m0, s69, 32768
v_exp_f32 v228, v100
v_mfma_f32_16x16x32_bf16 v[176:179], a[228:231], v[68:71], v[176:179]
ds_read_b128 a[252:255], v5 offset:53248
v_mfma_f32_16x16x32_bf16 v[176:179], a[232:235], v[72:75], v[176:179]
buffer_load_dwordx4 v238, s[52:55], s44 offen sc1 lds
v_exp_f32 v229, v101
v_mfma_f32_16x16x32_bf16 v[176:179], a[236:239], v[76:79], v[176:179]
v_cvt_pk_bf16_f32 v146, v228, v229
v_mfma_f32_16x16x32_bf16 v[184:187], a[236:239], v[92:95], v[252:255]
v_exp_f32 v230, v102
v_mfma_f32_16x16x32_bf16 v[184:187], a[232:235], v[88:91], v[184:187]
v_mfma_f32_16x16x32_bf16 v[184:187], a[228:231], v[84:87], v[184:187]
v_exp_f32 v231, v103
v_mfma_f32_16x16x32_bf16 v[184:187], a[224:227], v[80:83], v[184:187]
s_waitcnt lgkmcnt(0)
buffer_load_dwordx4 v238, s[52:55], s44 offen offset:1024 sc1 lds
v_mfma_f32_16x16x32_bf16 v[188:191], a[240:243], v[80:83], v[252:255]
v_exp_f32 v224, v104
v_mfma_f32_16x16x32_bf16 v[188:191], a[244:247], v[84:87], v[188:191]
ds_read_b64_tr_b16 a[224:225], v10 offset:32768
v_cvt_pk_bf16_f32 v147, v230, v231
v_mfma_f32_16x16x32_bf16 v[188:191], a[248:251], v[88:91], v[188:191]
v_exp_f32 v225, v105
v_mfma_f32_16x16x32_bf16 v[188:191], a[252:255], v[92:95], v[188:191]
buffer_load_dwordx4 v238, s[52:55], s44 offen offset:2048 sc1 lds
v_mfma_f32_16x16x32_bf16 v[180:183], a[252:255], v[76:79], v[248:251]
ds_read_b64_tr_b16 a[226:227], v10 offset:36864
v_cvt_pk_bf16_f32 v148, v224, v225
v_mfma_f32_16x16x32_bf16 v[180:183], a[248:251], v[72:75], v[180:183]
v_exp_f32 v226, v106
v_mfma_f32_16x16x32_bf16 v[180:183], a[244:247], v[68:71], v[180:183]
ds_read_b64_tr_b16 a[228:229], v10 offset:40960
v_mfma_f32_16x16x32_bf16 v[180:183], a[240:243], v[64:67], v[180:183]
v_exp_f32 v227, v107
v_mfma_f32_16x16x32_bf16 v[172:175], a[240:243], v[48:51], v[244:247]
ds_read_b64_tr_b16 a[230:231], v10 offset:45056
v_cvt_pk_bf16_f32 v149, v226, v227
v_mfma_f32_16x16x32_bf16 v[172:175], a[244:247], v[52:55], v[172:175]
buffer_load_dwordx4 v238, s[52:55], s44 offen offset:3072 sc1 lds
v_exp_f32 v228, v108
v_mfma_f32_16x16x32_bf16 v[172:175], a[248:251], v[56:59], v[172:175]
s_add_u32 s44, s16, 0
ds_read_b64_tr_b16 a[232:233], v11 offset:32768
v_mfma_f32_16x16x32_bf16 v[172:175], a[252:255], v[60:63], v[172:175]
s_add_u32 s45, s44, 4096
v_exp_f32 v229, v109
v_mfma_f32_16x16x32_bf16 v[164:167], a[252:255], v[44:47], v[240:243]
buffer_load_dwordx4 a[148:151], v238, s[52:55], s44 offen offset:0 sc1
v_mfma_f32_16x16x32_bf16 v[164:167], a[248:251], v[40:43], v[164:167]
v_exp_f32 v230, v110
v_mfma_f32_16x16x32_bf16 v[164:167], a[244:247], v[36:39], v[164:167]
ds_read_b64_tr_b16 a[234:235], v11 offset:36864
v_cvt_pk_bf16_f32 v150, v228, v229
v_mfma_f32_16x16x32_bf16 v[164:167], a[240:243], v[32:35], v[164:167]
s_waitcnt lgkmcnt(2)
ds_read_b64_tr_b16 a[236:237], v11 offset:40960
v_mfma_f32_16x16x32_bf16 a[64:67], a[224:227], v[192:195], a[64:67]
v_exp_f32 v231, v111
v_mfma_f32_16x16x32_bf16 a[64:67], a[228:231], v[208:211], a[64:67]
ds_read_b64_tr_b16 a[238:239], v11 offset:45056
v_cvt_pk_bf16_f32 v151, v230, v231
v_mfma_f32_16x16x32_bf16 a[68:71], a[228:231], v[212:215], a[68:71]
buffer_load_dwordx4 a[152:155], v238, s[52:55], s44 offen offset:1024 sc1
v_exp_f32 v224, v112
v_mfma_f32_16x16x32_bf16 a[68:71], a[224:227], v[196:199], a[68:71]
ds_read_b64_tr_b16 a[240:241], v12 offset:32768
v_mfma_f32_16x16x32_bf16 a[72:75], a[224:227], v[200:203], a[72:75]
v_exp_f32 v225, v113
v_mfma_f32_16x16x32_bf16 a[72:75], a[228:231], v[216:219], a[72:75]
ds_read_b64_tr_b16 a[242:243], v12 offset:36864
v_cvt_pk_bf16_f32 v152, v224, v225
v_mfma_f32_16x16x32_bf16 a[76:79], a[228:231], v[220:223], a[76:79]
buffer_load_dwordx4 a[156:159], v238, s[52:55], s44 offen offset:2048 sc1
v_exp_f32 v226, v114
v_mfma_f32_16x16x32_bf16 a[76:79], a[224:227], v[204:207], a[76:79]
s_waitcnt lgkmcnt(2)
ds_read_b64_tr_b16 a[244:245], v12 offset:40960
v_mfma_f32_16x16x32_bf16 a[92:95], a[232:235], v[204:207], a[92:95]
v_exp_f32 v227, v115
v_mfma_f32_16x16x32_bf16 a[92:95], a[236:239], v[220:223], a[92:95]
ds_read_b64_tr_b16 a[246:247], v12 offset:45056
v_cvt_pk_bf16_f32 v153, v226, v227
v_mfma_f32_16x16x32_bf16 a[88:91], a[236:239], v[216:219], a[88:91]
ds_read_b64_tr_b16 a[248:249], v13 offset:32768
v_mfma_f32_16x16x32_bf16 a[88:91], a[232:235], v[200:203], a[88:91]
buffer_load_dwordx4 a[160:163], v238, s[52:55], s44 offen offset:3072 sc1
v_exp_f32 v228, v116
v_mfma_f32_16x16x32_bf16 a[84:87], a[232:235], v[196:199], a[84:87]
ds_read_b64_tr_b16 a[250:251], v13 offset:36864
v_mfma_f32_16x16x32_bf16 a[84:87], a[236:239], v[212:215], a[84:87]
v_exp_f32 v229, v117
v_mfma_f32_16x16x32_bf16 a[80:83], a[236:239], v[208:211], a[80:83]
ds_read_b64_tr_b16 a[252:253], v13 offset:40960
v_cvt_pk_bf16_f32 v154, v228, v229
v_mfma_f32_16x16x32_bf16 a[80:83], a[232:235], v[192:195], a[80:83]
s_waitcnt lgkmcnt(3)
buffer_load_dwordx4 a[164:167], v238, s[52:55], s45 offen offset:0 sc1
v_exp_f32 v230, v118
v_mfma_f32_16x16x32_bf16 a[96:99], a[240:243], v[192:195], a[96:99]
s_add_u32 s44, s16, 20480
ds_read_b64_tr_b16 a[254:255], v13 offset:45056
v_mfma_f32_16x16x32_bf16 a[96:99], a[244:247], v[208:211], a[96:99]
s_add_u32 s45, s44, 4096
v_exp_f32 v231, v119
v_mfma_f32_16x16x32_bf16 a[100:103], a[244:247], v[212:215], a[100:103]
buffer_load_dwordx4 a[168:171], v238, s[52:55], s44 offen offset:0 sc1
v_mfma_f32_16x16x32_bf16 a[100:103], a[240:243], v[196:199], a[100:103]
v_exp_f32 v224, v120
v_mfma_f32_16x16x32_bf16 a[104:107], a[240:243], v[200:203], a[104:107]
ds_read_b128 a[224:227], v2 offset:57344
v_cvt_pk_bf16_f32 v155, v230, v231
v_mfma_f32_16x16x32_bf16 a[104:107], a[244:247], v[216:219], a[104:107]
ds_read_b128 a[228:231], v3 offset:57344
v_mfma_f32_16x16x32_bf16 a[108:111], a[244:247], v[220:223], a[108:111]
v_exp_f32 v225, v121
v_mfma_f32_16x16x32_bf16 a[108:111], a[240:243], v[204:207], a[108:111]
s_waitcnt lgkmcnt(2)
buffer_load_dwordx4 a[172:175], v238, s[52:55], s44 offen offset:1024 sc1
v_mfma_f32_16x16x32_bf16 a[124:127], a[248:251], v[204:207], a[124:127]
v_exp_f32 v226, v122
v_mfma_f32_16x16x32_bf16 a[124:127], a[252:255], v[220:223], a[124:127]
ds_read_b128 a[232:235], v4 offset:57344
v_cvt_pk_bf16_f32 v156, v224, v225
v_mfma_f32_16x16x32_bf16 a[120:123], a[252:255], v[216:219], a[120:123]
v_exp_f32 v227, v123
v_mfma_f32_16x16x32_bf16 a[120:123], a[248:251], v[200:203], a[120:123]
buffer_load_dwordx4 a[176:179], v238, s[52:55], s44 offen offset:2048 sc1
v_mfma_f32_16x16x32_bf16 a[116:119], a[248:251], v[196:199], a[116:119]
v_exp_f32 v228, v124
v_mfma_f32_16x16x32_bf16 a[116:119], a[252:255], v[212:215], a[116:119]
ds_read_b128 a[236:239], v5 offset:57344
v_cvt_pk_bf16_f32 v157, v226, v227
v_mfma_f32_16x16x32_bf16 a[112:115], a[252:255], v[208:211], a[112:115]
v_exp_f32 v229, v125
v_mfma_f32_16x16x32_bf16 a[112:115], a[248:251], v[192:195], a[112:115]
v_cvt_pk_bf16_f32 v158, v228, v229
v_mfma_f32_16x16x32_bf16 a[136:139], a[144:147], v[200:203], a[136:139]
v_exp_f32 v230, v126
v_mfma_f32_16x16x32_bf16 a[136:139], a[144:147], v[216:219], a[136:139]
buffer_load_dwordx4 a[180:183], v238, s[52:55], s44 offen offset:3072 sc1
v_mfma_f32_16x16x32_bf16 a[140:143], a[144:147], v[204:207], a[140:143]
v_exp_f32 v231, v127
v_mfma_f32_16x16x32_bf16 a[140:143], a[144:147], v[220:223], a[140:143]
s_waitcnt lgkmcnt(0)
v_cvt_pk_bf16_f32 v159, v230, v231
v_mfma_f32_16x16x32_bf16 v[96:99], a[224:227], v[32:35], v[240:243]
v_exp_f32 v224, v160
v_mfma_f32_16x16x32_bf16 v[96:99], a[228:231], v[36:39], v[96:99]
buffer_load_dwordx4 a[184:187], v238, s[52:55], s45 offen offset:0 sc1
v_mfma_f32_16x16x32_bf16 v[96:99], a[232:235], v[40:43], v[96:99]
s_add_u32 s44, s16, 40960
v_exp_f32 v225, v161
v_mfma_f32_16x16x32_bf16 v[96:99], a[236:239], v[44:47], v[96:99]
s_add_u32 s45, s44, 4096
ds_read_b128 a[240:243], v2 offset:61440
v_cvt_pk_bf16_f32 v192, v224, v225
v_mfma_f32_16x16x32_bf16 v[104:107], a[236:239], v[60:63], v[244:247]
v_exp_f32 v226, v162
v_mfma_f32_16x16x32_bf16 v[104:107], a[232:235], v[56:59], v[104:107]
ds_read_b128 a[244:247], v3 offset:61440
v_mfma_f32_16x16x32_bf16 v[104:107], a[228:231], v[52:55], v[104:107]
buffer_load_dwordx4 a[188:191], v238, s[52:55], s44 offen offset:0 sc1
v_exp_f32 v227, v163
v_mfma_f32_16x16x32_bf16 v[104:107], a[224:227], v[48:51], v[104:107]
ds_read_b128 a[248:251], v4 offset:61440
v_cvt_pk_bf16_f32 v193, v226, v227
v_mfma_f32_16x16x32_bf16 v[112:115], a[224:227], v[64:67], v[248:251]
v_exp_f32 v228, v164
v_mfma_f32_16x16x32_bf16 v[112:115], a[228:231], v[68:71], v[112:115]
ds_read_b128 a[252:255], v5 offset:61440
v_mfma_f32_16x16x32_bf16 v[112:115], a[232:235], v[72:75], v[112:115]
v_exp_f32 v229, v165
v_mfma_f32_16x16x32_bf16 v[112:115], a[236:239], v[76:79], v[112:115]
buffer_load_dwordx4 a[192:195], v238, s[52:55], s44 offen offset:1024 sc1
v_mfma_f32_16x16x32_bf16 v[120:123], a[236:239], v[92:95], v[252:255]
v_exp_f32 v230, v166
v_mfma_f32_16x16x32_bf16 v[120:123], a[232:235], v[88:91], v[120:123]
v_cvt_pk_bf16_f32 v194, v228, v229
v_mfma_f32_16x16x32_bf16 v[120:123], a[228:231], v[84:87], v[120:123]
v_exp_f32 v231, v167
v_mfma_f32_16x16x32_bf16 v[120:123], a[224:227], v[80:83], v[120:123]
s_waitcnt vmcnt(40) lgkmcnt(0)
s_barrier
ds_read_b64_tr_b16 a[224:225], v6 offset:49152
v_mfma_f32_16x16x32_bf16 v[124:127], a[240:243], v[80:83], v[252:255]
v_exp_f32 v224, v168
v_mfma_f32_16x16x32_bf16 v[124:127], a[244:247], v[84:87], v[124:127]
ds_read_b64_tr_b16 a[226:227], v6 offset:53248
v_cvt_pk_bf16_f32 v195, v230, v231
v_mfma_f32_16x16x32_bf16 v[124:127], a[248:251], v[88:91], v[124:127]
v_exp_f32 v225, v169
v_mfma_f32_16x16x32_bf16 v[124:127], a[252:255], v[92:95], v[124:127]
buffer_load_dwordx4 a[196:199], v238, s[52:55], s44 offen offset:2048 sc1
v_mfma_f32_16x16x32_bf16 v[116:119], a[252:255], v[76:79], v[248:251]
ds_read_b64_tr_b16 a[228:229], v6 offset:57344
v_cvt_pk_bf16_f32 v196, v224, v225
v_mfma_f32_16x16x32_bf16 v[116:119], a[248:251], v[72:75], v[116:119]
v_exp_f32 v226, v170
v_mfma_f32_16x16x32_bf16 v[116:119], a[244:247], v[68:71], v[116:119]
buffer_load_dwordx4 a[200:203], v238, s[52:55], s44 offen offset:3072 sc1
v_mfma_f32_16x16x32_bf16 v[116:119], a[240:243], v[64:67], v[116:119]
v_exp_f32 v227, v171
v_mfma_f32_16x16x32_bf16 v[108:111], a[240:243], v[48:51], v[244:247]
ds_read_b64_tr_b16 a[230:231], v6 offset:61440
v_cvt_pk_bf16_f32 v197, v226, v227
v_mfma_f32_16x16x32_bf16 v[108:111], a[244:247], v[52:55], v[108:111]
v_exp_f32 v228, v172
v_mfma_f32_16x16x32_bf16 v[108:111], a[248:251], v[56:59], v[108:111]
buffer_load_dwordx4 a[204:207], v238, s[52:55], s45 offen offset:0 sc1
v_mfma_f32_16x16x32_bf16 v[108:111], a[252:255], v[60:63], v[108:111]
s_add_u32 s44, s17, 122880
v_exp_f32 v229, v173
v_mfma_f32_16x16x32_bf16 v[100:103], a[252:255], v[44:47], v[240:243]
s_add_u32 m0, s69, 98304
ds_read_b64_tr_b16 a[232:233], v7 offset:49152
v_cvt_pk_bf16_f32 v198, v228, v229
v_mfma_f32_16x16x32_bf16 v[100:103], a[248:251], v[40:43], v[100:103]
v_exp_f32 v230, v174
v_mfma_f32_16x16x32_bf16 v[100:103], a[244:247], v[36:39], v[100:103]
ds_read_b64_tr_b16 a[234:235], v7 offset:53248
L_hop2_2:
s_cbranch_execz L_hop_ret2
v_mfma_f32_16x16x32_bf16 v[100:103], a[240:243], v[32:35], v[100:103]
s_waitcnt lgkmcnt(2)
ds_read_b64_tr_b16 a[236:237], v7 offset:57344
v_mfma_f32_16x16x32_bf16 a[0:3], a[224:227], v[128:131], a[0:3]
buffer_load_dwordx4 v238, s[52:55], s44 offen sc1 lds
v_exp_f32 v231, v175
v_mfma_f32_16x16x32_bf16 a[0:3], a[228:231], v[144:147], a[0:3]
ds_read_b64_tr_b16 a[238:239], v7 offset:61440
v_cvt_pk_bf16_f32 v199, v230, v231
v_mfma_f32_16x16x32_bf16 a[4:7], a[228:231], v[148:151], a[4:7]
v_exp_f32 v224, v176
v_mfma_f32_16x16x32_bf16 a[4:7], a[224:227], v[132:135], a[4:7]
ds_read_b64_tr_b16 a[240:241], v8 offset:49152
v_mfma_f32_16x16x32_bf16 a[8:11], a[224:227], v[136:139], a[8:11]
buffer_load_dwordx4 v238, s[52:55], s44 offen offset:1024 sc1 lds
v_exp_f32 v225, v177
v_mfma_f32_16x16x32_bf16 a[8:11], a[228:231], v[152:155], a[8:11]
ds_read_b64_tr_b16 a[242:243], v8 offset:53248
v_cvt_pk_bf16_f32 v200, v224, v225
v_mfma_f32_16x16x32_bf16 a[12:15], a[228:231], v[156:159], a[12:15]
v_exp_f32 v226, v178
v_mfma_f32_16x16x32_bf16 a[12:15], a[224:227], v[140:143], a[12:15]
s_waitcnt lgkmcnt(2)
ds_read_b64_tr_b16 a[244:245], v8 offset:57344
v_mfma_f32_16x16x32_bf16 a[28:31], a[232:235], v[140:143], a[28:31]
buffer_load_dwordx4 v238, s[52:55], s44 offen offset:2048 sc1 lds
v_exp_f32 v227, v179
v_mfma_f32_16x16x32_bf16 a[28:31], a[236:239], v[156:159], a[28:31]
ds_read_b64_tr_b16 a[246:247], v8 offset:61440
v_cvt_pk_bf16_f32 v201, v226, v227
v_mfma_f32_16x16x32_bf16 a[24:27], a[236:239], v[152:155], a[24:27]
ds_read_b64_tr_b16 a[248:249], v9 offset:49152
v_mfma_f32_16x16x32_bf16 a[24:27], a[232:235], v[136:139], a[24:27]
v_exp_f32 v228, v180
v_mfma_f32_16x16x32_bf16 a[20:23], a[232:235], v[132:135], a[20:23]
ds_read_b64_tr_b16 a[250:251], v9 offset:53248
v_mfma_f32_16x16x32_bf16 a[20:23], a[236:239], v[148:151], a[20:23]
buffer_load_dwordx4 v238, s[52:55], s44 offen offset:3072 sc1 lds
v_exp_f32 v229, v181
v_mfma_f32_16x16x32_bf16 a[16:19], a[236:239], v[144:147], a[16:19]
s_add_u32 s44, s16, 61440
ds_read_b64_tr_b16 a[252:253], v9 offset:57344
v_cvt_pk_bf16_f32 v202, v228, v229
v_mfma_f32_16x16x32_bf16 a[16:19], a[232:235], v[128:131], a[16:19]
s_waitcnt lgkmcnt(3)
v_exp_f32 v230, v182
v_mfma_f32_16x16x32_bf16 a[32:35], a[240:243], v[128:131], a[32:35]
s_add_u32 s45, s44, 4096
ds_read_b64_tr_b16 a[254:255], v9 offset:61440
v_mfma_f32_16x16x32_bf16 a[32:35], a[244:247], v[144:147], a[32:35]
buffer_load_dwordx4 a[208:211], v238, s[52:55], s44 offen offset:0 sc1
v_exp_f32 v231, v183
v_mfma_f32_16x16x32_bf16 a[36:39], a[244:247], v[148:151], a[36:39]
ds_read_b64_tr_b16 a[224:225], v10 offset:49152
v_cvt_pk_bf16_f32 v203, v230, v231
v_mfma_f32_16x16x32_bf16 a[36:39], a[240:243], v[132:135], a[36:39]
v_exp_f32 v224, v184
v_mfma_f32_16x16x32_bf16 a[40:43], a[240:243], v[136:139], a[40:43]
buffer_load_dwordx4 a[212:215], v238, s[52:55], s44 offen offset:1024 sc1
v_mfma_f32_16x16x32_bf16 a[40:43], a[244:247], v[152:155], a[40:43]
ds_read_b64_tr_b16 a[226:227], v10 offset:53248
v_mfma_f32_16x16x32_bf16 a[44:47], a[244:247], v[156:159], a[44:47]
v_exp_f32 v225, v185
v_mfma_f32_16x16x32_bf16 a[44:47], a[240:243], v[140:143], a[44:47]
s_waitcnt lgkmcnt(2)
ds_read_b64_tr_b16 a[228:229], v10 offset:57344
v_cvt_pk_bf16_f32 v204, v224, v225
v_mfma_f32_16x16x32_bf16 a[60:63], a[248:251], v[140:143], a[60:63]
v_exp_f32 v226, v186
v_mfma_f32_16x16x32_bf16 a[60:63], a[252:255], v[156:159], a[60:63]
buffer_load_dwordx4 a[216:219], v238, s[52:55], s44 offen offset:2048 sc1
v_mfma_f32_16x16x32_bf16 a[56:59], a[252:255], v[152:155], a[56:59]
v_exp_f32 v227, v187
v_mfma_f32_16x16x32_bf16 a[56:59], a[248:251], v[136:139], a[56:59]
ds_read_b64_tr_b16 a[230:231], v10 offset:61440
v_cvt_pk_bf16_f32 v205, v226, v227
v_mfma_f32_16x16x32_bf16 a[52:55], a[248:251], v[132:135], a[52:55]
v_exp_f32 v228, v188
v_mfma_f32_16x16x32_bf16 a[52:55], a[252:255], v[148:151], a[52:55]
buffer_load_dwordx4 a[220:223], v238, s[52:55], s44 offen offset:3072 sc1
v_mfma_f32_16x16x32_bf16 a[48:51], a[252:255], v[144:147], a[48:51]
v_exp_f32 v229, v189
v_mfma_f32_16x16x32_bf16 a[48:51], a[248:251], v[128:131], a[48:51]
ds_read_b64_tr_b16 a[232:233], v11 offset:49152
v_cvt_pk_bf16_f32 v206, v228, v229
v_mfma_f32_16x16x32_bf16 a[128:131], a[144:147], v[128:131], a[128:131]
v_exp_f32 v230, v190
v_mfma_f32_16x16x32_bf16 a[128:131], a[144:147], v[144:147], a[128:131]
buffer_load_dwordx4 v[32:35], v238, s[52:55], s45 offen offset:0 sc1
v_mfma_f32_16x16x32_bf16 a[132:135], a[144:147], v[132:135], a[132:135]
s_add_u32 s44, s16, 81920
v_exp_f32 v231, v191
v_mfma_f32_16x16x32_bf16 a[132:135], a[144:147], v[148:151], a[132:135]
s_waitcnt lgkmcnt(1)
ds_read_b64_tr_b16 a[234:235], v11 offset:53248
v_cvt_pk_bf16_f32 v207, v230, v231
v_mfma_f32_16x16x32_bf16 a[64:67], a[224:227], v[128:131], a[64:67]
s_add_u32 s45, s44, 4096
ds_read_b64_tr_b16 a[236:237], v11 offset:57344
v_exp_f32 v224, v96
v_mfma_f32_16x16x32_bf16 a[64:67], a[228:231], v[144:147], a[64:67]
ds_read_b64_tr_b16 a[238:239], v11 offset:61440
v_exp_f32 v225, v97
v_mfma_f32_16x16x32_bf16 a[68:71], a[228:231], v[148:151], a[68:71]
buffer_load_dwordx4 v[36:39], v238, s[52:55], s44 offen offset:0 sc1
v_cvt_pk_bf16_f32 v208, v224, v225
v_exp_f32 v226, v98
v_mfma_f32_16x16x32_bf16 a[68:71], a[224:227], v[132:135], a[68:71]
ds_read_b64_tr_b16 a[240:241], v12 offset:49152
v_exp_f32 v227, v99
v_mfma_f32_16x16x32_bf16 a[72:75], a[224:227], v[136:139], a[72:75]
ds_read_b64_tr_b16 a[242:243], v12 offset:53248
v_cvt_pk_bf16_f32 v209, v226, v227
v_exp_f32 v228, v100
v_mfma_f32_16x16x32_bf16 a[72:75], a[228:231], v[152:155], a[72:75]
buffer_load_dwordx4 v[40:43], v238, s[52:55], s44 offen offset:1024 sc1
v_exp_f32 v229, v101
v_mfma_f32_16x16x32_bf16 a[76:79], a[228:231], v[156:159], a[76:79]
ds_read_b64_tr_b16 a[244:245], v12 offset:57344
v_cvt_pk_bf16_f32 v210, v228, v229
v_exp_f32 v230, v102
v_mfma_f32_16x16x32_bf16 a[76:79], a[224:227], v[140:143], a[76:79]
s_waitcnt lgkmcnt(3)
ds_read_b64_tr_b16 a[246:247], v12 offset:61440
v_exp_f32 v231, v103
v_mfma_f32_16x16x32_bf16 a[92:95], a[232:235], v[140:143], a[92:95]
ds_read_b64_tr_b16 a[248:249], v13 offset:49152
v_cvt_pk_bf16_f32 v211, v230, v231
v_exp_f32 v224, v104
v_mfma_f32_16x16x32_bf16 a[92:95], a[236:239], v[156:159], a[92:95]
buffer_load_dwordx4 v[44:47], v238, s[52:55], s44 offen offset:2048 sc1
v_exp_f32 v225, v105
v_mfma_f32_16x16x32_bf16 a[88:91], a[236:239], v[152:155], a[88:91]
ds_read_b64_tr_b16 a[250:251], v13 offset:53248
v_cvt_pk_bf16_f32 v212, v224, v225
v_exp_f32 v226, v106
v_mfma_f32_16x16x32_bf16 a[88:91], a[232:235], v[136:139], a[88:91]
ds_read_b64_tr_b16 a[252:253], v13 offset:57344
v_exp_f32 v227, v107
v_mfma_f32_16x16x32_bf16 a[84:87], a[232:235], v[132:135], a[84:87]
ds_read_b64_tr_b16 a[254:255], v13 offset:61440
v_cvt_pk_bf16_f32 v213, v226, v227
v_exp_f32 v228, v108
v_mfma_f32_16x16x32_bf16 a[84:87], a[236:239], v[148:151], a[84:87]
v_exp_f32 v229, v109
v_mfma_f32_16x16x32_bf16 a[80:83], a[236:239], v[144:147], a[80:83]
buffer_load_dwordx4 v[48:51], v238, s[52:55], s44 offen offset:3072 sc1
v_cvt_pk_bf16_f32 v214, v228, v229
v_exp_f32 v230, v110
v_mfma_f32_16x16x32_bf16 a[80:83], a[232:235], v[128:131], a[80:83]
s_waitcnt lgkmcnt(4)
v_exp_f32 v231, v111
v_mfma_f32_16x16x32_bf16 a[96:99], a[240:243], v[128:131], a[96:99]
v_cvt_pk_bf16_f32 v215, v230, v231
v_exp_f32 v224, v112
v_mfma_f32_16x16x32_bf16 a[96:99], a[244:247], v[144:147], a[96:99]
v_exp_f32 v225, v113
v_mfma_f32_16x16x32_bf16 a[100:103], a[244:247], v[148:151], a[100:103]
buffer_load_dwordx4 v[52:55], v238, s[52:55], s45 offen offset:0 sc1
v_cvt_pk_bf16_f32 v216, v224, v225
v_exp_f32 v226, v114
v_mfma_f32_16x16x32_bf16 a[100:103], a[240:243], v[132:135], a[100:103]
s_add_u32 s44, s16, 102400
v_exp_f32 v227, v115
v_mfma_f32_16x16x32_bf16 a[104:107], a[240:243], v[136:139], a[104:107]
s_add_u32 s45, s44, 4096
v_cvt_pk_bf16_f32 v217, v226, v227
v_exp_f32 v228, v116
v_mfma_f32_16x16x32_bf16 a[104:107], a[244:247], v[152:155], a[104:107]
v_exp_f32 v229, v117
v_mfma_f32_16x16x32_bf16 a[108:111], a[244:247], v[156:159], a[108:111]
buffer_load_dwordx4 v[56:59], v238, s[52:55], s44 offen offset:0 sc1
v_cvt_pk_bf16_f32 v218, v228, v229
v_exp_f32 v230, v118
v_mfma_f32_16x16x32_bf16 a[108:111], a[240:243], v[140:143], a[108:111]
s_waitcnt lgkmcnt(0)
v_exp_f32 v231, v119
v_mfma_f32_16x16x32_bf16 a[124:127], a[248:251], v[140:143], a[124:127]
v_cvt_pk_bf16_f32 v219, v230, v231
v_exp_f32 v224, v120
v_mfma_f32_16x16x32_bf16 a[124:127], a[252:255], v[156:159], a[124:127]
v_exp_f32 v225, v121
v_mfma_f32_16x16x32_bf16 a[120:123], a[252:255], v[152:155], a[120:123]
s_waitcnt vmcnt(54)
s_barrier
ds_read_b64_tr_b16 a[224:225], v6 offset:16384
v_cvt_pk_bf16_f32 v220, v224, v225
v_exp_f32 v226, v122
v_mfma_f32_16x16x32_bf16 a[120:123], a[248:251], v[136:139], a[120:123]
ds_read_b64_tr_b16 a[226:227], v6 offset:20480
v_exp_f32 v227, v123
v_mfma_f32_16x16x32_bf16 a[116:119], a[248:251], v[132:135], a[116:119]
ds_read_b64_tr_b16 a[228:229], v6 offset:24576
v_cvt_pk_bf16_f32 v221, v226, v227
v_exp_f32 v228, v124
v_mfma_f32_16x16x32_bf16 a[116:119], a[252:255], v[148:151], a[116:119]
buffer_load_dwordx4 v[60:63], v238, s[52:55], s44 offen offset:1024 sc1
v_exp_f32 v229, v125
v_mfma_f32_16x16x32_bf16 a[112:115], a[252:255], v[144:147], a[112:115]
ds_read_b64_tr_b16 a[230:231], v6 offset:28672
v_cvt_pk_bf16_f32 v222, v228, v229
v_exp_f32 v230, v126
v_mfma_f32_16x16x32_bf16 a[112:115], a[248:251], v[128:131], a[112:115]
v_exp_f32 v231, v127
v_mfma_f32_16x16x32_bf16 a[136:139], a[144:147], v[136:139], a[136:139]
v_cvt_pk_bf16_f32 v223, v230, v231
v_mfma_f32_16x16x32_bf16 a[136:139], a[144:147], v[152:155], a[136:139]
buffer_load_dwordx4 v[64:67], v238, s[52:55], s44 offen offset:2048 sc1
v_mfma_f32_16x16x32_bf16 a[140:143], a[144:147], v[140:143], a[140:143]
ds_read_b64_tr_b16 a[232:233], v7 offset:16384
v_mfma_f32_16x16x32_bf16 a[140:143], a[144:147], v[156:159], a[140:143]
ds_read_b64_tr_b16 a[234:235], v7 offset:20480
v_mfma_f32_16x16x32_bf16 a[128:131], a[144:147], v[192:195], a[128:131]
ds_read_b64_tr_b16 a[236:237], v7 offset:24576
v_mov_b32 v23, s60
v_mfma_f32_16x16x32_bf16 a[128:131], a[144:147], v[208:211], a[128:131]
buffer_load_dwordx4 v[68:71], v238, s[52:55], s44 offen offset:3072 sc1
v_mfma_f32_16x16x32_bf16 a[132:135], a[144:147], v[196:199], a[132:135]
ds_read_b64_tr_b16 a[238:239], v7 offset:28672
v_lshlrev_b32 v23, 2, v23
v_mfma_f32_16x16x32_bf16 a[132:135], a[144:147], v[212:215], a[132:135]
v_mov_b32 v21, 0
v_mfma_f32_16x16x32_bf16 a[136:139], a[144:147], v[200:203], a[136:139]
v_mfma_f32_16x16x32_bf16 a[136:139], a[144:147], v[216:219], a[136:139]
buffer_load_dwordx4 v[72:75], v238, s[52:55], s45 offen offset:0 sc1
v_mfma_f32_16x16x32_bf16 a[140:143], a[144:147], v[204:207], a[140:143]
s_add_u32 s44, s16, 122880
ds_read_b64_tr_b16 a[240:241], v8 offset:16384
v_mfma_f32_16x16x32_bf16 a[140:143], a[144:147], v[220:223], a[140:143]
s_waitcnt lgkmcnt(5)
ds_read_b64_tr_b16 a[242:243], v8 offset:20480
v_mfma_f32_16x16x32_bf16 a[0:3], a[224:227], v[192:195], a[0:3]
s_add_u32 s45, s44, 4096
ds_read_b64_tr_b16 a[244:245], v8 offset:24576
v_mfma_f32_16x16x32_bf16 a[0:3], a[228:231], v[208:211], a[0:3]
ds_read_b64_tr_b16 a[246:247], v8 offset:28672
v_mfma_f32_16x16x32_bf16 a[4:7], a[228:231], v[212:215], a[4:7]
buffer_load_dwordx4 v[76:79], v238, s[52:55], s44 offen offset:0 sc1
v_mfma_f32_16x16x32_bf16 a[4:7], a[224:227], v[196:199], a[4:7]
v_accvgpr_read_b32 v224, a128
v_accvgpr_read_b32 v225, a132
v_mfma_f32_16x16x32_bf16 a[8:11], a[224:227], v[200:203], a[8:11]
v_accvgpr_read_b32 v226, a136
v_accvgpr_read_b32 v227, a140
v_mfma_f32_16x16x32_bf16 a[8:11], a[228:231], v[216:219], a[8:11]
v_rcp_f32 v24, v224
v_rcp_f32 v26, v225
v_mfma_f32_16x16x32_bf16 a[12:15], a[228:231], v[220:223], a[12:15]
buffer_load_dwordx4 v[80:83], v238, s[52:55], s44 offen offset:1024 sc1
v_mfma_f32_16x16x32_bf16 a[12:15], a[224:227], v[204:207], a[12:15]
s_waitcnt lgkmcnt(4)
ds_read_b64_tr_b16 a[248:249], v9 offset:16384
v_rcp_f32 v28, v226
v_mfma_f32_16x16x32_bf16 a[28:31], a[232:235], v[204:207], a[28:31]
ds_read_b64_tr_b16 a[250:251], v9 offset:20480
v_rcp_f32 v30, v227
v_mfma_f32_16x16x32_bf16 a[28:31], a[236:239], v[220:223], a[28:31]
ds_read_b64_tr_b16 a[252:253], v9 offset:24576
v_add_f32 v224, v224, v225
v_mfma_f32_16x16x32_bf16 a[24:27], a[236:239], v[216:219], a[24:27]
s_waitcnt vmcnt(40)
buffer_load_dwordx4 v[84:87], v238, s[52:55], s44 offen offset:2048 sc1
v_mfma_f32_16x16x32_bf16 a[24:27], a[232:235], v[200:203], a[24:27]
ds_read_b64_tr_b16 a[254:255], v9 offset:28672
v_add_f32 v226, v226, v227
v_mfma_f32_16x16x32_bf16 a[20:23], a[232:235], v[196:199], a[20:23]
v_add_f32 v224, v224, v226
v_cmp_nlt_f32 vcc, v224, s77
v_mfma_f32_16x16x32_bf16 a[20:23], a[236:239], v[212:215], a[20:23]
v_mov_b32 v25, v24
v_mov_b32 v27, v26
v_mfma_f32_16x16x32_bf16 a[16:19], a[236:239], v[208:211], a[16:19]
buffer_load_dwordx4 v[88:91], v238, s[52:55], s44 offen offset:3072 sc1
v_mfma_f32_16x16x32_bf16 a[16:19], a[232:235], v[192:195], a[16:19]
s_waitcnt lgkmcnt(4)
ds_read_b64_tr_b16 a[224:225], v10 offset:16384
v_mov_b32 v29, v28
v_mfma_f32_16x16x32_bf16 a[32:35], a[240:243], v[192:195], a[32:35]
ds_read_b64_tr_b16 a[226:227], v10 offset:20480
v_mov_b32 v31, v30
v_mfma_f32_16x16x32_bf16 a[32:35], a[244:247], v[208:211], a[32:35]
ds_read_b64_tr_b16 a[228:229], v10 offset:24576
s_or_b32 s8, vcc_lo, vcc_hi
v_mfma_f32_16x16x32_bf16 a[36:39], a[244:247], v[212:215], a[36:39]
ds_read_b64_tr_b16 a[230:231], v10 offset:28672
v_mov_b32 v22, s8
v_mfma_f32_16x16x32_bf16 a[36:39], a[240:243], v[196:199], a[36:39]
buffer_load_dwordx4 v[92:95], v238, s[52:55], s45 offen offset:0 sc1
v_mfma_f32_16x16x32_bf16 a[40:43], a[240:243], v[200:203], a[40:43]
s_add_u32 s44, s17, 0
ds_write_b32 v23, v22 offset:49152
s_xor_b32 s66, s74, 0
v_mfma_f32_16x16x32_bf16 a[40:43], a[244:247], v[216:219], a[40:43]
s_add_u32 s45, s44, 4096
v_accvgpr_read_b32 v160, a0
v_mfma_f32_16x16x32_bf16 a[44:47], a[244:247], v[220:223], a[44:47]
ds_read_b64_tr_b16 a[232:233], v11 offset:16384
v_accvgpr_read_b32 v161, a1
v_mfma_f32_16x16x32_bf16 a[44:47], a[240:243], v[204:207], a[44:47]
s_waitcnt lgkmcnt(6)
buffer_load_dwordx4 v[240:243], v238, s[52:55], s44 offen offset:0 sc1
v_mfma_f32_16x16x32_bf16 a[60:63], a[248:251], v[204:207], a[60:63]
ds_read_b64_tr_b16 a[234:235], v11 offset:20480
v_accvgpr_read_b32 v162, a2
v_mfma_f32_16x16x32_bf16 a[60:63], a[252:255], v[220:223], a[60:63]
ds_read_b64_tr_b16 a[236:237], v11 offset:24576
v_accvgpr_read_b32 v163, a3
v_mfma_f32_16x16x32_bf16 a[56:59], a[252:255], v[216:219], a[56:59]
ds_read_b64_tr_b16 a[238:239], v11 offset:28672
v_accvgpr_read_b32 v164, a16
v_mfma_f32_16x16x32_bf16 a[56:59], a[248:251], v[200:203], a[56:59]
buffer_load_dwordx4 v[244:247], v238, s[52:55], s44 offen offset:1024 sc1
v_mfma_f32_16x16x32_bf16 a[52:55], a[248:251], v[196:199], a[52:55]
v_accvgpr_read_b32 v165, a17
v_accvgpr_read_b32 v166, a18
v_mfma_f32_16x16x32_bf16 a[52:55], a[252:255], v[212:215], a[52:55]
v_accvgpr_read_b32 v167, a19
v_mul_f32 v160, v24, v160
v_mfma_f32_16x16x32_bf16 a[48:51], a[252:255], v[208:211], a[48:51]
ds_read_b64_tr_b16 a[240:241], v12 offset:16384
v_mul_f32 v161, v24, v161
v_mfma_f32_16x16x32_bf16 a[48:51], a[248:251], v[192:195], a[48:51]
s_waitcnt lgkmcnt(6)
ds_read_b64_tr_b16 a[242:243], v12 offset:20480
v_mul_f32 v162, v24, v162
v_mfma_f32_16x16x32_bf16 a[64:67], a[224:227], v[192:195], a[64:67]
buffer_load_dwordx4 v[248:251], v238, s[52:55], s44 offen offset:2048 sc1
v_mfma_f32_16x16x32_bf16 a[64:67], a[228:231], v[208:211], a[64:67]
ds_read_b64_tr_b16 a[244:245], v12 offset:24576
v_mul_f32 v163, v24, v163
v_mfma_f32_16x16x32_bf16 a[68:71], a[228:231], v[212:215], a[68:71]
ds_read_b64_tr_b16 a[246:247], v12 offset:28672
v_mul_f32 v164, v24, v164
v_mfma_f32_16x16x32_bf16 a[68:71], a[224:227], v[196:199], a[68:71]
v_mul_f32 v165, v24, v165
v_mul_f32 v166, v24, v166
v_mfma_f32_16x16x32_bf16 a[72:75], a[224:227], v[200:203], a[72:75]
buffer_load_dwordx4 v[252:255], v238, s[52:55], s44 offen offset:3072 sc1
v_mfma_f32_16x16x32_bf16 a[72:75], a[228:231], v[216:219], a[72:75]
v_mul_f32 v167, v24, v167
v_cvt_pk_bf16_f32 v96, v160, v161
v_mfma_f32_16x16x32_bf16 a[76:79], a[228:231], v[220:223], a[76:79]
ds_read_b64_tr_b16 a[248:249], v13 offset:16384
v_cvt_pk_bf16_f32 v97, v162, v163
v_mfma_f32_16x16x32_bf16 a[76:79], a[224:227], v[204:207], a[76:79]
s_waitcnt lgkmcnt(5)
ds_read_b64_tr_b16 a[250:251], v13 offset:20480
v_cvt_pk_bf16_f32 v98, v164, v165
v_mfma_f32_16x16x32_bf16 a[92:95], a[232:235], v[204:207], a[92:95]
buffer_load_dwordx4 v[112:115], v238, s[52:55], s45 offen offset:0 sc1
v_mfma_f32_16x16x32_bf16 a[92:95], a[236:239], v[220:223], a[92:95]
s_add_u32 s44, s17, 40960
ds_read_b64_tr_b16 a[252:253], v13 offset:24576
v_cvt_pk_bf16_f32 v99, v166, v167
v_mfma_f32_16x16x32_bf16 a[88:91], a[236:239], v[216:219], a[88:91]
s_add_u32 s45, s44, 4096
ds_read_b64_tr_b16 a[254:255], v13 offset:28672
buffer_store_dwordx4 v[96:99], v238, s[52:55], s66 offen offset:0 sc1
v_mfma_f32_16x16x32_bf16 a[88:91], a[232:235], v[200:203], a[88:91]
v_accvgpr_read_b32 v168, a4
v_mfma_f32_16x16x32_bf16 a[84:87], a[232:235], v[196:199], a[84:87]
buffer_load_dwordx4 v[116:119], v238, s[52:55], s44 offen offset:0 sc1
v_mfma_f32_16x16x32_bf16 a[84:87], a[236:239], v[212:215], a[84:87]
v_accvgpr_read_b32 v169, a5
v_accvgpr_read_b32 v170, a6
v_mfma_f32_16x16x32_bf16 a[80:83], a[236:239], v[208:211], a[80:83]
v_accvgpr_read_b32 v171, a7
v_accvgpr_read_b32 v172, a20
v_mfma_f32_16x16x32_bf16 a[80:83], a[232:235], v[192:195], a[80:83]
s_waitcnt lgkmcnt(4)
v_accvgpr_read_b32 v173, a21
v_accvgpr_read_b32 v174, a22
v_mfma_f32_16x16x32_bf16 a[96:99], a[240:243], v[192:195], a[96:99]
v_accvgpr_read_b32 v175, a23
v_mul_f32 v168, v26, v168
v_mfma_f32_16x16x32_bf16 a[96:99], a[244:247], v[208:211], a[96:99]
buffer_load_dwordx4 v[120:123], v238, s[52:55], s44 offen offset:1024 sc1
v_mfma_f32_16x16x32_bf16 a[100:103], a[244:247], v[212:215], a[100:103]
v_mul_f32 v169, v26, v169
v_mul_f32 v170, v26, v170
v_mfma_f32_16x16x32_bf16 a[100:103], a[240:243], v[196:199], a[100:103]
v_mul_f32 v171, v26, v171
v_mul_f32 v172, v26, v172
v_mfma_f32_16x16x32_bf16 a[104:107], a[240:243], v[200:203], a[104:107]
v_mul_f32 v173, v26, v173
v_mul_f32 v174, v26, v174
v_mfma_f32_16x16x32_bf16 a[104:107], a[244:247], v[216:219], a[104:107]
buffer_load_dwordx4 v[124:127], v238, s[52:55], s44 offen offset:2048 sc1
v_mfma_f32_16x16x32_bf16 a[108:111], a[244:247], v[220:223], a[108:111]
v_mul_f32 v175, v26, v175
v_cvt_pk_bf16_f32 v100, v168, v169
v_mfma_f32_16x16x32_bf16 a[108:111], a[240:243], v[204:207], a[108:111]
s_waitcnt lgkmcnt(0)
v_cvt_pk_bf16_f32 v101, v170, v171
v_cvt_pk_bf16_f32 v102, v172, v173
v_mfma_f32_16x16x32_bf16 a[124:127], a[248:251], v[204:207], a[124:127]
v_cvt_pk_bf16_f32 v103, v174, v175
buffer_store_dwordx4 v[100:103], v238, s[52:55], s66 offen offset:1024 sc1
v_mfma_f32_16x16x32_bf16 a[124:127], a[252:255], v[220:223], a[124:127]
buffer_load_dwordx4 v[128:131], v238, s[52:55], s44 offen offset:3072 sc1
v_mfma_f32_16x16x32_bf16 a[120:123], a[252:255], v[216:219], a[120:123]
s_xor_b32 s66, s74, 4096
v_mfma_f32_16x16x32_bf16 a[120:123], a[248:251], v[200:203], a[120:123]
v_accvgpr_read_b32 v176, a32
v_accvgpr_read_b32 v177, a33
v_mfma_f32_16x16x32_bf16 a[116:119], a[248:251], v[196:199], a[116:119]
v_accvgpr_read_b32 v178, a34
v_accvgpr_read_b32 v179, a35
v_mfma_f32_16x16x32_bf16 a[116:119], a[252:255], v[212:215], a[116:119]
buffer_load_dwordx4 v[132:135], v238, s[52:55], s45 offen offset:0 sc1
v_mfma_f32_16x16x32_bf16 a[112:115], a[252:255], v[208:211], a[112:115]
s_add_u32 s44, s17, 81920
v_accvgpr_read_b32 v180, a48
v_accvgpr_read_b32 v181, a49
v_mfma_f32_16x16x32_bf16 a[112:115], a[248:251], v[192:195], a[112:115]
s_add_u32 s45, s44, 4096
v_accvgpr_read_b32 v182, a50
v_accvgpr_read_b32 v183, a51
s_barrier
ds_read_b128 v[224:227], v21 offset:49152
v_mul_f32 v176, v24, v176
v_mul_f32 v177, v24, v177
v_mul_f32 v178, v24, v178
v_mul_f32 v179, v24, v179
v_mul_f32 v180, v24, v180
v_mul_f32 v181, v24, v181
v_mul_f32 v182, v24, v182
v_mul_f32 v183, v24, v183
v_cvt_pk_bf16_f32 v104, v176, v177
v_cvt_pk_bf16_f32 v105, v178, v179
v_cvt_pk_bf16_f32 v106, v180, v181
v_cvt_pk_bf16_f32 v107, v182, v183
buffer_store_dwordx4 v[104:107], v238, s[52:55], s66 offen offset:0 sc1
v_accvgpr_read_b32 v184, a36
v_accvgpr_read_b32 v185, a37
v_accvgpr_read_b32 v186, a38
v_accvgpr_read_b32 v187, a39
v_accvgpr_read_b32 v188, a52
v_accvgpr_read_b32 v189, a53
v_accvgpr_read_b32 v190, a54
v_accvgpr_read_b32 v191, a55
v_pk_mul_f32 v[184:185], v[26:27], v[184:185]
v_pk_mul_f32 v[186:187], v[26:27], v[186:187]
v_pk_mul_f32 v[188:189], v[26:27], v[188:189]
v_pk_mul_f32 v[190:191], v[26:27], v[190:191]
v_cvt_pk_bf16_f32 v108, v184, v185
v_cvt_pk_bf16_f32 v109, v186, v187
v_cvt_pk_bf16_f32 v110, v188, v189
v_cvt_pk_bf16_f32 v111, v190, v191
s_waitcnt lgkmcnt(0)
v_or3_b32 v224, v224, v225, v226
v_or_b32 v224, v224, v227
buffer_store_dwordx4 v[108:111], v238, s[52:55], s66 offen offset:1024 sc1
s_xor_b32 s66, s74, 8192
v_readfirstlane_b32 s8, v224
v_accvgpr_read_b32 v160, a64
v_accvgpr_read_b32 v161, a65
v_accvgpr_read_b32 v162, a66
s_andn2_b32 s8, s8, s73
s_cbranch_scc1 L_fallback
v_accvgpr_read_b32 v163, a67
v_accvgpr_read_b32 v164, a80
v_accvgpr_read_b32 v165, a81
v_accvgpr_read_b32 v166, a82
buffer_load_dwordx4 v[136:139], v238, s[52:55], s44 offen offset:0 sc1
buffer_load_dwordx4 v[140:143], v238, s[52:55], s44 offen offset:1024 sc1
buffer_load_dwordx4 v[144:147], v238, s[52:55], s44 offen offset:2048 sc1
s_waitcnt vmcnt(40)
buffer_load_dwordx4 v[148:151], v238, s[52:55], s44 offen offset:3072 sc1
buffer_load_dwordx4 v[152:155], v238, s[52:55], s45 offen offset:0 sc1
s_add_u32 s44, s17, 122880
s_add_u32 s45, s44, 4096
buffer_load_dwordx4 v[156:159], v238, s[52:55], s45 offen offset:0 sc1
v_lshrrev_b32 v21, 2, v1
v_min_u32 v21, 1, v21
v_lshlrev_b32 v21, 28, v21
v_lshl_add_u32 v12, v1, 8, v21
s_and_b32 s9, s60, 1
s_lshl_b32 s9, s9, 13
s_add_u32 s28, s28, s9
s_lshr_b32 s9, s60, 1
s_lshl_b32 s9, s9, 10
s_add_u32 s28, s28, s9
s_add_u32 s29, s28, 4096
v_accvgpr_read_b32 v167, a83
v_pk_mul_f32 v[160:161], v[24:25], v[160:161]
v_pk_mul_f32 v[162:163], v[24:25], v[162:163]
v_pk_mul_f32 v[164:165], v[24:25], v[164:165]
v_pk_mul_f32 v[166:167], v[24:25], v[166:167]
v_cvt_pk_bf16_f32 v96, v160, v161
v_cvt_pk_bf16_f32 v97, v162, v163
v_cvt_pk_bf16_f32 v98, v164, v165
v_cvt_pk_bf16_f32 v99, v166, v167
buffer_store_dwordx4 v[96:99], v238, s[52:55], s66 offen offset:0 sc1
v_accvgpr_read_b32 v168, a68
v_accvgpr_read_b32 v169, a69
v_accvgpr_read_b32 v170, a70
v_accvgpr_read_b32 v171, a71
v_accvgpr_read_b32 v172, a84
v_accvgpr_read_b32 v173, a85
v_accvgpr_read_b32 v174, a86
v_accvgpr_read_b32 v175, a87
v_pk_mul_f32 v[168:169], v[26:27], v[168:169]
v_pk_mul_f32 v[170:171], v[26:27], v[170:171]
v_pk_mul_f32 v[172:173], v[26:27], v[172:173]
v_pk_mul_f32 v[174:175], v[26:27], v[174:175]
v_cvt_pk_bf16_f32 v100, v168, v169
v_cvt_pk_bf16_f32 v101, v170, v171
v_cvt_pk_bf16_f32 v102, v172, v173
v_cvt_pk_bf16_f32 v103, v174, v175
buffer_store_dwordx4 v[100:103], v238, s[52:55], s66 offen offset:1024 sc1
s_xor_b32 s66, s74, 12288
v_accvgpr_read_b32 v176, a96
v_accvgpr_read_b32 v177, a97
v_accvgpr_read_b32 v178, a98
v_accvgpr_read_b32 v179, a99
v_accvgpr_read_b32 v180, a112
v_accvgpr_read_b32 v181, a113
v_accvgpr_read_b32 v182, a114
v_accvgpr_read_b32 v183, a115
v_pk_mul_f32 v[176:177], v[24:25], v[176:177]
v_pk_mul_f32 v[178:179], v[24:25], v[178:179]
v_pk_mul_f32 v[180:181], v[24:25], v[180:181]
v_pk_mul_f32 v[182:183], v[24:25], v[182:183]
v_cvt_pk_bf16_f32 v104, v176, v177
v_cvt_pk_bf16_f32 v105, v178, v179
v_cvt_pk_bf16_f32 v106, v180, v181
v_cvt_pk_bf16_f32 v107, v182, v183
buffer_store_dwordx4 v[104:107], v238, s[52:55], s66 offen offset:0 sc1
v_accvgpr_read_b32 v184, a100
v_accvgpr_read_b32 v185, a101
v_accvgpr_read_b32 v186, a102
v_accvgpr_read_b32 v187, a103
v_accvgpr_read_b32 v188, a116
v_accvgpr_read_b32 v189, a117
v_accvgpr_read_b32 v190, a118
v_accvgpr_read_b32 v191, a119
v_pk_mul_f32 v[184:185], v[26:27], v[184:185]
v_pk_mul_f32 v[186:187], v[26:27], v[186:187]
v_pk_mul_f32 v[188:189], v[26:27], v[188:189]
v_pk_mul_f32 v[190:191], v[26:27], v[190:191]
v_cvt_pk_bf16_f32 v108, v184, v185
v_cvt_pk_bf16_f32 v109, v186, v187
v_cvt_pk_bf16_f32 v110, v188, v189
v_cvt_pk_bf16_f32 v111, v190, v191
buffer_store_dwordx4 v[108:111], v238, s[52:55], s66 offen offset:1024 sc1
s_xor_b32 s66, s74, 524288
v_accvgpr_read_b32 v176, a8
v_accvgpr_read_b32 v177, a9
v_accvgpr_read_b32 v178, a10
v_accvgpr_read_b32 v179, a11
v_accvgpr_read_b32 v180, a24
v_accvgpr_read_b32 v181, a25
v_accvgpr_read_b32 v182, a26
v_accvgpr_read_b32 v183, a27
v_pk_mul_f32 v[176:177], v[28:29], v[176:177]
v_pk_mul_f32 v[178:179], v[28:29], v[178:179]
v_pk_mul_f32 v[180:181], v[28:29], v[180:181]
v_pk_mul_f32 v[182:183], v[28:29], v[182:183]
v_cvt_pk_bf16_f32 v104, v176, v177
v_cvt_pk_bf16_f32 v105, v178, v179
v_cvt_pk_bf16_f32 v106, v180, v181
v_cvt_pk_bf16_f32 v107, v182, v183
buffer_store_dwordx4 v[104:107], v238, s[52:55], s66 offen offset:0 sc1
v_accvgpr_read_b32 v184, a12
v_accvgpr_read_b32 v185, a13
v_accvgpr_read_b32 v186, a14
v_accvgpr_read_b32 v187, a15
v_accvgpr_read_b32 v188, a28
v_accvgpr_read_b32 v189, a29
v_accvgpr_read_b32 v190, a30
v_accvgpr_read_b32 v191, a31
v_pk_mul_f32 v[184:185], v[30:31], v[184:185]
v_pk_mul_f32 v[186:187], v[30:31], v[186:187]
v_pk_mul_f32 v[188:189], v[30:31], v[188:189]
L_hop2_3:
s_cbranch_execz L_hop_ret2
v_pk_mul_f32 v[190:191], v[30:31], v[190:191]
v_cvt_pk_bf16_f32 v108, v184, v185
v_cvt_pk_bf16_f32 v109, v186, v187
v_cvt_pk_bf16_f32 v110, v188, v189
v_cvt_pk_bf16_f32 v111, v190, v191
buffer_store_dwordx4 v[108:111], v238, s[52:55], s66 offen offset:1024 sc1
s_waitcnt vmcnt(2)
buffer_store_dword v233, v235, s[52:55], s78 offen sc1
s_xor_b32 s66, s74, 528384
v_accvgpr_read_b32 v160, a40
v_accvgpr_read_b32 v161, a41
v_accvgpr_read_b32 v162, a42
v_accvgpr_read_b32 v163, a43
v_accvgpr_read_b32 v164, a56
v_accvgpr_read_b32 v165, a57
v_accvgpr_read_b32 v166, a58
v_accvgpr_read_b32 v167, a59
v_pk_mul_f32 v[160:161], v[28:29], v[160:161]
v_pk_mul_f32 v[162:163], v[28:29], v[162:163]
v_pk_mul_f32 v[164:165], v[28:29], v[164:165]
v_pk_mul_f32 v[166:167], v[28:29], v[166:167]
v_cvt_pk_bf16_f32 v96, v160, v161
v_cvt_pk_bf16_f32 v97, v162, v163
v_cvt_pk_bf16_f32 v98, v164, v165
v_cvt_pk_bf16_f32 v99, v166, v167
buffer_store_dwordx4 v[96:99], v238, s[52:55], s66 offen offset:0 sc1
v_accvgpr_read_b32 v168, a44
v_accvgpr_read_b32 v169, a45
v_accvgpr_read_b32 v170, a46
v_accvgpr_read_b32 v171, a47
v_accvgpr_read_b32 v172, a60
v_accvgpr_read_b32 v173, a61
v_accvgpr_read_b32 v174, a62
v_accvgpr_read_b32 v175, a63
v_pk_mul_f32 v[168:169], v[30:31], v[168:169]
v_pk_mul_f32 v[170:171], v[30:31], v[170:171]
v_pk_mul_f32 v[172:173], v[30:31], v[172:173]
v_pk_mul_f32 v[174:175], v[30:31], v[174:175]
v_cvt_pk_bf16_f32 v100, v168, v169
v_cvt_pk_bf16_f32 v101, v170, v171
v_cvt_pk_bf16_f32 v102, v172, v173
v_cvt_pk_bf16_f32 v103, v174, v175
buffer_store_dwordx4 v[100:103], v238, s[52:55], s66 offen offset:1024 sc1
s_xor_b32 s66, s74, 532480
v_accvgpr_read_b32 v176, a72
v_accvgpr_read_b32 v177, a73
v_accvgpr_read_b32 v178, a74
v_accvgpr_read_b32 v179, a75
v_accvgpr_read_b32 v180, a88
v_accvgpr_read_b32 v181, a89
v_accvgpr_read_b32 v182, a90
v_accvgpr_read_b32 v183, a91
v_pk_mul_f32 v[176:177], v[28:29], v[176:177]
v_pk_mul_f32 v[178:179], v[28:29], v[178:179]
v_pk_mul_f32 v[180:181], v[28:29], v[180:181]
v_pk_mul_f32 v[182:183], v[28:29], v[182:183]
v_cvt_pk_bf16_f32 v104, v176, v177
v_cvt_pk_bf16_f32 v105, v178, v179
v_cvt_pk_bf16_f32 v106, v180, v181
v_cvt_pk_bf16_f32 v107, v182, v183
buffer_store_dwordx4 v[104:107], v238, s[52:55], s66 offen offset:0 sc1
v_accvgpr_read_b32 v184, a76
v_accvgpr_read_b32 v185, a77
v_accvgpr_read_b32 v186, a78
v_accvgpr_read_b32 v187, a79
v_accvgpr_read_b32 v188, a92
v_accvgpr_read_b32 v189, a93
v_accvgpr_read_b32 v190, a94
v_accvgpr_read_b32 v191, a95
v_pk_mul_f32 v[184:185], v[30:31], v[184:185]
v_pk_mul_f32 v[186:187], v[30:31], v[186:187]
v_pk_mul_f32 v[188:189], v[30:31], v[188:189]
v_pk_mul_f32 v[190:191], v[30:31], v[190:191]
v_cvt_pk_bf16_f32 v108, v184, v185
v_cvt_pk_bf16_f32 v109, v186, v187
v_cvt_pk_bf16_f32 v110, v188, v189
v_cvt_pk_bf16_f32 v111, v190, v191
buffer_store_dwordx4 v[108:111], v238, s[52:55], s66 offen offset:1024 sc1
s_xor_b32 s66, s74, 536576
v_accvgpr_read_b32 v160, a104
v_accvgpr_read_b32 v161, a105
v_accvgpr_read_b32 v162, a106
v_accvgpr_read_b32 v163, a107
v_accvgpr_read_b32 v164, a120
v_accvgpr_read_b32 v165, a121
v_accvgpr_read_b32 v166, a122
v_accvgpr_read_b32 v167, a123
v_pk_mul_f32 v[160:161], v[28:29], v[160:161]
v_pk_mul_f32 v[162:163], v[28:29], v[162:163]
v_pk_mul_f32 v[164:165], v[28:29], v[164:165]
v_pk_mul_f32 v[166:167], v[28:29], v[166:167]
v_cvt_pk_bf16_f32 v96, v160, v161
v_cvt_pk_bf16_f32 v97, v162, v163
v_cvt_pk_bf16_f32 v98, v164, v165
v_cvt_pk_bf16_f32 v99, v166, v167
buffer_store_dwordx4 v[96:99], v238, s[52:55], s66 offen offset:0 sc1
v_accvgpr_read_b32 v168, a108
v_accvgpr_read_b32 v169, a109
v_accvgpr_read_b32 v170, a110
v_accvgpr_read_b32 v171, a111
v_accvgpr_read_b32 v172, a124
v_accvgpr_read_b32 v173, a125
v_accvgpr_read_b32 v174, a126
v_accvgpr_read_b32 v175, a127
v_pk_mul_f32 v[168:169], v[30:31], v[168:169]
v_pk_mul_f32 v[170:171], v[30:31], v[170:171]
v_pk_mul_f32 v[172:173], v[30:31], v[172:173]
v_pk_mul_f32 v[174:175], v[30:31], v[174:175]
v_cvt_pk_bf16_f32 v100, v168, v169
v_cvt_pk_bf16_f32 v101, v170, v171
v_cvt_pk_bf16_f32 v102, v172, v173
v_cvt_pk_bf16_f32 v103, v174, v175
buffer_store_dwordx4 v[100:103], v238, s[52:55], s66 offen offset:1024 sc1
buffer_load_dword v13, v12, s[52:55], s28 offen sc1
s_add_u32 s44, s17, 143360
s_add_u32 s45, s44, 4096
buffer_load_dwordx4 a[144:147], v238, s[52:55], s45 offen offset:0 sc1
v_mov_b32 v11, v238
s_add_u32 s8, s60, 1
s_and_b32 s8, s8, 3
s_lshl_b32 s9, s8, 10
v_add_u32 v2, s9, v11
s_min_u32 s9, s8, 1
s_add_u32 s9, s9, s8
s_lshl_b32 s9, s9, 14
s_add_u32 s9, s9, 49152
v_add_u32 v6, s9, v11
s_add_u32 s8, s60, 2
s_and_b32 s8, s8, 3
s_lshl_b32 s9, s8, 10
v_add_u32 v3, s9, v11
s_min_u32 s9, s8, 1
s_add_u32 s9, s9, s8
s_lshl_b32 s9, s9, 14
s_add_u32 s9, s9, 54272
v_add_u32 v7, s9, v11
s_add_u32 s8, s60, 3
s_and_b32 s8, s8, 3
s_lshl_b32 s9, s8, 10
v_add_u32 v4, s9, v11
s_min_u32 s9, s8, 1
s_add_u32 s9, s9, s8
s_lshl_b32 s9, s9, 14
s_add_u32 s9, s9, 59392
v_add_u32 v8, s9, v11
s_add_u32 s8, s60, 4
s_and_b32 s8, s8, 3
s_lshl_b32 s9, s8, 10
v_add_u32 v5, s9, v11
s_min_u32 s9, s60, 1
s_add_u32 s9, s9, s60
s_lshl_b32 s9, s9, 14
s_add_u32 s9, s9, 49152
v_add_u32 v9, s9, v11
v_lshlrev_b32 v17, 3, v1
v_mov_b32 v18, 1
v_mov_b32 v19, v236
v_mov_b32 v20, v235
v_and_b32 v21, 15, v1
v_mul_u32_u24 v21, 1280, v21
v_lshrrev_b32 v22, 4, v1
v_lshl_add_u32 v10, v22, 3, v21
s_add_u32 s9, s69, 0
v_add_u32 v14, s9, v11
s_add_u32 s9, s69, 65536
v_add_u32 v15, s9, v11
s_add_u32 s9, s69, 131072
v_add_u32 v16, s9, v11
v_lshrrev_b32 v21, 3, v1
v_min_u32 v21, 1, v21
v_lshlrev_b32 v21, 28, v21
v_lshl_add_u32 v28, v1, 8, v21
s_and_b32 s8, s60, 1
s_lshl_b32 s8, s8, 13
s_add_u32 s31, s31, s8
s_lshr_b32 s8, s60, 1
s_lshl_b32 s8, s8, 12
s_add_u32 s31, s31, s8
v_and_b32 v21, 15, v1
v_mul_u32_u24 v21, 160, v21
v_lshrrev_b32 v22, 4, v1
v_lshl_add_u32 v21, v22, 3, v21
s_add_u32 s9, s69, 131072
v_add_u32 v10, s9, v21
v_add_u32 v23, 0, v1
v_mul_u32_u24 v29, 6554, v23
v_lshrrev_b32 v29, 16, v29
v_mul_u32_u24 v29, 1120, v29
v_lshl_add_u32 v29, v23, 4, v29
v_add_u32 v23, 64, v1
v_mul_u32_u24 v21, 6554, v23
v_lshrrev_b32 v21, 16, v21
v_mul_u32_u24 v21, 1120, v21
v_lshl_add_u32 v21, v23, 4, v21
v_add_u32 v23, 128, v1
v_mul_u32_u24 v22, 6554, v23
v_lshrrev_b32 v22, 16, v22
v_mul_u32_u24 v22, 1120, v22
v_lshl_add_u32 v22, v23, 4, v22
v_lshrrev_b32 v23, 5, v1
v_lshl_add_u32 v22, v23, 28, v22
ds_read_b128 a[128:131], v15 offset:32768
ds_read_b128 a[132:135], v15 offset:33792
ds_read_b128 a[136:139], v15 offset:34816
ds_read_b128 a[140:143], v15 offset:35840
s_mov_b64 exec, 0
s_cmp_eq_u32 s60, 0
s_cbranch_scc1 L_hop9_0
s_cmp_eq_u32 s60, 1
s_cbranch_scc1 L_hop9_1
s_cmp_eq_u32 s60, 2
s_cbranch_scc1 L_hop9_2
s_branch L_hop9_3
L_hop9_2:
L_hop9_3:
L_hop_ret9:
s_mov_b64 exec, -1
s_waitcnt vmcnt(2)
buffer_store_dword v18, v20, s[52:55], s27 offen sc1
s_waitcnt vmcnt(2)
v_cmp_ne_u32 vcc, 0, v13
s_andn2_b32 s8, 15, vcc_lo
s_cbranch_scc1 L_spin0
L_spin_ret0:
s_barrier
s_add_u32 s4, s18, 0
s_add_u32 s5, s18, 16384
buffer_load_dwordx4 a[224:227], v2, s[52:55], s4 offen sc1
buffer_load_dwordx4 a[228:231], v2, s[52:55], s5 offen sc1
buffer_load_dwordx4 a[232:235], v3, s[52:55], s5 offen sc1
buffer_load_dwordx4 a[236:239], v3, s[52:55], s4 offen sc1
buffer_load_dwordx4 a[240:243], v4, s[52:55], s4 offen sc1
buffer_load_dwordx4 a[244:247], v4, s[52:55], s5 offen sc1
buffer_load_dwordx4 a[248:251], v5, s[52:55], s5 offen sc1
buffer_load_dwordx4 a[252:255], v5, s[52:55], s4 offen sc1
s_add_u32 s6, s18, 32768
s_add_u32 s7, s18, 49152
buffer_load_dwordx4 a[80:83], v2, s[52:55], s6 offen sc1
buffer_load_dwordx4 a[84:87], v2, s[52:55], s7 offen sc1
buffer_load_dwordx4 a[88:91], v3, s[52:55], s7 offen sc1
buffer_load_dwordx4 a[92:95], v3, s[52:55], s6 offen sc1
s_waitcnt vmcnt(11)
v_mfma_f32_16x16x32_bf16 a[0:3], a[148:151], a[224:227], 0
s_waitcnt vmcnt(10)
v_mfma_f32_16x16x32_bf16 a[0:3], a[168:171], a[228:231], a[0:3]
v_mfma_f32_16x16x32_bf16 a[4:7], a[172:175], a[228:231], 0
v_mfma_f32_16x16x32_bf16 a[4:7], a[152:155], a[224:227], a[4:7]
v_mfma_f32_16x16x32_bf16 a[8:11], a[156:159], a[224:227], 0
buffer_load_dwordx4 a[96:99], v4, s[52:55], s6 offen sc1
v_mfma_f32_16x16x32_bf16 a[8:11], a[176:179], a[228:231], a[8:11]
v_mfma_f32_16x16x32_bf16 a[12:15], a[180:183], a[228:231], 0
buffer_load_dwordx4 a[100:103], v4, s[52:55], s7 offen sc1
v_mfma_f32_16x16x32_bf16 a[12:15], a[160:163], a[224:227], a[12:15]
v_mfma_f32_16x16x32_bf16 a[16:19], a[164:167], a[224:227], 0
v_mfma_f32_16x16x32_bf16 a[16:19], a[184:187], a[228:231], a[16:19]
s_waitcnt vmcnt(11)
v_mfma_f32_16x16x32_bf16 a[36:39], a[184:187], a[232:235], 0
s_waitcnt vmcnt(10)
v_mfma_f32_16x16x32_bf16 a[36:39], a[164:167], a[236:239], a[36:39]
v_mfma_f32_16x16x32_bf16 a[32:35], a[160:163], a[236:239], 0
v_mfma_f32_16x16x32_bf16 a[32:35], a[180:183], a[232:235], a[32:35]
v_mfma_f32_16x16x32_bf16 a[28:31], a[176:179], a[232:235], 0
buffer_load_dwordx4 a[104:107], v5, s[52:55], s7 offen sc1
v_mfma_f32_16x16x32_bf16 a[28:31], a[156:159], a[236:239], a[28:31]
v_mfma_f32_16x16x32_bf16 a[24:27], a[152:155], a[236:239], 0
buffer_load_dwordx4 a[108:111], v5, s[52:55], s6 offen sc1
v_mfma_f32_16x16x32_bf16 a[24:27], a[172:175], a[232:235], a[24:27]
s_add_u32 s10, s18, 65536
s_add_u32 s11, s18, 81920
v_mfma_f32_16x16x32_bf16 a[20:23], a[168:171], a[232:235], 0
v_mfma_f32_16x16x32_bf16 a[20:23], a[148:151], a[236:239], a[20:23]
s_waitcnt vmcnt(11)
v_mfma_f32_16x16x32_bf16 a[40:43], a[148:151], a[240:243], 0
s_waitcnt vmcnt(10)
v_mfma_f32_16x16x32_bf16 a[40:43], a[168:171], a[244:247], a[40:43]
v_mfma_f32_16x16x32_bf16 a[44:47], a[172:175], a[244:247], 0
v_mfma_f32_16x16x32_bf16 a[44:47], a[152:155], a[240:243], a[44:47]
v_mfma_f32_16x16x32_bf16 a[48:51], a[156:159], a[240:243], 0
buffer_load_dwordx4 a[112:115], v2, s[52:55], s10 offen sc1
v_mfma_f32_16x16x32_bf16 a[48:51], a[176:179], a[244:247], a[48:51]
v_mfma_f32_16x16x32_bf16 a[52:55], a[180:183], a[244:247], 0
buffer_load_dwordx4 a[116:119], v2, s[52:55], s11 offen sc1
v_mfma_f32_16x16x32_bf16 a[52:55], a[160:163], a[240:243], a[52:55]
v_mfma_f32_16x16x32_bf16 a[56:59], a[164:167], a[240:243], 0
v_mfma_f32_16x16x32_bf16 a[56:59], a[184:187], a[244:247], a[56:59]
s_waitcnt vmcnt(11)
v_mfma_f32_16x16x32_bf16 a[76:79], a[184:187], a[248:251], 0
s_waitcnt vmcnt(10)
v_mfma_f32_16x16x32_bf16 a[76:79], a[164:167], a[252:255], a[76:79]
v_mfma_f32_16x16x32_bf16 a[72:75], a[160:163], a[252:255], 0
v_mfma_f32_16x16x32_bf16 a[72:75], a[180:183], a[248:251], a[72:75]
v_mfma_f32_16x16x32_bf16 a[68:71], a[176:179], a[248:251], 0
buffer_load_dwordx4 a[120:123], v3, s[52:55], s11 offen sc1
v_mfma_f32_16x16x32_bf16 a[68:71], a[156:159], a[252:255], a[68:71]
v_mfma_f32_16x16x32_bf16 a[64:67], a[152:155], a[252:255], 0
buffer_load_dwordx4 a[124:127], v3, s[52:55], s10 offen sc1
v_mfma_f32_16x16x32_bf16 a[64:67], a[172:175], a[248:251], a[64:67]
v_mfma_f32_16x16x32_bf16 a[60:63], a[168:171], a[248:251], 0
v_mfma_f32_16x16x32_bf16 a[60:63], a[148:151], a[252:255], a[60:63]
s_waitcnt vmcnt(11)
v_mfma_f32_16x16x32_bf16 a[0:3], a[188:191], a[80:83], a[0:3]
s_waitcnt vmcnt(10)
buffer_load_dword v13, v12, s[52:55], s29 offen sc1
v_mfma_f32_16x16x32_bf16 a[0:3], a[208:211], a[84:87], a[0:3]
v_mfma_f32_16x16x32_bf16 a[4:7], a[212:215], a[84:87], a[4:7]
v_mfma_f32_16x16x32_bf16 a[4:7], a[192:195], a[80:83], a[4:7]
v_mfma_f32_16x16x32_bf16 a[8:11], a[196:199], a[80:83], a[8:11]
buffer_load_dwordx4 a[224:227], v4, s[52:55], s10 offen sc1
v_mfma_f32_16x16x32_bf16 a[8:11], a[216:219], a[84:87], a[8:11]
v_mfma_f32_16x16x32_bf16 a[12:15], a[220:223], a[84:87], a[12:15]
buffer_load_dwordx4 a[228:231], v4, s[52:55], s11 offen sc1
v_mfma_f32_16x16x32_bf16 a[12:15], a[200:203], a[80:83], a[12:15]
v_mfma_f32_16x16x32_bf16 a[16:19], a[204:207], a[80:83], a[16:19]
v_mfma_f32_16x16x32_bf16 a[16:19], v[32:35], a[84:87], a[16:19]
s_waitcnt vmcnt(12)
v_mfma_f32_16x16x32_bf16 a[36:39], v[32:35], a[88:91], a[36:39]
s_waitcnt vmcnt(11)
v_mfma_f32_16x16x32_bf16 a[36:39], a[204:207], a[92:95], a[36:39]
v_mfma_f32_16x16x32_bf16 a[32:35], a[200:203], a[92:95], a[32:35]
v_mfma_f32_16x16x32_bf16 a[32:35], a[220:223], a[88:91], a[32:35]
v_mfma_f32_16x16x32_bf16 a[28:31], a[216:219], a[88:91], a[28:31]
buffer_load_dwordx4 a[232:235], v5, s[52:55], s11 offen sc1
v_mfma_f32_16x16x32_bf16 a[28:31], a[196:199], a[92:95], a[28:31]
v_mfma_f32_16x16x32_bf16 a[24:27], a[192:195], a[92:95], a[24:27]
buffer_load_dwordx4 a[236:239], v5, s[52:55], s10 offen sc1
v_mfma_f32_16x16x32_bf16 a[24:27], a[212:215], a[88:91], a[24:27]
s_add_u32 s4, s18, 98304
s_add_u32 s5, s18, 114688
v_mfma_f32_16x16x32_bf16 a[20:23], a[208:211], a[88:91], a[20:23]
v_mfma_f32_16x16x32_bf16 a[20:23], a[188:191], a[92:95], a[20:23]
s_waitcnt vmcnt(12)
v_mfma_f32_16x16x32_bf16 a[40:43], a[188:191], a[96:99], a[40:43]
s_waitcnt vmcnt(11)
v_mfma_f32_16x16x32_bf16 a[40:43], a[208:211], a[100:103], a[40:43]
v_mfma_f32_16x16x32_bf16 a[44:47], a[212:215], a[100:103], a[44:47]
v_mfma_f32_16x16x32_bf16 a[44:47], a[192:195], a[96:99], a[44:47]
v_mfma_f32_16x16x32_bf16 a[48:51], a[196:199], a[96:99], a[48:51]
buffer_load_dwordx4 a[240:243], v2, s[52:55], s4 offen sc1
v_mfma_f32_16x16x32_bf16 a[48:51], a[216:219], a[100:103], a[48:51]
v_mfma_f32_16x16x32_bf16 a[52:55], a[220:223], a[100:103], a[52:55]
buffer_load_dwordx4 a[244:247], v2, s[52:55], s5 offen sc1
v_mfma_f32_16x16x32_bf16 a[52:55], a[200:203], a[96:99], a[52:55]
v_mfma_f32_16x16x32_bf16 a[56:59], a[204:207], a[96:99], a[56:59]
v_mfma_f32_16x16x32_bf16 a[56:59], v[32:35], a[100:103], a[56:59]
s_waitcnt vmcnt(12)
v_mfma_f32_16x16x32_bf16 a[76:79], v[32:35], a[104:107], a[76:79]
s_waitcnt vmcnt(11)
v_mfma_f32_16x16x32_bf16 a[76:79], a[204:207], a[108:111], a[76:79]
v_mfma_f32_16x16x32_bf16 a[72:75], a[200:203], a[108:111], a[72:75]
v_mfma_f32_16x16x32_bf16 a[72:75], a[220:223], a[104:107], a[72:75]
v_mfma_f32_16x16x32_bf16 a[68:71], a[216:219], a[104:107], a[68:71]
buffer_load_dwordx4 a[248:251], v3, s[52:55], s5 offen sc1
v_mfma_f32_16x16x32_bf16 a[68:71], a[196:199], a[108:111], a[68:71]
v_mfma_f32_16x16x32_bf16 a[64:67], a[192:195], a[108:111], a[64:67]
buffer_load_dwordx4 a[252:255], v3, s[52:55], s4 offen sc1
v_mfma_f32_16x16x32_bf16 a[64:67], a[212:215], a[104:107], a[64:67]
v_mfma_f32_16x16x32_bf16 a[60:63], a[208:211], a[104:107], a[60:63]
v_mfma_f32_16x16x32_bf16 a[60:63], a[188:191], a[108:111], a[60:63]
s_waitcnt vmcnt(12)
v_mfma_f32_16x16x32_bf16 a[0:3], v[36:39], a[112:115], a[0:3]
s_waitcnt vmcnt(11)
v_mfma_f32_16x16x32_bf16 a[0:3], v[56:59], a[116:119], a[0:3]
v_mfma_f32_16x16x32_bf16 a[4:7], v[60:63], a[116:119], a[4:7]
v_mfma_f32_16x16x32_bf16 a[4:7], v[40:43], a[112:115], a[4:7]
v_mfma_f32_16x16x32_bf16 a[8:11], v[44:47], a[112:115], a[8:11]
buffer_load_dwordx4 a[80:83], v4, s[52:55], s4 offen sc1
v_mfma_f32_16x16x32_bf16 a[8:11], v[64:67], a[116:119], a[8:11]
v_mfma_f32_16x16x32_bf16 a[12:15], v[68:71], a[116:119], a[12:15]
buffer_load_dwordx4 a[84:87], v4, s[52:55], s5 offen sc1
v_mfma_f32_16x16x32_bf16 a[12:15], v[48:51], a[112:115], a[12:15]
v_mfma_f32_16x16x32_bf16 a[16:19], v[52:55], a[112:115], a[16:19]
v_mfma_f32_16x16x32_bf16 a[16:19], v[72:75], a[116:119], a[16:19]
s_waitcnt vmcnt(12)
v_mfma_f32_16x16x32_bf16 a[36:39], v[72:75], a[120:123], a[36:39]
s_waitcnt vmcnt(11)
v_mfma_f32_16x16x32_bf16 a[36:39], v[52:55], a[124:127], a[36:39]
v_mfma_f32_16x16x32_bf16 a[32:35], v[48:51], a[124:127], a[32:35]
v_mfma_f32_16x16x32_bf16 a[32:35], v[68:71], a[120:123], a[32:35]
v_mfma_f32_16x16x32_bf16 a[28:31], v[64:67], a[120:123], a[28:31]
buffer_load_dwordx4 a[88:91], v5, s[52:55], s5 offen sc1
v_mfma_f32_16x16x32_bf16 a[28:31], v[44:47], a[124:127], a[28:31]
v_mfma_f32_16x16x32_bf16 a[24:27], v[40:43], a[124:127], a[24:27]
buffer_load_dwordx4 a[92:95], v5, s[52:55], s4 offen sc1
v_mfma_f32_16x16x32_bf16 a[24:27], v[60:63], a[120:123], a[24:27]
s_add_u32 s6, s19, 0
s_add_u32 s7, s19, 16384
v_mfma_f32_16x16x32_bf16 a[20:23], v[56:59], a[120:123], a[20:23]
v_mfma_f32_16x16x32_bf16 a[20:23], v[36:39], a[124:127], a[20:23]
s_waitcnt vmcnt(11)
v_mfma_f32_16x16x32_bf16 a[40:43], v[36:39], a[224:227], a[40:43]
s_waitcnt vmcnt(10)
v_mfma_f32_16x16x32_bf16 a[40:43], v[56:59], a[228:231], a[40:43]
ds_read_b128 a[96:99], v16 offset:0
v_mfma_f32_16x16x32_bf16 a[44:47], v[60:63], a[228:231], a[44:47]
v_mfma_f32_16x16x32_bf16 a[44:47], v[40:43], a[224:227], a[44:47]
ds_read_b128 a[100:103], v16 offset:1024
v_mfma_f32_16x16x32_bf16 a[48:51], v[44:47], a[224:227], a[48:51]
v_cmp_ne_u32 vcc, 0, v13
s_andn2_b32 s8, 15, vcc_lo
s_cbranch_scc1 L_spin1
L_spin_ret1:
s_barrier
buffer_load_dwordx4 a[104:107], v2, s[52:55], s6 offen sc1
v_mfma_f32_16x16x32_bf16 a[48:51], v[64:67], a[228:231], a[48:51]
ds_read_b128 a[108:111], v16 offset:2048
v_mfma_f32_16x16x32_bf16 a[52:55], v[68:71], a[228:231], a[52:55]
buffer_load_dwordx4 a[112:115], v2, s[52:55], s7 offen sc1
v_mfma_f32_16x16x32_bf16 a[52:55], v[48:51], a[224:227], a[52:55]
ds_read_b128 a[116:119], v16 offset:3072
v_mfma_f32_16x16x32_bf16 a[56:59], v[52:55], a[224:227], a[56:59]
v_mfma_f32_16x16x32_bf16 a[56:59], v[72:75], a[228:231], a[56:59]
s_waitcnt vmcnt(11)
ds_read_b128 a[120:123], v16 offset:16384
v_mfma_f32_16x16x32_bf16 a[76:79], v[72:75], a[232:235], a[76:79]
s_waitcnt vmcnt(10)
buffer_load_dwordx4 a[124:127], v3, s[52:55], s7 offen sc1
v_mfma_f32_16x16x32_bf16 a[76:79], v[52:55], a[236:239], a[76:79]
v_mfma_f32_16x16x32_bf16 a[72:75], v[48:51], a[236:239], a[72:75]
v_mfma_f32_16x16x32_bf16 a[72:75], v[68:71], a[232:235], a[72:75]
v_mfma_f32_16x16x32_bf16 a[68:71], v[64:67], a[232:235], a[68:71]
buffer_load_dwordx4 a[224:227], v3, s[52:55], s6 offen sc1
v_mfma_f32_16x16x32_bf16 a[68:71], v[44:47], a[236:239], a[68:71]
v_mfma_f32_16x16x32_bf16 a[64:67], v[40:43], a[236:239], a[64:67]
v_mfma_f32_16x16x32_bf16 a[64:67], v[60:63], a[232:235], a[64:67]
v_mfma_f32_16x16x32_bf16 a[60:63], v[56:59], a[232:235], a[60:63]
buffer_load_dwordx4 a[228:231], v4, s[52:55], s6 offen sc1
v_mfma_f32_16x16x32_bf16 a[60:63], v[36:39], a[236:239], a[60:63]
s_waitcnt vmcnt(12)
v_mfma_f32_16x16x32_bf16 a[0:3], v[76:79], a[240:243], a[0:3]
s_waitcnt vmcnt(11) lgkmcnt(4)
v_mfma_f32_16x16x32_bf16 a[0:3], a[96:99], a[244:247], a[0:3]
s_waitcnt lgkmcnt(3)
v_mfma_f32_16x16x32_bf16 a[4:7], a[100:103], a[244:247], a[4:7]
buffer_load_dwordx4 a[232:235], v4, s[52:55], s7 offen sc1
v_mfma_f32_16x16x32_bf16 a[4:7], v[80:83], a[240:243], a[4:7]
v_mfma_f32_16x16x32_bf16 a[8:11], v[84:87], a[240:243], a[8:11]
s_waitcnt lgkmcnt(2)
v_mfma_f32_16x16x32_bf16 a[8:11], a[108:111], a[244:247], a[8:11]
s_waitcnt lgkmcnt(1)
v_mfma_f32_16x16x32_bf16 a[12:15], a[116:119], a[244:247], a[12:15]
buffer_load_dwordx4 a[236:239], v5, s[52:55], s7 offen sc1
v_mfma_f32_16x16x32_bf16 a[12:15], v[88:91], a[240:243], a[12:15]
v_mfma_f32_16x16x32_bf16 a[16:19], v[92:95], a[240:243], a[16:19]
s_waitcnt lgkmcnt(0)
v_mfma_f32_16x16x32_bf16 a[16:19], a[120:123], a[244:247], a[16:19]
s_waitcnt vmcnt(12)
v_mfma_f32_16x16x32_bf16 a[36:39], a[120:123], a[248:251], a[36:39]
s_waitcnt vmcnt(11)
buffer_load_dwordx4 a[240:243], v5, s[52:55], s6 offen sc1
v_mfma_f32_16x16x32_bf16 a[36:39], v[92:95], a[252:255], a[36:39]
s_add_u32 s10, s19, 32768
s_add_u32 s11, s19, 49152
v_mfma_f32_16x16x32_bf16 a[32:35], v[88:91], a[252:255], a[32:35]
v_mfma_f32_16x16x32_bf16 a[32:35], a[116:119], a[248:251], a[32:35]
v_mfma_f32_16x16x32_bf16 a[28:31], a[108:111], a[248:251], a[28:31]
v_mfma_f32_16x16x32_bf16 a[28:31], v[84:87], a[252:255], a[28:31]
v_mfma_f32_16x16x32_bf16 a[24:27], v[80:83], a[252:255], a[24:27]
v_mfma_f32_16x16x32_bf16 a[24:27], a[100:103], a[248:251], a[24:27]
v_mfma_f32_16x16x32_bf16 a[20:23], a[96:99], a[248:251], a[20:23]
v_mfma_f32_16x16x32_bf16 a[20:23], v[76:79], a[252:255], a[20:23]
s_waitcnt vmcnt(11)
v_mfma_f32_16x16x32_bf16 a[40:43], v[76:79], a[80:83], a[40:43]
s_waitcnt vmcnt(10)
v_mfma_f32_16x16x32_bf16 a[40:43], a[96:99], a[84:87], a[40:43]
ds_read_b128 a[244:247], v14 offset:0
v_mfma_f32_16x16x32_bf16 a[44:47], a[100:103], a[84:87], a[44:47]
v_mfma_f32_16x16x32_bf16 a[44:47], v[80:83], a[80:83], a[44:47]
ds_read_b128 a[248:251], v14 offset:1024
v_mfma_f32_16x16x32_bf16 a[48:51], v[84:87], a[80:83], a[48:51]
v_mfma_f32_16x16x32_bf16 a[48:51], a[108:111], a[84:87], a[48:51]
ds_read_b128 a[252:255], v14 offset:2048
v_mfma_f32_16x16x32_bf16 a[52:55], a[116:119], a[84:87], a[52:55]
v_mfma_f32_16x16x32_bf16 a[52:55], v[88:91], a[80:83], a[52:55]
v_mfma_f32_16x16x32_bf16 a[56:59], v[92:95], a[80:83], a[56:59]
v_mfma_f32_16x16x32_bf16 a[56:59], a[120:123], a[84:87], a[56:59]
s_waitcnt vmcnt(9)
ds_read_b128 a[80:83], v14 offset:3072
v_mfma_f32_16x16x32_bf16 a[76:79], a[120:123], a[88:91], a[76:79]
s_waitcnt vmcnt(8)
buffer_load_dwordx4 a[84:87], v2, s[52:55], s10 offen sc1
v_mfma_f32_16x16x32_bf16 a[76:79], v[92:95], a[92:95], a[76:79]
ds_read_b128 a[120:123], v16 offset:17408
v_mfma_f32_16x16x32_bf16 a[72:75], v[88:91], a[92:95], a[72:75]
v_mfma_f32_16x16x32_bf16 a[72:75], a[116:119], a[88:91], a[72:75]
v_mfma_f32_16x16x32_bf16 a[68:71], a[108:111], a[88:91], a[68:71]
buffer_load_dwordx4 a[116:119], v2, s[52:55], s11 offen sc1
v_mfma_f32_16x16x32_bf16 a[68:71], v[84:87], a[92:95], a[68:71]
v_mfma_f32_16x16x32_bf16 a[64:67], v[80:83], a[92:95], a[64:67]
buffer_load_dwordx4 a[108:111], v3, s[52:55], s11 offen sc1
v_mfma_f32_16x16x32_bf16 a[64:67], a[100:103], a[88:91], a[64:67]
v_mfma_f32_16x16x32_bf16 a[60:63], a[96:99], a[88:91], a[60:63]
buffer_load_dwordx4 a[100:103], v3, s[52:55], s10 offen sc1
v_mfma_f32_16x16x32_bf16 a[60:63], v[76:79], a[92:95], a[60:63]
s_waitcnt vmcnt(11)
v_mfma_f32_16x16x32_bf16 a[0:3], v[240:243], a[104:107], a[0:3]
s_waitcnt vmcnt(10) lgkmcnt(4)
v_mfma_f32_16x16x32_bf16 a[0:3], a[244:247], a[112:115], a[0:3]
s_waitcnt lgkmcnt(3)
v_mfma_f32_16x16x32_bf16 a[4:7], a[248:251], a[112:115], a[4:7]
buffer_load_dwordx4 a[96:99], v4, s[52:55], s10 offen sc1
v_mfma_f32_16x16x32_bf16 a[4:7], v[244:247], a[104:107], a[4:7]
v_mfma_f32_16x16x32_bf16 a[8:11], v[248:251], a[104:107], a[8:11]
s_waitcnt lgkmcnt(2)
v_mfma_f32_16x16x32_bf16 a[8:11], a[252:255], a[112:115], a[8:11]
s_waitcnt lgkmcnt(1)
v_mfma_f32_16x16x32_bf16 a[12:15], a[80:83], a[112:115], a[12:15]
buffer_load_dwordx4 a[88:91], v4, s[52:55], s11 offen sc1
v_mfma_f32_16x16x32_bf16 a[12:15], v[252:255], a[104:107], a[12:15]
v_mfma_f32_16x16x32_bf16 a[16:19], v[112:115], a[104:107], a[16:19]
s_waitcnt lgkmcnt(0)
v_mfma_f32_16x16x32_bf16 a[16:19], a[120:123], a[112:115], a[16:19]
s_waitcnt vmcnt(11)
v_mfma_f32_16x16x32_bf16 a[36:39], a[120:123], a[124:127], a[36:39]
s_waitcnt vmcnt(10)
buffer_load_dwordx4 a[92:95], v5, s[52:55], s11 offen sc1
v_mfma_f32_16x16x32_bf16 a[36:39], v[112:115], a[224:227], a[36:39]
v_mfma_f32_16x16x32_bf16 a[32:35], v[252:255], a[224:227], a[32:35]
v_mfma_f32_16x16x32_bf16 a[32:35], a[80:83], a[124:127], a[32:35]
v_mfma_f32_16x16x32_bf16 a[28:31], a[252:255], a[124:127], a[28:31]
v_mfma_f32_16x16x32_bf16 a[28:31], v[248:251], a[224:227], a[28:31]
v_mfma_f32_16x16x32_bf16 a[24:27], v[244:247], a[224:227], a[24:27]
v_mfma_f32_16x16x32_bf16 a[24:27], a[248:251], a[124:127], a[24:27]
v_mfma_f32_16x16x32_bf16 a[20:23], a[244:247], a[124:127], a[20:23]
v_mfma_f32_16x16x32_bf16 a[20:23], v[240:243], a[224:227], a[20:23]
s_waitcnt vmcnt(10)
v_mfma_f32_16x16x32_bf16 a[40:43], v[240:243], a[228:231], a[40:43]
s_waitcnt vmcnt(9)
v_mfma_f32_16x16x32_bf16 a[40:43], a[244:247], a[232:235], a[40:43]
ds_read_b128 a[104:107], v14 offset:16384
v_mfma_f32_16x16x32_bf16 a[44:47], a[248:251], a[232:235], a[44:47]
v_mfma_f32_16x16x32_bf16 a[44:47], v[244:247], a[228:231], a[44:47]
ds_read_b128 a[112:115], v14 offset:17408
v_mfma_f32_16x16x32_bf16 a[48:51], v[248:251], a[228:231], a[48:51]
v_mfma_f32_16x16x32_bf16 a[48:51], a[252:255], a[232:235], a[48:51]
ds_read_b128 a[124:127], v14 offset:18432
v_mfma_f32_16x16x32_bf16 a[52:55], a[80:83], a[232:235], a[52:55]
v_mfma_f32_16x16x32_bf16 a[52:55], v[252:255], a[228:231], a[52:55]
ds_read_b128 a[224:227], v14 offset:19456
v_mfma_f32_16x16x32_bf16 a[56:59], v[112:115], a[228:231], a[56:59]
v_mfma_f32_16x16x32_bf16 a[56:59], a[120:123], a[232:235], a[56:59]
s_waitcnt vmcnt(8)
ds_read_b128 a[228:231], v16 offset:18432
v_mfma_f32_16x16x32_bf16 a[76:79], a[120:123], a[236:239], a[76:79]
s_waitcnt vmcnt(7)
buffer_load_dword v13, v28, s[52:55], s31 offen sc1
v_mfma_f32_16x16x32_bf16 a[76:79], v[112:115], a[240:243], a[76:79]
v_mfma_f32_16x16x32_bf16 a[72:75], v[252:255], a[240:243], a[72:75]
buffer_load_dwordx4 a[232:235], v5, s[52:55], s10 offen sc1
v_mfma_f32_16x16x32_bf16 a[72:75], a[80:83], a[236:239], a[72:75]
s_add_u32 s4, s19, 65536
s_add_u32 s5, s19, 81920
v_mfma_f32_16x16x32_bf16 a[68:71], a[252:255], a[236:239], a[68:71]
buffer_load_dwordx4 a[120:123], v2, s[52:55], s4 offen sc1
v_mfma_f32_16x16x32_bf16 a[68:71], v[248:251], a[240:243], a[68:71]
v_mfma_f32_16x16x32_bf16 a[64:67], v[244:247], a[240:243], a[64:67]
buffer_load_dwordx4 a[80:83], v2, s[52:55], s5 offen sc1
v_mfma_f32_16x16x32_bf16 a[64:67], a[248:251], a[236:239], a[64:67]
v_mfma_f32_16x16x32_bf16 a[60:63], a[244:247], a[236:239], a[60:63]
buffer_load_dwordx4 a[252:255], v3, s[52:55], s5 offen sc1
v_mfma_f32_16x16x32_bf16 a[60:63], v[240:243], a[240:243], a[60:63]
s_waitcnt vmcnt(11)
v_mfma_f32_16x16x32_bf16 a[0:3], v[116:119], a[84:87], a[0:3]
s_waitcnt vmcnt(10) lgkmcnt(4)
buffer_load_dwordx4 a[248:251], v3, s[52:55], s4 offen sc1
v_mfma_f32_16x16x32_bf16 a[0:3], a[104:107], a[116:119], a[0:3]
s_waitcnt lgkmcnt(3)
v_mfma_f32_16x16x32_bf16 a[4:7], a[112:115], a[116:119], a[4:7]
v_mfma_f32_16x16x32_bf16 a[4:7], v[120:123], a[84:87], a[4:7]
v_mfma_f32_16x16x32_bf16 a[8:11], v[124:127], a[84:87], a[8:11]
s_waitcnt lgkmcnt(2)
buffer_load_dwordx4 a[244:247], v4, s[52:55], s4 offen sc1
v_mfma_f32_16x16x32_bf16 a[8:11], a[124:127], a[116:119], a[8:11]
s_waitcnt lgkmcnt(1)
v_mfma_f32_16x16x32_bf16 a[12:15], a[224:227], a[116:119], a[12:15]
buffer_load_dwordx4 a[236:239], v4, s[52:55], s5 offen sc1
v_mfma_f32_16x16x32_bf16 a[12:15], v[128:131], a[84:87], a[12:15]
v_mfma_f32_16x16x32_bf16 a[16:19], v[132:135], a[84:87], a[16:19]
s_waitcnt lgkmcnt(0)
v_mfma_f32_16x16x32_bf16 a[16:19], a[228:231], a[116:119], a[16:19]
s_waitcnt vmcnt(12)
v_mfma_f32_16x16x32_bf16 a[36:39], a[228:231], a[108:111], a[36:39]
s_waitcnt vmcnt(11)
buffer_load_dwordx4 a[240:243], v5, s[52:55], s5 offen sc1
v_mfma_f32_16x16x32_bf16 a[36:39], v[132:135], a[100:103], a[36:39]
v_mfma_f32_16x16x32_bf16 a[32:35], v[128:131], a[100:103], a[32:35]
v_mfma_f32_16x16x32_bf16 a[32:35], a[224:227], a[108:111], a[32:35]
L_hop9_0:
s_cbranch_execz L_hop_ret9
v_mfma_f32_16x16x32_bf16 a[28:31], a[124:127], a[108:111], a[28:31]
v_mfma_f32_16x16x32_bf16 a[28:31], v[124:127], a[100:103], a[28:31]
v_mfma_f32_16x16x32_bf16 a[24:27], v[120:123], a[100:103], a[24:27]
v_mfma_f32_16x16x32_bf16 a[24:27], a[112:115], a[108:111], a[24:27]
v_mfma_f32_16x16x32_bf16 a[20:23], a[104:107], a[108:111], a[20:23]
v_mfma_f32_16x16x32_bf16 a[20:23], v[116:119], a[100:103], a[20:23]
s_waitcnt vmcnt(11)
v_mfma_f32_16x16x32_bf16 a[40:43], v[116:119], a[96:99], a[40:43]
s_waitcnt vmcnt(10)
v_mfma_f32_16x16x32_bf16 a[40:43], a[104:107], a[88:91], a[40:43]
ds_read_b128 a[84:87], v15 offset:0
v_mfma_f32_16x16x32_bf16 a[44:47], a[112:115], a[88:91], a[44:47]
v_mfma_f32_16x16x32_bf16 a[44:47], v[120:123], a[96:99], a[44:47]
ds_read_b128 a[116:119], v15 offset:1024
v_mfma_f32_16x16x32_bf16 a[48:51], v[124:127], a[96:99], a[48:51]
v_mfma_f32_16x16x32_bf16 a[48:51], a[124:127], a[88:91], a[48:51]
ds_read_b128 a[108:111], v15 offset:2048
v_mfma_f32_16x16x32_bf16 a[52:55], a[224:227], a[88:91], a[52:55]
v_mfma_f32_16x16x32_bf16 a[52:55], v[128:131], a[96:99], a[52:55]
ds_read_b128 a[100:103], v15 offset:3072
v_mfma_f32_16x16x32_bf16 a[56:59], v[132:135], a[96:99], a[56:59]
v_mfma_f32_16x16x32_bf16 a[56:59], a[228:231], a[88:91], a[56:59]
s_waitcnt vmcnt(9)
ds_read_b128 a[96:99], v16 offset:19456
v_mfma_f32_16x16x32_bf16 a[76:79], a[228:231], a[92:95], a[76:79]
s_waitcnt vmcnt(7)
buffer_load_dwordx4 a[88:91], v5, s[52:55], s4 offen sc1
v_mfma_f32_16x16x32_bf16 a[76:79], v[132:135], a[232:235], a[76:79]
s_add_u32 s6, s19, 98304
s_add_u32 s7, s19, 114688
v_mfma_f32_16x16x32_bf16 a[72:75], v[128:131], a[232:235], a[72:75]
buffer_load_dwordx4 a[228:231], v2, s[52:55], s6 offen sc1
v_mfma_f32_16x16x32_bf16 a[72:75], a[224:227], a[92:95], a[72:75]
v_mfma_f32_16x16x32_bf16 a[68:71], a[124:127], a[92:95], a[68:71]
buffer_load_dwordx4 a[224:227], v2, s[52:55], s7 offen sc1
v_mfma_f32_16x16x32_bf16 a[68:71], v[124:127], a[232:235], a[68:71]
v_mfma_f32_16x16x32_bf16 a[64:67], v[120:123], a[232:235], a[64:67]
buffer_load_dwordx4 a[124:127], v3, s[52:55], s7 offen sc1
v_mfma_f32_16x16x32_bf16 a[64:67], a[112:115], a[92:95], a[64:67]
v_mfma_f32_16x16x32_bf16 a[60:63], a[104:107], a[92:95], a[60:63]
buffer_load_dwordx4 a[112:115], v3, s[52:55], s6 offen sc1
v_mfma_f32_16x16x32_bf16 a[60:63], v[116:119], a[232:235], a[60:63]
s_waitcnt vmcnt(11)
v_mfma_f32_16x16x32_bf16 a[0:3], v[136:139], a[120:123], a[0:3]
s_waitcnt vmcnt(10) lgkmcnt(4)
v_mfma_f32_16x16x32_bf16 a[0:3], a[84:87], a[80:83], a[0:3]
s_waitcnt lgkmcnt(3)
v_mfma_f32_16x16x32_bf16 a[4:7], a[116:119], a[80:83], a[4:7]
buffer_load_dwordx4 a[104:107], v4, s[52:55], s6 offen sc1
v_mfma_f32_16x16x32_bf16 a[4:7], v[140:143], a[120:123], a[4:7]
v_mfma_f32_16x16x32_bf16 a[8:11], v[144:147], a[120:123], a[8:11]
s_waitcnt lgkmcnt(2)
v_mfma_f32_16x16x32_bf16 a[8:11], a[108:111], a[80:83], a[8:11]
s_waitcnt lgkmcnt(1)
v_mfma_f32_16x16x32_bf16 a[12:15], a[100:103], a[80:83], a[12:15]
buffer_load_dwordx4 a[92:95], v4, s[52:55], s7 offen sc1
v_mfma_f32_16x16x32_bf16 a[12:15], v[148:151], a[120:123], a[12:15]
v_mfma_f32_16x16x32_bf16 a[16:19], v[152:155], a[120:123], a[16:19]
s_waitcnt lgkmcnt(0)
v_mfma_f32_16x16x32_bf16 a[16:19], a[96:99], a[80:83], a[16:19]
s_waitcnt vmcnt(11)
v_mfma_f32_16x16x32_bf16 a[36:39], a[96:99], a[252:255], a[36:39]
s_waitcnt vmcnt(10)
buffer_load_dwordx4 a[232:235], v5, s[52:55], s7 offen sc1
v_mfma_f32_16x16x32_bf16 a[36:39], v[152:155], a[248:251], a[36:39]
v_mfma_f32_16x16x32_bf16 a[32:35], v[148:151], a[248:251], a[32:35]
v_mfma_f32_16x16x32_bf16 a[32:35], a[100:103], a[252:255], a[32:35]
v_mfma_f32_16x16x32_bf16 a[28:31], a[108:111], a[252:255], a[28:31]
v_mfma_f32_16x16x32_bf16 a[28:31], v[144:147], a[248:251], a[28:31]
v_mfma_f32_16x16x32_bf16 a[24:27], v[140:143], a[248:251], a[24:27]
v_mfma_f32_16x16x32_bf16 a[24:27], a[116:119], a[252:255], a[24:27]
v_mfma_f32_16x16x32_bf16 a[20:23], a[84:87], a[252:255], a[20:23]
v_mfma_f32_16x16x32_bf16 a[20:23], v[136:139], a[248:251], a[20:23]
s_waitcnt vmcnt(10)
v_mfma_f32_16x16x32_bf16 a[40:43], v[136:139], a[244:247], a[40:43]
s_waitcnt vmcnt(9)
v_mfma_f32_16x16x32_bf16 a[40:43], a[84:87], a[236:239], a[40:43]
ds_read_b128 a[120:123], v14 offset:32768
v_mfma_f32_16x16x32_bf16 a[44:47], a[116:119], a[236:239], a[44:47]
v_mfma_f32_16x16x32_bf16 a[44:47], v[140:143], a[244:247], a[44:47]
ds_read_b128 a[80:83], v14 offset:33792
v_mfma_f32_16x16x32_bf16 a[48:51], v[144:147], a[244:247], a[48:51]
v_mfma_f32_16x16x32_bf16 a[48:51], a[108:111], a[236:239], a[48:51]
ds_read_b128 a[252:255], v14 offset:34816
v_mfma_f32_16x16x32_bf16 a[52:55], a[100:103], a[236:239], a[52:55]
v_mfma_f32_16x16x32_bf16 a[52:55], v[148:151], a[244:247], a[52:55]
ds_read_b128 a[248:251], v14 offset:35840
v_mfma_f32_16x16x32_bf16 a[56:59], v[152:155], a[244:247], a[56:59]
buffer_load_dwordx4 a[244:247], v5, s[52:55], s6 offen sc1
v_mfma_f32_16x16x32_bf16 a[56:59], a[96:99], a[236:239], a[56:59]
s_waitcnt vmcnt(9)
s_add_u32 s10, s20, 0
v_mfma_f32_16x16x32_bf16 a[76:79], a[96:99], a[240:243], a[76:79]
s_waitcnt vmcnt(8)
s_add_u32 s11, s20, 16384
v_mfma_f32_16x16x32_bf16 a[76:79], v[152:155], a[88:91], a[76:79]
v_mfma_f32_16x16x32_bf16 a[72:75], v[148:151], a[88:91], a[72:75]
v_cmp_ne_u32 vcc, 0, v13
s_andn2_b32 s8, 0xff, vcc_lo
s_cbranch_scc1 L_spin2
L_spin_ret2:
s_barrier
buffer_load_dwordx4 a[236:239], v2, s[52:55], s10 offen sc1
v_mfma_f32_16x16x32_bf16 a[72:75], a[100:103], a[240:243], a[72:75]
v_mfma_f32_16x16x32_bf16 a[68:71], a[108:111], a[240:243], a[68:71]
buffer_load_dwordx4 a[96:99], v2, s[52:55], s11 offen sc1
v_mfma_f32_16x16x32_bf16 a[68:71], v[144:147], a[88:91], a[68:71]
v_mfma_f32_16x16x32_bf16 a[64:67], v[140:143], a[88:91], a[64:67]
buffer_load_dwordx4 a[100:103], v3, s[52:55], s11 offen sc1
v_mfma_f32_16x16x32_bf16 a[64:67], a[116:119], a[240:243], a[64:67]
v_mfma_f32_16x16x32_bf16 a[60:63], a[84:87], a[240:243], a[60:63]
buffer_load_dwordx4 a[108:111], v3, s[52:55], s10 offen sc1
v_mfma_f32_16x16x32_bf16 a[60:63], v[136:139], a[88:91], a[60:63]
s_waitcnt vmcnt(11)
v_mfma_f32_16x16x32_bf16 a[0:3], a[128:131], a[228:231], a[0:3]
s_waitcnt vmcnt(10) lgkmcnt(3)
v_mfma_f32_16x16x32_bf16 a[0:3], a[120:123], a[224:227], a[0:3]
s_waitcnt lgkmcnt(2)
v_mfma_f32_16x16x32_bf16 a[4:7], a[80:83], a[224:227], a[4:7]
buffer_load_dwordx4 a[116:119], v4, s[52:55], s10 offen sc1
v_mfma_f32_16x16x32_bf16 a[4:7], a[132:135], a[228:231], a[4:7]
v_mfma_f32_16x16x32_bf16 a[8:11], a[136:139], a[228:231], a[8:11]
s_waitcnt lgkmcnt(1)
v_mfma_f32_16x16x32_bf16 a[8:11], a[252:255], a[224:227], a[8:11]
s_waitcnt lgkmcnt(0)
v_mfma_f32_16x16x32_bf16 a[12:15], a[248:251], a[224:227], a[12:15]
buffer_load_dwordx4 a[84:87], v4, s[52:55], s11 offen sc1
v_mfma_f32_16x16x32_bf16 a[12:15], a[140:143], a[228:231], a[12:15]
v_mfma_f32_16x16x32_bf16 a[16:19], v[156:159], a[228:231], a[16:19]
v_mfma_f32_16x16x32_bf16 a[16:19], a[144:147], a[224:227], a[16:19]
s_waitcnt vmcnt(11)
ds_write_b128 v6, a[0:3] offset:0
v_mfma_f32_16x16x32_bf16 a[20:23], a[120:123], a[124:127], a[20:23]
s_waitcnt vmcnt(10)
buffer_load_dwordx4 a[240:243], v5, s[52:55], s11 offen sc1
v_mfma_f32_16x16x32_bf16 a[20:23], a[128:131], a[112:115], a[20:23]
ds_write_b128 v6, a[4:7] offset:1024
v_mfma_f32_16x16x32_bf16 a[24:27], a[132:135], a[112:115], a[24:27]
v_mfma_f32_16x16x32_bf16 a[24:27], a[80:83], a[124:127], a[24:27]
ds_write_b128 v6, a[8:11] offset:2048
v_mfma_f32_16x16x32_bf16 a[28:31], a[252:255], a[124:127], a[28:31]
buffer_load_dwordx4 a[88:91], v5, s[52:55], s10 offen sc1
v_mfma_f32_16x16x32_bf16 a[28:31], a[136:139], a[112:115], a[28:31]
s_add_u32 s4, s20, 32768
ds_write_b128 v6, a[12:15] offset:3072
v_mfma_f32_16x16x32_bf16 a[32:35], a[140:143], a[112:115], a[32:35]
s_add_u32 s5, s20, 49152
v_mfma_f32_16x16x32_bf16 a[32:35], a[248:251], a[124:127], a[32:35]
ds_write_b128 v6, a[16:19] offset:4096
v_mfma_f32_16x16x32_bf16 a[36:39], a[144:147], a[124:127], a[36:39]
buffer_load_dwordx4 a[228:231], v2, s[52:55], s4 offen sc1
v_mfma_f32_16x16x32_bf16 a[36:39], v[156:159], a[112:115], a[36:39]
s_waitcnt vmcnt(12)
ds_write_b128 v7, a[20:23] offset:0
v_mfma_f32_16x16x32_bf16 a[40:43], a[128:131], a[104:107], a[40:43]
s_waitcnt vmcnt(11)
v_mfma_f32_16x16x32_bf16 a[40:43], a[120:123], a[92:95], a[40:43]
ds_write_b128 v7, a[24:27] offset:1024
v_mfma_f32_16x16x32_bf16 a[44:47], a[80:83], a[92:95], a[44:47]
buffer_load_dwordx4 a[224:227], v2, s[52:55], s5 offen sc1
v_mfma_f32_16x16x32_bf16 a[44:47], a[132:135], a[104:107], a[44:47]
ds_write_b128 v7, a[28:31] offset:2048
v_mfma_f32_16x16x32_bf16 a[48:51], a[136:139], a[104:107], a[48:51]
v_mfma_f32_16x16x32_bf16 a[48:51], a[252:255], a[92:95], a[48:51]
ds_write_b128 v7, a[32:35] offset:3072
v_mfma_f32_16x16x32_bf16 a[52:55], a[248:251], a[92:95], a[52:55]
buffer_load_dwordx4 a[124:127], v3, s[52:55], s5 offen sc1
v_mfma_f32_16x16x32_bf16 a[52:55], a[140:143], a[104:107], a[52:55]
ds_write_b128 v7, a[36:39] offset:4096
v_mfma_f32_16x16x32_bf16 a[56:59], v[156:159], a[104:107], a[56:59]
v_mfma_f32_16x16x32_bf16 a[56:59], a[144:147], a[92:95], a[56:59]
s_waitcnt vmcnt(12)
ds_write_b128 v8, a[40:43] offset:0
v_mfma_f32_16x16x32_bf16 a[60:63], a[120:123], a[232:235], a[60:63]
s_waitcnt vmcnt(11)
buffer_load_dwordx4 a[112:115], v3, s[52:55], s4 offen sc1
v_mfma_f32_16x16x32_bf16 a[60:63], a[128:131], a[244:247], a[60:63]
ds_write_b128 v8, a[44:47] offset:1024
v_mfma_f32_16x16x32_bf16 a[64:67], a[132:135], a[244:247], a[64:67]
v_mfma_f32_16x16x32_bf16 a[64:67], a[80:83], a[232:235], a[64:67]
ds_write_b128 v8, a[48:51] offset:2048
v_mfma_f32_16x16x32_bf16 a[68:71], a[252:255], a[232:235], a[68:71]
buffer_load_dwordx4 a[104:107], v4, s[52:55], s4 offen sc1
v_mfma_f32_16x16x32_bf16 a[68:71], a[136:139], a[244:247], a[68:71]
ds_write_b128 v8, a[52:55] offset:3072
v_mfma_f32_16x16x32_bf16 a[72:75], a[140:143], a[244:247], a[72:75]
v_mfma_f32_16x16x32_bf16 a[72:75], a[248:251], a[232:235], a[72:75]
ds_write_b128 v8, a[56:59] offset:4096
v_mfma_f32_16x16x32_bf16 a[76:79], a[144:147], a[232:235], a[76:79]
buffer_load_dwordx4 a[92:95], v4, s[52:55], s5 offen sc1
v_mfma_f32_16x16x32_bf16 a[76:79], v[156:159], a[244:247], a[76:79]
s_waitcnt vmcnt(13)
v_mfma_f32_16x16x32_bf16 v[160:163], a[148:151], a[236:239], 0
s_waitcnt vmcnt(12)
v_mfma_f32_16x16x32_bf16 v[160:163], a[168:171], a[96:99], v[160:163]
v_mfma_f32_16x16x32_bf16 v[164:167], a[172:175], a[96:99], 0
buffer_load_dwordx4 a[120:123], v5, s[52:55], s5 offen sc1
v_mfma_f32_16x16x32_bf16 v[164:167], a[152:155], a[236:239], v[164:167]
s_waitcnt lgkmcnt(0)
s_barrier
v_mfma_f32_16x16x32_bf16 v[168:171], a[156:159], a[236:239], 0
ds_read_b128 v[100:103], v9 offset:0
v_mfma_f32_16x16x32_bf16 v[168:171], a[176:179], a[96:99], v[168:171]
ds_read_b128 v[104:107], v9 offset:5120
v_mfma_f32_16x16x32_bf16 v[172:175], a[180:183], a[96:99], 0
buffer_load_dwordx4 a[80:83], v5, s[52:55], s4 offen sc1
v_mfma_f32_16x16x32_bf16 v[172:175], a[160:163], a[236:239], v[172:175]
s_add_u32 s6, s20, 65536
ds_read_b128 v[108:111], v9 offset:10240
v_accvgpr_read_b32 v96, a60
v_mfma_f32_16x16x32_bf16 v[176:179], a[164:167], a[236:239], 0
s_add_u32 s7, s20, 81920
v_accvgpr_read_b32 v97, a61
v_accvgpr_read_b32 v98, a62
v_mfma_f32_16x16x32_bf16 v[176:179], a[184:187], a[96:99], v[176:179]
s_waitcnt vmcnt(13)
v_accvgpr_read_b32 v99, a63
s_waitcnt lgkmcnt(2)
v_mfma_f32_16x16x32_bf16 v[196:199], a[184:187], a[100:103], 0
s_waitcnt vmcnt(12)
buffer_load_dwordx4 a[252:255], v2, s[52:55], s6 offen sc1
v_mfma_f32_16x16x32_bf16 v[196:199], a[164:167], a[108:111], v[196:199]
v_add_f32 v96, v96, v100
v_add_f32 v97, v97, v101
v_mfma_f32_16x16x32_bf16 v[192:195], a[160:163], a[108:111], 0
v_add_f32 v98, v98, v102
v_add_f32 v99, v99, v103
v_mfma_f32_16x16x32_bf16 v[192:195], a[180:183], a[100:103], v[192:195]
ds_read_b128 v[100:103], v9 offset:1024
s_waitcnt lgkmcnt(2)
v_mfma_f32_16x16x32_bf16 v[188:191], a[176:179], a[100:103], 0
buffer_load_dwordx4 a[248:251], v2, s[52:55], s7 offen sc1
v_mfma_f32_16x16x32_bf16 v[188:191], a[156:159], a[108:111], v[188:191]
v_add_f32 v96, v96, v104
v_add_f32 v97, v97, v105
v_mfma_f32_16x16x32_bf16 v[184:187], a[152:155], a[108:111], 0
v_add_f32 v98, v98, v106
v_add_f32 v99, v99, v107
v_mfma_f32_16x16x32_bf16 v[184:187], a[172:175], a[100:103], v[184:187]
ds_read_b128 v[104:107], v9 offset:6144
s_waitcnt lgkmcnt(2)
v_mfma_f32_16x16x32_bf16 v[180:183], a[168:171], a[100:103], 0
buffer_load_dwordx4 a[232:235], v3, s[52:55], s7 offen sc1
v_mfma_f32_16x16x32_bf16 v[180:183], a[148:151], a[108:111], v[180:183]
s_waitcnt vmcnt(14)
v_add_f32 v96, v96, v108
v_add_f32 v97, v97, v109
v_mfma_f32_16x16x32_bf16 v[200:203], a[148:151], a[116:119], 0
s_waitcnt vmcnt(13)
v_add_f32 v98, v98, v110
v_add_f32 v99, v99, v111
v_mfma_f32_16x16x32_bf16 v[200:203], a[168:171], a[84:87], v[200:203]
ds_read_b128 v[108:111], v9 offset:11264
v_cvt_pk_bf16_f32 v24, v96, v97
v_mfma_f32_16x16x32_bf16 v[204:207], a[172:175], a[84:87], 0
buffer_load_dwordx4 a[244:247], v3, s[52:55], s6 offen sc1
v_mfma_f32_16x16x32_bf16 v[204:207], a[152:155], a[116:119], v[204:207]
v_cvt_pk_bf16_f32 v25, v98, v99
v_accvgpr_read_b32 v96, a64
v_mfma_f32_16x16x32_bf16 v[208:211], a[156:159], a[116:119], 0
v_accvgpr_read_b32 v97, a65
v_accvgpr_read_b32 v98, a66
v_mfma_f32_16x16x32_bf16 v[208:211], a[176:179], a[84:87], v[208:211]
v_accvgpr_read_b32 v99, a67
s_waitcnt lgkmcnt(2)
v_mfma_f32_16x16x32_bf16 v[212:215], a[180:183], a[84:87], 0
buffer_load_dwordx4 a[236:239], v4, s[52:55], s6 offen sc1
v_mfma_f32_16x16x32_bf16 v[212:215], a[160:163], a[116:119], v[212:215]
v_add_f32 v96, v96, v100
v_add_f32 v97, v97, v101
v_mfma_f32_16x16x32_bf16 v[216:219], a[164:167], a[116:119], 0
v_add_f32 v98, v98, v102
v_add_f32 v99, v99, v103
v_mfma_f32_16x16x32_bf16 v[216:219], a[184:187], a[84:87], v[216:219]
s_waitcnt vmcnt(14)
ds_read_b128 v[100:103], v9 offset:2048
s_waitcnt lgkmcnt(2)
v_mfma_f32_16x16x32_bf16 v[236:239], a[184:187], a[240:243], 0
s_waitcnt vmcnt(13)
buffer_load_dwordx4 a[96:99], v4, s[52:55], s7 offen sc1
v_mfma_f32_16x16x32_bf16 v[236:239], a[164:167], a[88:91], v[236:239]
v_add_f32 v96, v96, v104
v_add_f32 v97, v97, v105
v_mfma_f32_16x16x32_bf16 v[232:235], a[160:163], a[88:91], 0
v_add_f32 v98, v98, v106
v_add_f32 v99, v99, v107
v_mfma_f32_16x16x32_bf16 v[232:235], a[180:183], a[240:243], v[232:235]
ds_read_b128 v[104:107], v9 offset:7168
s_waitcnt lgkmcnt(2)
v_mfma_f32_16x16x32_bf16 v[228:231], a[176:179], a[240:243], 0
buffer_load_dwordx4 a[100:103], v5, s[52:55], s7 offen sc1
v_mfma_f32_16x16x32_bf16 v[228:231], a[156:159], a[88:91], v[228:231]
v_add_f32 v96, v96, v108
v_add_f32 v97, v97, v109
v_mfma_f32_16x16x32_bf16 v[224:227], a[152:155], a[88:91], 0
v_add_f32 v98, v98, v110
v_add_f32 v99, v99, v111
v_mfma_f32_16x16x32_bf16 v[224:227], a[172:175], a[240:243], v[224:227]
ds_read_b128 v[108:111], v9 offset:12288
v_cvt_pk_bf16_f32 v26, v96, v97
v_mfma_f32_16x16x32_bf16 v[220:223], a[168:171], a[240:243], 0
buffer_load_dwordx4 a[108:111], v5, s[52:55], s6 offen sc1
v_mfma_f32_16x16x32_bf16 v[220:223], a[148:151], a[88:91], v[220:223]
s_waitcnt vmcnt(15)
v_cvt_pk_bf16_f32 v27, v98, v99
v_mfma_f32_16x16x32_bf16 v[160:163], a[188:191], a[228:231], v[160:163]
s_waitcnt vmcnt(14)
buffer_store_dwordx4 v[24:27], v11, s[52:55], s64 offen offset:0 sc1
v_mfma_f32_16x16x32_bf16 v[160:163], a[208:211], a[224:227], v[160:163]
s_add_u32 s10, s20, 98304
v_accvgpr_read_b32 v96, a68
v_accvgpr_read_b32 v97, a69
v_mfma_f32_16x16x32_bf16 v[164:167], a[212:215], a[224:227], v[164:167]
s_add_u32 s11, s20, 114688
buffer_load_dwordx4 a[116:119], v2, s[52:55], s10 offen sc1
v_mfma_f32_16x16x32_bf16 v[164:167], a[192:195], a[228:231], v[164:167]
v_accvgpr_read_b32 v98, a70
v_accvgpr_read_b32 v99, a71
v_mfma_f32_16x16x32_bf16 v[168:171], a[196:199], a[228:231], v[168:171]
s_waitcnt lgkmcnt(2)
v_add_f32 v96, v96, v100
v_mfma_f32_16x16x32_bf16 v[168:171], a[216:219], a[224:227], v[168:171]
v_add_f32 v97, v97, v101
v_add_f32 v98, v98, v102
v_mfma_f32_16x16x32_bf16 v[172:175], a[220:223], a[224:227], v[172:175]
buffer_load_dwordx4 a[84:87], v2, s[52:55], s11 offen sc1
v_mfma_f32_16x16x32_bf16 v[172:175], a[200:203], a[228:231], v[172:175]
v_add_f32 v99, v99, v103
v_mfma_f32_16x16x32_bf16 v[176:179], a[204:207], a[228:231], v[176:179]
ds_read_b128 v[100:103], v9 offset:3072
s_waitcnt lgkmcnt(2)
v_mfma_f32_16x16x32_bf16 v[176:179], v[32:35], a[224:227], v[176:179]
s_waitcnt vmcnt(16)
v_add_f32 v96, v96, v104
v_add_f32 v97, v97, v105
v_mfma_f32_16x16x32_bf16 v[196:199], v[32:35], a[124:127], v[196:199]
s_waitcnt vmcnt(15)
buffer_load_dwordx4 a[184:187], v3, s[52:55], s11 offen sc1
v_mfma_f32_16x16x32_bf16 v[196:199], a[204:207], a[112:115], v[196:199]
v_add_f32 v98, v98, v106
v_add_f32 v99, v99, v107
v_mfma_f32_16x16x32_bf16 v[192:195], a[200:203], a[112:115], v[192:195]
ds_read_b128 v[104:107], v9 offset:8192
s_waitcnt lgkmcnt(2)
v_mfma_f32_16x16x32_bf16 v[192:195], a[220:223], a[124:127], v[192:195]
v_add_f32 v96, v96, v108
v_add_f32 v97, v97, v109
v_mfma_f32_16x16x32_bf16 v[188:191], a[216:219], a[124:127], v[188:191]
buffer_load_dwordx4 a[164:167], v3, s[52:55], s10 offen sc1
v_mfma_f32_16x16x32_bf16 v[188:191], a[196:199], a[112:115], v[188:191]
v_add_f32 v98, v98, v110
v_add_f32 v99, v99, v111
v_mfma_f32_16x16x32_bf16 v[184:187], a[192:195], a[112:115], v[184:187]
ds_read_b128 v[108:111], v9 offset:13312
v_cvt_pk_bf16_f32 v24, v96, v97
v_mfma_f32_16x16x32_bf16 v[184:187], a[212:215], a[124:127], v[184:187]
v_cvt_pk_bf16_f32 v25, v98, v99
v_accvgpr_read_b32 v96, a72
v_mfma_f32_16x16x32_bf16 v[180:183], a[208:211], a[124:127], v[180:183]
v_accvgpr_read_b32 v97, a73
v_accvgpr_read_b32 v98, a74
v_mfma_f32_16x16x32_bf16 v[180:183], a[188:191], a[112:115], v[180:183]
s_waitcnt vmcnt(16)
v_accvgpr_read_b32 v99, a75
s_waitcnt lgkmcnt(2)
v_mfma_f32_16x16x32_bf16 v[200:203], a[188:191], a[104:107], v[200:203]
s_waitcnt vmcnt(15)
buffer_load_dwordx4 a[160:163], v4, s[52:55], s10 offen sc1
v_mfma_f32_16x16x32_bf16 v[200:203], a[208:211], a[92:95], v[200:203]
v_add_f32 v96, v96, v100
v_add_f32 v97, v97, v101
v_mfma_f32_16x16x32_bf16 v[204:207], a[212:215], a[92:95], v[204:207]
v_add_f32 v98, v98, v102
v_add_f32 v99, v99, v103
v_mfma_f32_16x16x32_bf16 v[204:207], a[192:195], a[104:107], v[204:207]
ds_read_b128 v[100:103], v9 offset:4096
s_waitcnt lgkmcnt(2)
v_mfma_f32_16x16x32_bf16 v[208:211], a[196:199], a[104:107], v[208:211]
buffer_load_dwordx4 a[180:183], v4, s[52:55], s11 offen sc1
v_mfma_f32_16x16x32_bf16 v[208:211], a[216:219], a[92:95], v[208:211]
v_add_f32 v96, v96, v104
v_add_f32 v97, v97, v105
v_mfma_f32_16x16x32_bf16 v[212:215], a[220:223], a[92:95], v[212:215]
v_add_f32 v98, v98, v106
v_add_f32 v99, v99, v107
v_mfma_f32_16x16x32_bf16 v[212:215], a[200:203], a[104:107], v[212:215]
ds_read_b128 v[104:107], v9 offset:9216
s_waitcnt lgkmcnt(2)
v_mfma_f32_16x16x32_bf16 v[216:219], a[204:207], a[104:107], v[216:219]
v_add_f32 v96, v96, v108
v_add_f32 v97, v97, v109
v_mfma_f32_16x16x32_bf16 v[216:219], v[32:35], a[92:95], v[216:219]
s_waitcnt vmcnt(16)
v_add_f32 v98, v98, v110
v_add_f32 v99, v99, v111
v_mfma_f32_16x16x32_bf16 v[236:239], v[32:35], a[120:123], v[236:239]
s_waitcnt vmcnt(15)
buffer_load_dwordx4 a[176:179], v5, s[52:55], s11 offen sc1
v_mfma_f32_16x16x32_bf16 v[236:239], a[204:207], a[80:83], v[236:239]
ds_read_b128 v[108:111], v9 offset:14336
v_cvt_pk_bf16_f32 v26, v96, v97
v_mfma_f32_16x16x32_bf16 v[232:235], a[200:203], a[80:83], v[232:235]
v_cvt_pk_bf16_f32 v27, v98, v99
v_mfma_f32_16x16x32_bf16 v[232:235], a[220:223], a[120:123], v[232:235]
v_mfma_f32_16x16x32_bf16 v[228:231], a[216:219], a[120:123], v[228:231]
buffer_load_dwordx4 a[156:159], v5, s[52:55], s10 offen sc1
v_mfma_f32_16x16x32_bf16 v[228:231], a[196:199], a[80:83], v[228:231]
s_add_u32 s4, s21, 0
s_add_u32 s5, s21, 16384
v_mfma_f32_16x16x32_bf16 v[224:227], a[192:195], a[80:83], v[224:227]
buffer_store_dwordx4 v[24:27], v11, s[52:55], s64 offen offset:1024 sc1
v_mfma_f32_16x16x32_bf16 v[224:227], a[212:215], a[120:123], v[224:227]
v_accvgpr_read_b32 v96, a76
v_accvgpr_read_b32 v97, a77
v_mfma_f32_16x16x32_bf16 v[220:223], a[208:211], a[120:123], v[220:223]
v_accvgpr_read_b32 v98, a78
v_accvgpr_read_b32 v99, a79
v_mfma_f32_16x16x32_bf16 v[220:223], a[188:191], a[80:83], v[220:223]
s_waitcnt vmcnt(17)
s_waitcnt lgkmcnt(2)
v_add_f32 v96, v96, v100
v_mfma_f32_16x16x32_bf16 v[160:163], v[36:39], a[252:255], v[160:163]
s_waitcnt vmcnt(16)
buffer_load_dwordx4 a[152:155], v2, s[52:55], s4 offen sc1
v_mfma_f32_16x16x32_bf16 v[160:163], v[56:59], a[248:251], v[160:163]
v_add_f32 v97, v97, v101
v_add_f32 v98, v98, v102
v_mfma_f32_16x16x32_bf16 v[164:167], v[60:63], a[248:251], v[164:167]
v_add_f32 v99, v99, v103
s_waitcnt lgkmcnt(1)
v_mfma_f32_16x16x32_bf16 v[164:167], v[40:43], a[252:255], v[164:167]
v_add_f32 v96, v96, v104
v_add_f32 v97, v97, v105
v_mfma_f32_16x16x32_bf16 v[168:171], v[44:47], a[252:255], v[168:171]
buffer_load_dwordx4 a[172:175], v2, s[52:55], s5 offen sc1
v_mfma_f32_16x16x32_bf16 v[168:171], v[64:67], a[248:251], v[168:171]
v_add_f32 v98, v98, v106
v_add_f32 v99, v99, v107
v_mfma_f32_16x16x32_bf16 v[172:175], v[68:71], a[248:251], v[172:175]
s_waitcnt lgkmcnt(0)
v_add_f32 v96, v96, v108
v_mfma_f32_16x16x32_bf16 v[172:175], v[48:51], a[252:255], v[172:175]
v_add_f32 v97, v97, v109
v_add_f32 v98, v98, v110
v_mfma_f32_16x16x32_bf16 v[176:179], v[52:55], a[252:255], v[176:179]
v_add_f32 v99, v99, v111
v_cvt_pk_bf16_f32 v24, v96, v97
v_mfma_f32_16x16x32_bf16 v[176:179], v[72:75], a[248:251], v[176:179]
s_waitcnt vmcnt(17)
v_cvt_pk_bf16_f32 v25, v98, v99
v_mfma_f32_16x16x32_bf16 v[196:199], v[72:75], a[232:235], v[196:199]
s_waitcnt vmcnt(16)
buffer_load_dwordx4 a[168:171], v3, s[52:55], s5 offen sc1
v_mfma_f32_16x16x32_bf16 v[196:199], v[52:55], a[244:247], v[196:199]
v_mfma_f32_16x16x32_bf16 v[192:195], v[48:51], a[244:247], v[192:195]
buffer_store_dwordx2 v[24:25], v17, s[52:55], s64 offen offset:2048 sc1
v_mfma_f32_16x16x32_bf16 v[192:195], v[68:71], a[232:235], v[192:195]
v_mfma_f32_16x16x32_bf16 v[188:191], v[64:67], a[232:235], v[188:191]
buffer_load_dwordx4 a[240:243], v3, s[52:55], s4 offen sc1
v_mfma_f32_16x16x32_bf16 v[188:191], v[44:47], a[244:247], v[188:191]
v_mfma_f32_16x16x32_bf16 v[184:187], v[40:43], a[244:247], v[184:187]
v_mfma_f32_16x16x32_bf16 v[184:187], v[60:63], a[232:235], v[184:187]
v_mfma_f32_16x16x32_bf16 v[180:183], v[56:59], a[232:235], v[180:183]
v_mfma_f32_16x16x32_bf16 v[180:183], v[36:39], a[244:247], v[180:183]
s_waitcnt vmcnt(18)
v_mfma_f32_16x16x32_bf16 v[200:203], v[36:39], a[236:239], v[200:203]
s_waitcnt vmcnt(17)
buffer_load_dwordx4 a[148:151], v4, s[52:55], s4 offen sc1
v_mfma_f32_16x16x32_bf16 v[200:203], v[56:59], a[96:99], v[200:203]
ds_read_b128 a[88:91], v16 offset:0
v_mfma_f32_16x16x32_bf16 v[204:207], v[60:63], a[96:99], v[204:207]
v_mfma_f32_16x16x32_bf16 v[204:207], v[40:43], a[236:239], v[204:207]
ds_read_b128 a[228:231], v16 offset:1024
v_mfma_f32_16x16x32_bf16 v[208:211], v[44:47], a[236:239], v[208:211]
buffer_load_dwordx4 a[224:227], v4, s[52:55], s5 offen sc1
v_mfma_f32_16x16x32_bf16 v[208:211], v[64:67], a[96:99], v[208:211]
ds_read_b128 a[124:127], v16 offset:2048
v_mfma_f32_16x16x32_bf16 v[212:215], v[68:71], a[96:99], v[212:215]
v_mfma_f32_16x16x32_bf16 v[212:215], v[48:51], a[236:239], v[212:215]
ds_read_b128 a[112:115], v16 offset:3072
v_mfma_f32_16x16x32_bf16 v[216:219], v[52:55], a[236:239], v[216:219]
v_mfma_f32_16x16x32_bf16 v[216:219], v[72:75], a[96:99], v[216:219]
s_waitcnt vmcnt(18)
ds_read_b128 a[104:107], v16 offset:16384
v_mfma_f32_16x16x32_bf16 v[236:239], v[72:75], a[100:103], v[236:239]
s_waitcnt vmcnt(17)
buffer_load_dwordx4 a[92:95], v5, s[52:55], s5 offen sc1
v_mfma_f32_16x16x32_bf16 v[236:239], v[52:55], a[108:111], v[236:239]
v_mfma_f32_16x16x32_bf16 v[232:235], v[48:51], a[108:111], v[232:235]
v_mfma_f32_16x16x32_bf16 v[232:235], v[68:71], a[100:103], v[232:235]
v_mfma_f32_16x16x32_bf16 v[228:231], v[64:67], a[100:103], v[228:231]
buffer_load_dwordx4 v[32:35], v5, s[52:55], s4 offen sc1
v_mfma_f32_16x16x32_bf16 v[228:231], v[44:47], a[108:111], v[228:231]
s_add_u32 s6, s21, 32768
s_add_u32 s7, s21, 49152
v_mfma_f32_16x16x32_bf16 v[224:227], v[40:43], a[108:111], v[224:227]
s_add_u32 s10, s21, 65536
s_add_u32 s11, s21, 81920
v_mfma_f32_16x16x32_bf16 v[224:227], v[60:63], a[100:103], v[224:227]
s_add_u32 s4, s21, 98304
s_add_u32 s5, s21, 114688
v_mfma_f32_16x16x32_bf16 v[220:223], v[56:59], a[100:103], v[220:223]
v_mfma_f32_16x16x32_bf16 v[220:223], v[36:39], a[108:111], v[220:223]
s_waitcnt vmcnt(17)
v_mfma_f32_16x16x32_bf16 v[160:163], v[76:79], a[116:119], v[160:163]
s_waitcnt vmcnt(16) lgkmcnt(4)
buffer_load_dwordx4 a[204:207], v2, s[52:55], s6 offen sc1
v_mfma_f32_16x16x32_bf16 v[160:163], a[88:91], a[84:87], v[160:163]
s_waitcnt lgkmcnt(3)
v_mfma_f32_16x16x32_bf16 v[164:167], a[228:231], a[84:87], v[164:167]
v_mfma_f32_16x16x32_bf16 v[164:167], v[80:83], a[116:119], v[164:167]
v_mfma_f32_16x16x32_bf16 v[168:171], v[84:87], a[116:119], v[168:171]
s_waitcnt lgkmcnt(2)
buffer_load_dwordx4 a[200:203], v2, s[52:55], s7 offen sc1
v_mfma_f32_16x16x32_bf16 v[168:171], a[124:127], a[84:87], v[168:171]
s_waitcnt lgkmcnt(1)
v_mfma_f32_16x16x32_bf16 v[172:175], a[112:115], a[84:87], v[172:175]
v_mfma_f32_16x16x32_bf16 v[172:175], v[88:91], a[116:119], v[172:175]
v_mfma_f32_16x16x32_bf16 v[176:179], v[92:95], a[116:119], v[176:179]
s_waitcnt lgkmcnt(0)
buffer_load_dwordx4 a[220:223], v2, s[52:55], s10 offen sc1
v_mfma_f32_16x16x32_bf16 v[176:179], a[104:107], a[84:87], v[176:179]
s_waitcnt vmcnt(18)
v_mfma_f32_16x16x32_bf16 v[196:199], a[104:107], a[184:187], v[196:199]
s_waitcnt vmcnt(17)
v_mfma_f32_16x16x32_bf16 v[196:199], v[92:95], a[164:167], v[196:199]
v_mfma_f32_16x16x32_bf16 v[192:195], v[88:91], a[164:167], v[192:195]
buffer_load_dwordx4 a[216:219], v2, s[52:55], s11 offen sc1
v_mfma_f32_16x16x32_bf16 v[192:195], a[112:115], a[184:187], v[192:195]
v_mfma_f32_16x16x32_bf16 v[188:191], a[124:127], a[184:187], v[188:191]
v_mfma_f32_16x16x32_bf16 v[188:191], v[84:87], a[164:167], v[188:191]
v_mfma_f32_16x16x32_bf16 v[184:187], v[80:83], a[164:167], v[184:187]
buffer_load_dwordx4 a[196:199], v2, s[52:55], s4 offen sc1
v_mfma_f32_16x16x32_bf16 v[184:187], a[228:231], a[184:187], v[184:187]
v_mfma_f32_16x16x32_bf16 v[180:183], a[88:91], a[184:187], v[180:183]
v_mfma_f32_16x16x32_bf16 v[180:183], v[76:79], a[164:167], v[180:183]
s_waitcnt vmcnt(18)
v_mfma_f32_16x16x32_bf16 v[200:203], v[76:79], a[160:163], v[200:203]
s_waitcnt vmcnt(17)
buffer_load_dwordx4 a[192:195], v2, s[52:55], s5 offen sc1
v_mfma_f32_16x16x32_bf16 v[200:203], a[88:91], a[180:183], v[200:203]
ds_read_b128 a[212:215], v14 offset:0
v_mfma_f32_16x16x32_bf16 v[204:207], a[228:231], a[180:183], v[204:207]
s_waitcnt vmcnt(11)
buffer_store_dword v18, v20, s[52:55], s63 offen sc1
v_mfma_f32_16x16x32_bf16 v[204:207], v[80:83], a[160:163], v[204:207]
ds_read_b128 a[208:211], v14 offset:1024
v_mfma_f32_16x16x32_bf16 v[208:211], v[84:87], a[160:163], v[208:211]
v_mfma_f32_16x16x32_bf16 v[208:211], a[124:127], a[180:183], v[208:211]
ds_read_b128 a[120:123], v14 offset:2048
v_mfma_f32_16x16x32_bf16 v[212:215], a[112:115], a[180:183], v[212:215]
v_mfma_f32_16x16x32_bf16 v[212:215], v[88:91], a[160:163], v[212:215]
ds_read_b128 a[188:191], v14 offset:3072
v_mfma_f32_16x16x32_bf16 v[216:219], v[92:95], a[160:163], v[216:219]
v_mfma_f32_16x16x32_bf16 v[216:219], a[104:107], a[180:183], v[216:219]
ds_read_b128 a[80:83], v16 offset:17408
v_mfma_f32_16x16x32_bf16 v[236:239], a[104:107], a[176:179], v[236:239]
buffer_load_dwordx4 a[252:255], v3, s[52:55], s5 offen sc1
v_mfma_f32_16x16x32_bf16 v[236:239], v[92:95], a[156:159], v[236:239]
v_mfma_f32_16x16x32_bf16 v[232:235], v[88:91], a[156:159], v[232:235]
v_mfma_f32_16x16x32_bf16 v[232:235], a[112:115], a[176:179], v[232:235]
v_mfma_f32_16x16x32_bf16 v[228:231], a[124:127], a[176:179], v[228:231]
buffer_load_dwordx4 a[248:251], v3, s[52:55], s4 offen sc1
v_mfma_f32_16x16x32_bf16 v[228:231], v[84:87], a[156:159], v[228:231]
v_mfma_f32_16x16x32_bf16 v[224:227], v[80:83], a[156:159], v[224:227]
v_mfma_f32_16x16x32_bf16 v[224:227], a[228:231], a[176:179], v[224:227]
v_mfma_f32_16x16x32_bf16 v[220:223], a[88:91], a[176:179], v[220:223]
buffer_load_dwordx4 a[232:235], v3, s[52:55], s11 offen sc1
v_mfma_f32_16x16x32_bf16 v[220:223], v[76:79], a[156:159], v[220:223]
v_mfma_f32_16x16x32_bf16 v[160:163], v[240:243], a[152:155], v[160:163]
s_waitcnt lgkmcnt(4)
v_mfma_f32_16x16x32_bf16 v[160:163], a[212:215], a[172:175], v[160:163]
s_waitcnt lgkmcnt(3)
v_mfma_f32_16x16x32_bf16 v[164:167], a[208:211], a[172:175], v[164:167]
buffer_load_dwordx4 a[244:247], v3, s[52:55], s10 offen sc1
v_mfma_f32_16x16x32_bf16 v[164:167], v[244:247], a[152:155], v[164:167]
v_mfma_f32_16x16x32_bf16 v[168:171], v[248:251], a[152:155], v[168:171]
s_waitcnt lgkmcnt(2)
v_mfma_f32_16x16x32_bf16 v[168:171], a[120:123], a[172:175], v[168:171]
s_waitcnt lgkmcnt(1)
v_mfma_f32_16x16x32_bf16 v[172:175], a[188:191], a[172:175], v[172:175]
buffer_load_dwordx4 a[236:239], v3, s[52:55], s7 offen sc1
v_mfma_f32_16x16x32_bf16 v[172:175], v[252:255], a[152:155], v[172:175]
v_mfma_f32_16x16x32_bf16 v[176:179], v[112:115], a[152:155], v[176:179]
s_waitcnt lgkmcnt(0)
v_mfma_f32_16x16x32_bf16 v[176:179], a[80:83], a[172:175], v[176:179]
v_mfma_f32_16x16x32_bf16 v[196:199], a[80:83], a[168:171], v[196:199]
L_hop9_1:
s_cbranch_execz L_hop_ret9
s_waitcnt vmcnt(16)
buffer_load_dwordx4 a[96:99], v3, s[52:55], s6 offen sc1
v_mfma_f32_16x16x32_bf16 v[196:199], v[112:115], a[240:243], v[196:199]
v_mfma_f32_16x16x32_bf16 v[192:195], v[252:255], a[240:243], v[192:195]
v_mfma_f32_16x16x32_bf16 v[192:195], a[188:191], a[168:171], v[192:195]
v_mfma_f32_16x16x32_bf16 v[188:191], a[120:123], a[168:171], v[188:191]
v_mfma_f32_16x16x32_bf16 v[188:191], v[248:251], a[240:243], v[188:191]
v_mfma_f32_16x16x32_bf16 v[184:187], v[244:247], a[240:243], v[184:187]
v_mfma_f32_16x16x32_bf16 v[184:187], a[208:211], a[168:171], v[184:187]
v_mfma_f32_16x16x32_bf16 v[180:183], a[212:215], a[168:171], v[180:183]
v_mfma_f32_16x16x32_bf16 v[180:183], v[240:243], a[240:243], v[180:183]
s_waitcnt vmcnt(16)
v_mfma_f32_16x16x32_bf16 v[200:203], v[240:243], a[148:151], v[200:203]
s_waitcnt vmcnt(15)
buffer_load_dwordx4 v[72:75], v4, s[52:55], s6 offen sc1
v_mfma_f32_16x16x32_bf16 v[200:203], a[212:215], a[224:227], v[200:203]
ds_read_b128 v[52:55], v14 offset:16384
v_mfma_f32_16x16x32_bf16 v[204:207], a[208:211], a[224:227], v[204:207]
v_mfma_f32_16x16x32_bf16 v[204:207], v[244:247], a[148:151], v[204:207]
ds_read_b128 v[48:51], v15 offset:0
v_mfma_f32_16x16x32_bf16 v[208:211], v[248:251], a[148:151], v[208:211]
buffer_load_dwordx4 v[68:71], v4, s[52:55], s7 offen sc1
v_mfma_f32_16x16x32_bf16 v[208:211], a[120:123], a[224:227], v[208:211]
ds_read_b128 v[64:67], v14 offset:32768
v_mfma_f32_16x16x32_bf16 v[212:215], a[188:191], a[224:227], v[212:215]
v_mfma_f32_16x16x32_bf16 v[212:215], v[252:255], a[148:151], v[212:215]
ds_read_b128 v[44:47], v14 offset:33792
v_mfma_f32_16x16x32_bf16 v[216:219], v[112:115], a[148:151], v[216:219]
buffer_load_dwordx4 v[40:43], v4, s[52:55], s10 offen sc1
v_mfma_f32_16x16x32_bf16 v[216:219], a[80:83], a[224:227], v[216:219]
s_waitcnt vmcnt(17)
ds_read_b128 v[60:63], v15 offset:1024
v_mfma_f32_16x16x32_bf16 v[236:239], a[80:83], a[92:95], v[236:239]
s_waitcnt vmcnt(16)
v_mfma_f32_16x16x32_bf16 v[236:239], v[112:115], v[32:35], v[236:239]
ds_read_b128 v[56:59], v14 offset:17408
v_mfma_f32_16x16x32_bf16 v[232:235], v[252:255], v[32:35], v[232:235]
buffer_load_dwordx4 a[100:103], v4, s[52:55], s11 offen sc1
v_mfma_f32_16x16x32_bf16 v[232:235], a[188:191], a[92:95], v[232:235]
ds_read_b128 v[36:39], v14 offset:18432
v_mfma_f32_16x16x32_bf16 v[228:231], a[120:123], a[92:95], v[228:231]
v_mfma_f32_16x16x32_bf16 v[228:231], v[248:251], v[32:35], v[228:231]
ds_read_b128 a[108:111], v15 offset:2048
v_mfma_f32_16x16x32_bf16 v[224:227], v[244:247], v[32:35], v[224:227]
buffer_load_dwordx4 a[116:119], v4, s[52:55], s4 offen sc1
v_mfma_f32_16x16x32_bf16 v[224:227], a[208:211], a[92:95], v[224:227]
ds_read_b128 a[84:87], v14 offset:34816
v_mfma_f32_16x16x32_bf16 v[220:223], a[212:215], a[92:95], v[220:223]
v_mfma_f32_16x16x32_bf16 v[220:223], v[240:243], v[32:35], v[220:223]
s_waitcnt vmcnt(17)
ds_read_b128 a[184:187], v14 offset:35840
v_mfma_f32_16x16x32_bf16 v[160:163], v[116:119], a[204:207], v[160:163]
s_waitcnt vmcnt(16) lgkmcnt(9)
s_barrier
buffer_load_dwordx4 a[164:167], v4, s[52:55], s5 offen sc1
v_mfma_f32_16x16x32_bf16 v[160:163], v[52:55], a[200:203], v[160:163]
s_waitcnt vmcnt(16)
ds_read_b128 a[160:163], v15 offset:3072
v_mfma_f32_16x16x32_bf16 v[160:163], v[136:139], a[220:223], v[160:163]
s_waitcnt vmcnt(15) lgkmcnt(9)
v_mfma_f32_16x16x32_bf16 v[160:163], v[48:51], a[216:219], v[160:163]
s_waitcnt vmcnt(14)
ds_read_b128 a[180:183], v14 offset:19456
v_mfma_f32_16x16x32_bf16 v[160:163], a[128:131], a[196:199], v[160:163]
s_waitcnt vmcnt(13) lgkmcnt(9)
v_mfma_f32_16x16x32_bf16 v[160:163], v[64:67], a[192:195], v[160:163]
s_waitcnt lgkmcnt(8)
ds_read_b128 a[104:107], v16 offset:18432
v_mfma_f32_16x16x32_bf16 v[164:167], v[44:47], a[192:195], v[164:167]
v_mfma_f32_16x16x32_bf16 v[164:167], a[132:135], a[196:199], v[164:167]
s_waitcnt lgkmcnt(8)
ds_read_b128 v[92:95], v16 offset:19456
v_mfma_f32_16x16x32_bf16 v[164:167], v[60:63], a[216:219], v[164:167]
v_mfma_f32_16x16x32_bf16 v[164:167], v[140:143], a[220:223], v[164:167]
s_waitcnt lgkmcnt(8)
v_mfma_f32_16x16x32_bf16 v[164:167], v[56:59], a[200:203], v[164:167]
buffer_load_dwordx4 v[88:91], v5, s[52:55], s5 offen sc1
v_mfma_f32_16x16x32_bf16 v[164:167], v[120:123], a[204:207], v[164:167]
v_mfma_f32_16x16x32_bf16 v[168:171], v[124:127], a[204:207], v[168:171]
s_waitcnt lgkmcnt(7)
buffer_load_dword v13, v19, s[52:55], s46 offen sc1
v_mfma_f32_16x16x32_bf16 v[168:171], v[36:39], a[200:203], v[168:171]
ds_write_b128 v6, v[160:163] offset:0
v_mfma_f32_16x16x32_bf16 v[168:171], v[144:147], a[220:223], v[168:171]
s_waitcnt lgkmcnt(7)
buffer_load_dwordx4 a[112:115], v5, s[52:55], s4 offen sc1
v_mfma_f32_16x16x32_bf16 v[168:171], a[108:111], a[216:219], v[168:171]
v_mfma_f32_16x16x32_bf16 v[168:171], a[136:139], a[196:199], v[168:171]
s_waitcnt lgkmcnt(6)
v_mfma_f32_16x16x32_bf16 v[168:171], a[84:87], a[192:195], v[168:171]
s_waitcnt lgkmcnt(5)
v_mfma_f32_16x16x32_bf16 v[172:175], a[184:187], a[192:195], v[172:175]
buffer_load_dwordx4 a[124:127], v5, s[52:55], s11 offen sc1
v_mfma_f32_16x16x32_bf16 v[172:175], a[140:143], a[196:199], v[172:175]
s_waitcnt lgkmcnt(4)
ds_write_b128 v6, v[164:167] offset:1024
v_mfma_f32_16x16x32_bf16 v[172:175], a[160:163], a[216:219], v[172:175]
v_mfma_f32_16x16x32_bf16 v[172:175], v[148:151], a[220:223], v[172:175]
s_waitcnt lgkmcnt(4)
v_mfma_f32_16x16x32_bf16 v[172:175], a[180:183], a[200:203], v[172:175]
buffer_load_dwordx4 v[84:87], v5, s[52:55], s10 offen sc1
v_mfma_f32_16x16x32_bf16 v[172:175], v[128:131], a[204:207], v[172:175]
v_mfma_f32_16x16x32_bf16 v[176:179], v[132:135], a[204:207], v[176:179]
s_waitcnt lgkmcnt(3)
v_mfma_f32_16x16x32_bf16 v[176:179], a[104:107], a[200:203], v[176:179]
ds_write_b128 v6, v[168:171] offset:2048
v_mfma_f32_16x16x32_bf16 v[176:179], v[152:155], a[220:223], v[176:179]
s_waitcnt lgkmcnt(3)
buffer_load_dwordx4 v[80:83], v5, s[52:55], s7 offen sc1
v_mfma_f32_16x16x32_bf16 v[176:179], v[92:95], a[216:219], v[176:179]
v_mfma_f32_16x16x32_bf16 v[176:179], v[156:159], a[196:199], v[176:179]
v_mfma_f32_16x16x32_bf16 v[176:179], a[144:147], a[192:195], v[176:179]
s_waitcnt vmcnt(17)
v_mfma_f32_16x16x32_bf16 v[180:183], v[64:67], a[252:255], v[180:183]
s_waitcnt vmcnt(16)
buffer_load_dwordx4 a[228:231], v5, s[52:55], s6 offen sc1
v_mfma_f32_16x16x32_bf16 v[180:183], a[128:131], a[248:251], v[180:183]
s_waitcnt vmcnt(16)
ds_write_b128 v6, v[172:175] offset:3072
v_mfma_f32_16x16x32_bf16 v[180:183], v[48:51], a[232:235], v[180:183]
s_waitcnt vmcnt(15)
v_mfma_f32_16x16x32_bf16 v[180:183], v[136:139], a[244:247], v[180:183]
s_waitcnt vmcnt(14)
v_mfma_f32_16x16x32_bf16 v[180:183], v[52:55], a[236:239], v[180:183]
s_waitcnt vmcnt(13)
v_mfma_f32_16x16x32_bf16 v[180:183], v[116:119], a[96:99], v[180:183]
v_mfma_f32_16x16x32_bf16 v[184:187], v[120:123], a[96:99], v[184:187]
v_mfma_f32_16x16x32_bf16 v[184:187], v[56:59], a[236:239], v[184:187]
ds_write_b128 v6, v[176:179] offset:4096
v_mfma_f32_16x16x32_bf16 v[184:187], v[140:143], a[244:247], v[184:187]
v_mfma_f32_16x16x32_bf16 v[184:187], v[60:63], a[232:235], v[184:187]
v_mfma_f32_16x16x32_bf16 v[184:187], a[132:135], a[248:251], v[184:187]
v_mfma_f32_16x16x32_bf16 v[184:187], v[44:47], a[252:255], v[184:187]
v_mfma_f32_16x16x32_bf16 v[188:191], a[84:87], a[252:255], v[188:191]
v_mfma_f32_16x16x32_bf16 v[188:191], a[136:139], a[248:251], v[188:191]
ds_write_b128 v7, v[180:183] offset:0
v_mfma_f32_16x16x32_bf16 v[188:191], a[108:111], a[232:235], v[188:191]
v_mfma_f32_16x16x32_bf16 v[188:191], v[144:147], a[244:247], v[188:191]
v_mfma_f32_16x16x32_bf16 v[188:191], v[36:39], a[236:239], v[188:191]
v_mfma_f32_16x16x32_bf16 v[188:191], v[124:127], a[96:99], v[188:191]
v_mfma_f32_16x16x32_bf16 v[192:195], v[128:131], a[96:99], v[192:195]
v_mfma_f32_16x16x32_bf16 v[192:195], a[180:183], a[236:239], v[192:195]
ds_write_b128 v7, v[184:187] offset:1024
v_mfma_f32_16x16x32_bf16 v[192:195], v[148:151], a[244:247], v[192:195]
v_mfma_f32_16x16x32_bf16 v[192:195], a[160:163], a[232:235], v[192:195]
v_mfma_f32_16x16x32_bf16 v[192:195], a[140:143], a[248:251], v[192:195]
v_mfma_f32_16x16x32_bf16 v[192:195], a[184:187], a[252:255], v[192:195]
v_mfma_f32_16x16x32_bf16 v[196:199], a[144:147], a[252:255], v[196:199]
s_waitcnt vmcnt(5)
v_cmp_ne_u32 vcc, 0, v13
s_cmp_lg_u32 vcc_lo, 1
s_cbranch_scc1 L_spinx
L_spin_retx:
buffer_load_dwordx4 v[76:79], v11, s[52:55], s65 offen offset:0 sc1
v_mfma_f32_16x16x32_bf16 v[196:199], v[156:159], a[248:251], v[196:199]
ds_write_b128 v7, v[188:191] offset:2048
v_mfma_f32_16x16x32_bf16 v[196:199], v[92:95], a[232:235], v[196:199]
buffer_load_dwordx4 v[112:115], v11, s[52:55], s65 offen offset:1024 sc1
v_mfma_f32_16x16x32_bf16 v[196:199], v[152:155], a[244:247], v[196:199]
v_mfma_f32_16x16x32_bf16 v[196:199], a[104:107], a[236:239], v[196:199]
buffer_load_dwordx2 v[252:253], v17, s[52:55], s65 offen offset:2048 sc1
v_mfma_f32_16x16x32_bf16 v[196:199], v[132:135], a[96:99], v[196:199]
v_mfma_f32_16x16x32_bf16 v[200:203], v[116:119], v[72:75], v[200:203]
v_mfma_f32_16x16x32_bf16 v[200:203], v[52:55], v[68:71], v[200:203]
ds_write_b128 v7, v[192:195] offset:3072
v_mfma_f32_16x16x32_bf16 v[200:203], v[136:139], v[40:43], v[200:203]
v_mfma_f32_16x16x32_bf16 v[200:203], v[48:51], a[100:103], v[200:203]
v_mfma_f32_16x16x32_bf16 v[200:203], a[128:131], a[116:119], v[200:203]
v_mfma_f32_16x16x32_bf16 v[200:203], v[64:67], a[164:167], v[200:203]
v_mfma_f32_16x16x32_bf16 v[204:207], v[44:47], a[164:167], v[204:207]
v_mfma_f32_16x16x32_bf16 v[204:207], a[132:135], a[116:119], v[204:207]
ds_write_b128 v7, v[196:199] offset:4096
v_mfma_f32_16x16x32_bf16 v[204:207], v[60:63], a[100:103], v[204:207]
v_mfma_f32_16x16x32_bf16 v[204:207], v[140:143], v[40:43], v[204:207]
v_mfma_f32_16x16x32_bf16 v[204:207], v[56:59], v[68:71], v[204:207]
v_mfma_f32_16x16x32_bf16 v[204:207], v[120:123], v[72:75], v[204:207]
v_mfma_f32_16x16x32_bf16 v[208:211], v[124:127], v[72:75], v[208:211]
v_mfma_f32_16x16x32_bf16 v[208:211], v[36:39], v[68:71], v[208:211]
ds_write_b128 v8, v[200:203] offset:0
v_mfma_f32_16x16x32_bf16 v[208:211], v[144:147], v[40:43], v[208:211]
v_mfma_f32_16x16x32_bf16 v[208:211], a[108:111], a[100:103], v[208:211]
v_mfma_f32_16x16x32_bf16 v[208:211], a[136:139], a[116:119], v[208:211]
v_mfma_f32_16x16x32_bf16 v[208:211], a[84:87], a[164:167], v[208:211]
v_mfma_f32_16x16x32_bf16 v[212:215], a[184:187], a[164:167], v[212:215]
v_mfma_f32_16x16x32_bf16 v[212:215], a[140:143], a[116:119], v[212:215]
ds_write_b128 v8, v[204:207] offset:1024
v_mfma_f32_16x16x32_bf16 v[212:215], a[160:163], a[100:103], v[212:215]
v_mfma_f32_16x16x32_bf16 v[212:215], v[148:151], v[40:43], v[212:215]
v_mfma_f32_16x16x32_bf16 v[212:215], a[180:183], v[68:71], v[212:215]
v_mfma_f32_16x16x32_bf16 v[212:215], v[128:131], v[72:75], v[212:215]
v_mfma_f32_16x16x32_bf16 v[216:219], v[132:135], v[72:75], v[216:219]
v_mfma_f32_16x16x32_bf16 v[216:219], a[104:107], v[68:71], v[216:219]
ds_write_b128 v8, v[208:211] offset:2048
v_mfma_f32_16x16x32_bf16 v[216:219], v[152:155], v[40:43], v[216:219]
v_mfma_f32_16x16x32_bf16 v[216:219], v[92:95], a[100:103], v[216:219]
v_mfma_f32_16x16x32_bf16 v[216:219], v[156:159], a[116:119], v[216:219]
v_mfma_f32_16x16x32_bf16 v[216:219], a[144:147], a[164:167], v[216:219]
v_mfma_f32_16x16x32_bf16 v[220:223], v[64:67], v[88:91], v[220:223]
s_waitcnt vmcnt(7)
v_mfma_f32_16x16x32_bf16 v[220:223], a[128:131], a[112:115], v[220:223]
s_waitcnt vmcnt(6)
ds_write_b128 v8, v[212:215] offset:3072
v_mfma_f32_16x16x32_bf16 v[220:223], v[48:51], a[124:127], v[220:223]
s_waitcnt vmcnt(5)
v_mfma_f32_16x16x32_bf16 v[220:223], v[136:139], v[84:87], v[220:223]
s_waitcnt vmcnt(4)
v_mfma_f32_16x16x32_bf16 v[220:223], v[52:55], v[80:83], v[220:223]
s_waitcnt vmcnt(3)
v_mfma_f32_16x16x32_bf16 v[220:223], v[116:119], a[228:231], v[220:223]
v_mfma_f32_16x16x32_bf16 v[224:227], v[120:123], a[228:231], v[224:227]
v_mfma_f32_16x16x32_bf16 v[224:227], v[56:59], v[80:83], v[224:227]
ds_write_b128 v8, v[216:219] offset:4096
v_mfma_f32_16x16x32_bf16 v[224:227], v[140:143], v[84:87], v[224:227]
v_mfma_f32_16x16x32_bf16 v[224:227], v[60:63], a[124:127], v[224:227]
v_mfma_f32_16x16x32_bf16 v[224:227], a[132:135], a[112:115], v[224:227]
v_mfma_f32_16x16x32_bf16 v[224:227], v[44:47], v[88:91], v[224:227]
s_waitcnt lgkmcnt(0)
s_barrier
v_mfma_f32_16x16x32_bf16 v[228:231], a[84:87], v[88:91], v[228:231]
ds_read_b128 v[160:163], v9 offset:0
v_mfma_f32_16x16x32_bf16 v[228:231], a[136:139], a[112:115], v[228:231]
ds_read_b128 v[180:183], v9 offset:5120
v_mfma_f32_16x16x32_bf16 v[228:231], a[108:111], a[124:127], v[228:231]
ds_read_b128 v[200:203], v9 offset:10240
v_mfma_f32_16x16x32_bf16 v[228:231], v[144:147], v[84:87], v[228:231]
ds_read_b128 v[164:167], v9 offset:1024
v_mfma_f32_16x16x32_bf16 v[228:231], v[36:39], v[80:83], v[228:231]
ds_read_b128 v[184:187], v9 offset:6144
v_mfma_f32_16x16x32_bf16 v[228:231], v[124:127], a[228:231], v[228:231]
ds_read_b128 v[204:207], v9 offset:11264
v_mfma_f32_16x16x32_bf16 v[232:235], v[128:131], a[228:231], v[232:235]
ds_read_b128 v[168:171], v9 offset:2048
v_mfma_f32_16x16x32_bf16 v[232:235], a[180:183], v[80:83], v[232:235]
ds_read_b128 v[188:191], v9 offset:7168
v_mfma_f32_16x16x32_bf16 v[232:235], v[148:151], v[84:87], v[232:235]
ds_read_b128 v[208:211], v9 offset:12288
v_mfma_f32_16x16x32_bf16 v[232:235], a[160:163], a[124:127], v[232:235]
ds_read_b128 v[172:175], v9 offset:3072
v_mfma_f32_16x16x32_bf16 v[232:235], a[140:143], a[112:115], v[232:235]
ds_read_b128 v[192:195], v9 offset:8192
v_mfma_f32_16x16x32_bf16 v[232:235], a[184:187], v[88:91], v[232:235]
ds_read_b128 v[212:215], v9 offset:13312
v_mfma_f32_16x16x32_bf16 v[236:239], a[144:147], v[88:91], v[236:239]
ds_read_b128 v[176:179], v9 offset:4096
v_mfma_f32_16x16x32_bf16 v[236:239], v[156:159], a[112:115], v[236:239]
ds_read_b128 v[196:199], v9 offset:9216
v_mfma_f32_16x16x32_bf16 v[236:239], v[92:95], a[124:127], v[236:239]
ds_read_b128 v[216:219], v9 offset:14336
v_mfma_f32_16x16x32_bf16 v[236:239], v[152:155], v[84:87], v[236:239]
v_mfma_f32_16x16x32_bf16 v[236:239], a[104:107], v[80:83], v[236:239]
v_mfma_f32_16x16x32_bf16 v[236:239], v[132:135], a[228:231], v[236:239]
s_waitcnt vmcnt(0)
s_waitcnt lgkmcnt(12)
v_lshlrev_b32 v96, 16, v76
v_and_b32 v97, 0xffff0000, v76
v_pk_add_f32 v[220:221], v[220:221], v[96:97]
v_lshlrev_b32 v96, 16, v77
v_and_b32 v97, 0xffff0000, v77
v_pk_add_f32 v[222:223], v[222:223], v[96:97]
v_pk_add_f32 v[160:161], v[160:161], v[180:181]
v_pk_add_f32 v[220:221], v[220:221], v[200:201]
v_pk_add_f32 v[162:163], v[162:163], v[182:183]
v_pk_add_f32 v[222:223], v[222:223], v[202:203]
v_pk_add_f32 v[220:221], v[220:221], v[160:161]
v_pk_add_f32 v[222:223], v[222:223], v[162:163]
v_cvt_pk_bf16_f32 v220, v220, v221
v_cvt_pk_bf16_f32 v221, v222, v223
ds_write_b64 v10, v[220:221] offset:0
s_waitcnt lgkmcnt(10)
v_lshlrev_b32 v96, 16, v78
v_and_b32 v97, 0xffff0000, v78
v_pk_add_f32 v[224:225], v[224:225], v[96:97]
v_lshlrev_b32 v96, 16, v79
v_and_b32 v97, 0xffff0000, v79
v_pk_add_f32 v[226:227], v[226:227], v[96:97]
v_pk_add_f32 v[164:165], v[164:165], v[184:185]
v_pk_add_f32 v[224:225], v[224:225], v[204:205]
v_pk_add_f32 v[166:167], v[166:167], v[186:187]
v_pk_add_f32 v[226:227], v[226:227], v[206:207]
v_pk_add_f32 v[224:225], v[224:225], v[164:165]
v_pk_add_f32 v[226:227], v[226:227], v[166:167]
v_cvt_pk_bf16_f32 v224, v224, v225
v_cvt_pk_bf16_f32 v225, v226, v227
ds_write_b64 v10, v[224:225] offset:32
s_waitcnt lgkmcnt(8)
v_lshlrev_b32 v96, 16, v112
v_and_b32 v97, 0xffff0000, v112
v_pk_add_f32 v[228:229], v[228:229], v[96:97]
v_lshlrev_b32 v96, 16, v113
v_and_b32 v97, 0xffff0000, v113
v_pk_add_f32 v[230:231], v[230:231], v[96:97]
v_pk_add_f32 v[168:169], v[168:169], v[188:189]
v_pk_add_f32 v[228:229], v[228:229], v[208:209]
v_pk_add_f32 v[170:171], v[170:171], v[190:191]
v_pk_add_f32 v[230:231], v[230:231], v[210:211]
v_pk_add_f32 v[228:229], v[228:229], v[168:169]
v_pk_add_f32 v[230:231], v[230:231], v[170:171]
v_cvt_pk_bf16_f32 v228, v228, v229
v_cvt_pk_bf16_f32 v229, v230, v231
ds_write_b64 v10, v[228:229] offset:64
s_waitcnt lgkmcnt(6)
v_lshlrev_b32 v96, 16, v114
v_and_b32 v97, 0xffff0000, v114
v_pk_add_f32 v[232:233], v[232:233], v[96:97]
v_lshlrev_b32 v96, 16, v115
v_and_b32 v97, 0xffff0000, v115
v_pk_add_f32 v[234:235], v[234:235], v[96:97]
v_pk_add_f32 v[172:173], v[172:173], v[192:193]
v_pk_add_f32 v[232:233], v[232:233], v[212:213]
v_pk_add_f32 v[174:175], v[174:175], v[194:195]
v_pk_add_f32 v[234:235], v[234:235], v[214:215]
v_pk_add_f32 v[232:233], v[232:233], v[172:173]
v_pk_add_f32 v[234:235], v[234:235], v[174:175]
v_cvt_pk_bf16_f32 v232, v232, v233
v_cvt_pk_bf16_f32 v233, v234, v235
ds_write_b64 v10, v[232:233] offset:96
s_waitcnt lgkmcnt(4)
v_lshlrev_b32 v96, 16, v252
v_and_b32 v97, 0xffff0000, v252
v_pk_add_f32 v[236:237], v[236:237], v[96:97]
v_lshlrev_b32 v96, 16, v253
v_and_b32 v97, 0xffff0000, v253
v_pk_add_f32 v[238:239], v[238:239], v[96:97]
v_pk_add_f32 v[176:177], v[176:177], v[196:197]
v_pk_add_f32 v[236:237], v[236:237], v[216:217]
v_pk_add_f32 v[178:179], v[178:179], v[198:199]
v_pk_add_f32 v[238:239], v[238:239], v[218:219]
v_pk_add_f32 v[236:237], v[236:237], v[176:177]
v_pk_add_f32 v[238:239], v[238:239], v[178:179]
v_cvt_pk_bf16_f32 v236, v236, v237
v_cvt_pk_bf16_f32 v237, v238, v239
ds_write_b64 v10, v[236:237] offset:128
ds_read_b128 v[160:163], v16 offset:0
ds_read_b128 v[164:167], v16 offset:1024
ds_read_b128 v[168:171], v16 offset:2048
s_waitcnt lgkmcnt(2)
buffer_store_dwordx4 v[160:163], v29, s[56:59], s35 offen
s_waitcnt lgkmcnt(1)
buffer_store_dwordx4 v[164:167], v21, s[56:59], s35 offen
s_waitcnt lgkmcnt(0)
buffer_store_dwordx4 v[168:171], v22, s[56:59], s35 offen
L_end:
s_endpgm
L_ci_spin:
s_mov_b32 s3, 0
L_ci_loop:
buffer_load_dword v239, v234, s[12:15], 0 offen sc1
s_waitcnt vmcnt(0)
v_readfirstlane_b32 s8, v239
v_readlane_b32 s9, v239, 1
s_nop 1
s_add_u32 s8, s8, s9
s_add_u32 s3, s3, 1
s_cmp_gt_u32 s3, 0x40000
s_cbranch_scc1 L_ci_ret
s_cmp_ge_u32 s8, 256
s_cbranch_scc0 L_ci_loop
s_branch L_ci_ret
L_spin0:
s_mov_b32 s3, 0
L_spin_loop0:
buffer_load_dword v13, v12, s[52:55], s28 offen sc1
s_waitcnt vmcnt(0)
v_cmp_ne_u32 vcc, 0, v13
s_add_u32 s3, s3, 1
s_cmp_gt_u32 s3, 0x40000
s_cbranch_scc1 L_spin_ret0
s_andn2_b32 s8, 15, vcc_lo
s_cbranch_scc1 L_spin_loop0
s_branch L_spin_ret0
L_spin1:
s_mov_b32 s3, 0
L_spin_loop1:
buffer_load_dword v13, v12, s[52:55], s29 offen sc1
s_waitcnt vmcnt(0)
v_cmp_ne_u32 vcc, 0, v13
s_add_u32 s3, s3, 1
s_cmp_gt_u32 s3, 0x40000
s_cbranch_scc1 L_spin_ret1
s_andn2_b32 s8, 15, vcc_lo
s_cbranch_scc1 L_spin_loop1
s_branch L_spin_ret1
L_spin2:
s_mov_b32 s3, 0
L_spin_loop2:
buffer_load_dword v13, v28, s[52:55], s31 offen sc1
s_waitcnt vmcnt(0)
v_cmp_ne_u32 vcc, 0, v13
s_add_u32 s3, s3, 1
s_cmp_gt_u32 s3, 0x40000
s_cbranch_scc1 L_spin_ret2
s_andn2_b32 s8, 0xff, vcc_lo
s_cbranch_scc1 L_spin_loop2
s_branch L_spin_ret2
L_spinx:
s_mov_b32 s3, 0
L_spin_loopx:
buffer_load_dword v13, v19, s[52:55], s46 offen sc1
s_waitcnt vmcnt(0)
v_cmp_ne_u32 vcc, 0, v13
s_add_u32 s3, s3, 1
s_cmp_gt_u32 s3, 0x40000
s_cbranch_scc1 L_spin_retx
s_andn2_b32 s8, 1, vcc_lo
s_cbranch_scc1 L_spin_loopx
s_branch L_spin_retx
L_fallback:
s_mov_b32 s73, -1
s_waitcnt vmcnt(0) lgkmcnt(0)
s_barrier
s_branch L_top
L_maxpass:
s_mov_b32 s8, 0
s_mov_b32 s9, m0
v_add_u32 v224, 131072, v2
v_add_u32 v225, 131072, v3
v_add_u32 v226, 131072, v4
v_add_u32 v227, 131072, v5
v_mov_b32 v24, 0xff800000
v_mov_b32 v25, 0xff800000
v_mov_b32 v26, 0xff800000
v_mov_b32 v27, 0xff800000
L_maxloop:
s_waitcnt vmcnt(0) lgkmcnt(0)
s_barrier
s_xor_b32 s3, s8, s67
s_add_u32 m0, s69, 131072
s_nop 0
buffer_load_dwordx4 v14, s[36:39], s3 offen offset:0 lds
buffer_load_dwordx4 v15, s[36:39], s3 offen offset:1024 lds
buffer_load_dwordx4 v16, s[36:39], s3 offen offset:2048 lds
buffer_load_dwordx4 v17, s[36:39], s3 offen offset:3072 lds
s_waitcnt vmcnt(0)
s_barrier
ds_read_b128 a[0:3], v224 offset:0
ds_read_b128 a[4:7], v225 offset:0
ds_read_b128 a[8:11], v226 offset:0
ds_read_b128 a[12:15], v227 offset:0
s_waitcnt lgkmcnt(0)
v_mfma_f32_16x16x32_bf16 v[96:99], a[0:3], v[32:35], 0
v_mfma_f32_16x16x32_bf16 v[96:99], a[4:7], v[36:39], v[96:99]
v_mfma_f32_16x16x32_bf16 v[96:99], a[8:11], v[40:43], v[96:99]
v_mfma_f32_16x16x32_bf16 v[96:99], a[12:15], v[44:47], v[96:99]
v_mfma_f32_16x16x32_bf16 v[100:103], a[0:3], v[48:51], 0
v_mfma_f32_16x16x32_bf16 v[100:103], a[4:7], v[52:55], v[100:103]
v_mfma_f32_16x16x32_bf16 v[100:103], a[8:11], v[56:59], v[100:103]
v_mfma_f32_16x16x32_bf16 v[100:103], a[12:15], v[60:63], v[100:103]
v_mfma_f32_16x16x32_bf16 v[104:107], a[0:3], v[64:67], 0
v_mfma_f32_16x16x32_bf16 v[104:107], a[4:7], v[68:71], v[104:107]
v_mfma_f32_16x16x32_bf16 v[104:107], a[8:11], v[72:75], v[104:107]
v_mfma_f32_16x16x32_bf16 v[104:107], a[12:15], v[76:79], v[104:107]
v_mfma_f32_16x16x32_bf16 v[108:111], a[0:3], v[80:83], 0
v_mfma_f32_16x16x32_bf16 v[108:111], a[4:7], v[84:87], v[108:111]
v_mfma_f32_16x16x32_bf16 v[108:111], a[8:11], v[88:91], v[108:111]
v_mfma_f32_16x16x32_bf16 v[108:111], a[12:15], v[92:95], v[108:111]
s_nop 9
v_max3_f32 v24, v96, v97, v24
v_max3_f32 v24, v98, v99, v24
v_max3_f32 v25, v100, v101, v25
v_max3_f32 v25, v102, v103, v25
v_max3_f32 v26, v104, v105, v26
v_max3_f32 v26, v106, v107, v26
v_max3_f32 v27, v108, v109, v27
v_max3_f32 v27, v110, v111, v27
ds_read_b128 a[0:3], v224 offset:4096
ds_read_b128 a[4:7], v225 offset:4096
ds_read_b128 a[8:11], v226 offset:4096
ds_read_b128 a[12:15], v227 offset:4096
s_waitcnt lgkmcnt(0)
v_mfma_f32_16x16x32_bf16 v[96:99], a[0:3], v[32:35], 0
v_mfma_f32_16x16x32_bf16 v[96:99], a[4:7], v[36:39], v[96:99]
v_mfma_f32_16x16x32_bf16 v[96:99], a[8:11], v[40:43], v[96:99]
v_mfma_f32_16x16x32_bf16 v[96:99], a[12:15], v[44:47], v[96:99]
v_mfma_f32_16x16x32_bf16 v[100:103], a[0:3], v[48:51], 0
v_mfma_f32_16x16x32_bf16 v[100:103], a[4:7], v[52:55], v[100:103]
v_mfma_f32_16x16x32_bf16 v[100:103], a[8:11], v[56:59], v[100:103]
v_mfma_f32_16x16x32_bf16 v[100:103], a[12:15], v[60:63], v[100:103]
v_mfma_f32_16x16x32_bf16 v[104:107], a[0:3], v[64:67], 0
v_mfma_f32_16x16x32_bf16 v[104:107], a[4:7], v[68:71], v[104:107]
v_mfma_f32_16x16x32_bf16 v[104:107], a[8:11], v[72:75], v[104:107]
v_mfma_f32_16x16x32_bf16 v[104:107], a[12:15], v[76:79], v[104:107]
v_mfma_f32_16x16x32_bf16 v[108:111], a[0:3], v[80:83], 0
v_mfma_f32_16x16x32_bf16 v[108:111], a[4:7], v[84:87], v[108:111]
v_mfma_f32_16x16x32_bf16 v[108:111], a[8:11], v[88:91], v[108:111]
v_mfma_f32_16x16x32_bf16 v[108:111], a[12:15], v[92:95], v[108:111]
s_nop 9
v_max3_f32 v24, v96, v97, v24
v_max3_f32 v24, v98, v99, v24
v_max3_f32 v25, v100, v101, v25
v_max3_f32 v25, v102, v103, v25
v_max3_f32 v26, v104, v105, v26
v_max3_f32 v26, v106, v107, v26
v_max3_f32 v27, v108, v109, v27
v_max3_f32 v27, v110, v111, v27
ds_read_b128 a[0:3], v224 offset:8192
ds_read_b128 a[4:7], v225 offset:8192
ds_read_b128 a[8:11], v226 offset:8192
ds_read_b128 a[12:15], v227 offset:8192
s_waitcnt lgkmcnt(0)
v_mfma_f32_16x16x32_bf16 v[96:99], a[0:3], v[32:35], 0
v_mfma_f32_16x16x32_bf16 v[96:99], a[4:7], v[36:39], v[96:99]
v_mfma_f32_16x16x32_bf16 v[96:99], a[8:11], v[40:43], v[96:99]
v_mfma_f32_16x16x32_bf16 v[96:99], a[12:15], v[44:47], v[96:99]
v_mfma_f32_16x16x32_bf16 v[100:103], a[0:3], v[48:51], 0
v_mfma_f32_16x16x32_bf16 v[100:103], a[4:7], v[52:55], v[100:103]
v_mfma_f32_16x16x32_bf16 v[100:103], a[8:11], v[56:59], v[100:103]
v_mfma_f32_16x16x32_bf16 v[100:103], a[12:15], v[60:63], v[100:103]
v_mfma_f32_16x16x32_bf16 v[104:107], a[0:3], v[64:67], 0
v_mfma_f32_16x16x32_bf16 v[104:107], a[4:7], v[68:71], v[104:107]
v_mfma_f32_16x16x32_bf16 v[104:107], a[8:11], v[72:75], v[104:107]
v_mfma_f32_16x16x32_bf16 v[104:107], a[12:15], v[76:79], v[104:107]
v_mfma_f32_16x16x32_bf16 v[108:111], a[0:3], v[80:83], 0
v_mfma_f32_16x16x32_bf16 v[108:111], a[4:7], v[84:87], v[108:111]
v_mfma_f32_16x16x32_bf16 v[108:111], a[8:11], v[88:91], v[108:111]
v_mfma_f32_16x16x32_bf16 v[108:111], a[12:15], v[92:95], v[108:111]
s_nop 9
v_max3_f32 v24, v96, v97, v24
v_max3_f32 v24, v98, v99, v24
v_max3_f32 v25, v100, v101, v25
v_max3_f32 v25, v102, v103, v25
v_max3_f32 v26, v104, v105, v26
v_max3_f32 v26, v106, v107, v26
v_max3_f32 v27, v108, v109, v27
v_max3_f32 v27, v110, v111, v27
ds_read_b128 a[0:3], v224 offset:12288
ds_read_b128 a[4:7], v225 offset:12288
ds_read_b128 a[8:11], v226 offset:12288
ds_read_b128 a[12:15], v227 offset:12288
s_waitcnt lgkmcnt(0)
v_mfma_f32_16x16x32_bf16 v[96:99], a[0:3], v[32:35], 0
v_mfma_f32_16x16x32_bf16 v[96:99], a[4:7], v[36:39], v[96:99]
v_mfma_f32_16x16x32_bf16 v[96:99], a[8:11], v[40:43], v[96:99]
v_mfma_f32_16x16x32_bf16 v[96:99], a[12:15], v[44:47], v[96:99]
v_mfma_f32_16x16x32_bf16 v[100:103], a[0:3], v[48:51], 0
v_mfma_f32_16x16x32_bf16 v[100:103], a[4:7], v[52:55], v[100:103]
v_mfma_f32_16x16x32_bf16 v[100:103], a[8:11], v[56:59], v[100:103]
v_mfma_f32_16x16x32_bf16 v[100:103], a[12:15], v[60:63], v[100:103]
v_mfma_f32_16x16x32_bf16 v[104:107], a[0:3], v[64:67], 0
v_mfma_f32_16x16x32_bf16 v[104:107], a[4:7], v[68:71], v[104:107]
v_mfma_f32_16x16x32_bf16 v[104:107], a[8:11], v[72:75], v[104:107]
v_mfma_f32_16x16x32_bf16 v[104:107], a[12:15], v[76:79], v[104:107]
v_mfma_f32_16x16x32_bf16 v[108:111], a[0:3], v[80:83], 0
v_mfma_f32_16x16x32_bf16 v[108:111], a[4:7], v[84:87], v[108:111]
v_mfma_f32_16x16x32_bf16 v[108:111], a[8:11], v[88:91], v[108:111]
v_mfma_f32_16x16x32_bf16 v[108:111], a[12:15], v[92:95], v[108:111]
s_nop 9
v_max3_f32 v24, v96, v97, v24
v_max3_f32 v24, v98, v99, v24
v_max3_f32 v25, v100, v101, v25
v_max3_f32 v25, v102, v103, v25
v_max3_f32 v26, v104, v105, v26
v_max3_f32 v26, v106, v107, v26
v_max3_f32 v27, v108, v109, v27
v_max3_f32 v27, v110, v111, v27
s_sub_u32 s8, s8, 213504
s_and_b32 s8, s8, 213504
s_cbranch_scc1 L_maxloop
v_mov_b32 v224, v24
v_mov_b32 v225, v25
v_mov_b32 v226, v26
v_mov_b32 v227, v27
v_permlane32_swap_b32 v24, v224
v_permlane32_swap_b32 v25, v225
v_permlane32_swap_b32 v26, v226
v_permlane32_swap_b32 v27, v227
v_max_f32 v24, v24, v224
v_max_f32 v25, v25, v225
v_max_f32 v26, v26, v226
v_max_f32 v27, v27, v227
v_mov_b32 v224, v24
v_mov_b32 v225, v25
v_mov_b32 v226, v26
v_mov_b32 v227, v27
v_permlane16_swap_b32 v24, v224
v_permlane16_swap_b32 v25, v225
v_permlane16_swap_b32 v26, v226
v_permlane16_swap_b32 v27, v227
v_max_f32 v24, v24, v224
v_max_f32 v25, v25, v225
v_max_f32 v26, v26, v226
v_max_f32 v27, v27, v227
v_sub_f32 v240, 0, v24
v_sub_f32 v241, 0, v24
v_sub_f32 v242, 0, v24
v_sub_f32 v243, 0, v24
v_sub_f32 v244, 0, v25
v_sub_f32 v245, 0, v25
v_sub_f32 v246, 0, v25
v_sub_f32 v247, 0, v25
v_sub_f32 v248, 0, v26
v_sub_f32 v249, 0, v26
v_sub_f32 v250, 0, v26
v_sub_f32 v251, 0, v26
v_sub_f32 v252, 0, v27
v_sub_f32 v253, 0, v27
v_sub_f32 v254, 0, v27
v_sub_f32 v255, 0, v27
s_mov_b32 m0, s9
s_nop 1
s_branch L_rerun
L_codeend:
.section .rodata,"a"
.p2align 6
.amdhsa_kernel standalone__mha_block_cached__near_ridge_kernel
  .amdhsa_next_free_vgpr 512
  .amdhsa_next_free_sgpr 102
  .amdhsa_accum_offset 256
  .amdhsa_group_segment_fixed_size 0
  .amdhsa_kernarg_size 64
  .amdhsa_user_sgpr_count 2
  .amdhsa_user_sgpr_kernarg_segment_ptr 1
  .amdhsa_system_sgpr_workgroup_id_x 1
  .amdhsa_float_denorm_mode_32 3
.end_amdhsa_kernel
```
